```python
import torch

def _softmax(x, axis=-1):
    return torch.softmax(x, dim=axis)
def _gelu(x):
    return torch.nn.functional.gelu(x, approximate="tanh")
def _silu(x):
    return torch.nn.functional.silu(x)
def _sigmoid(x):
    return torch.sigmoid(x)
def _layernorm(x, axis=-1, eps=1e-5):
    m = x.mean(dim=axis, keepdim=True)
    v = x.var(dim=axis, keepdim=True, unbiased=False)
    return (x - m) / torch.sqrt(v + eps)
def _scatter_add(tgt, idx, src, axis=0):
    return tgt.clone().index_add_(axis, idx, src)
def _segment_sum(src, seg, n):
    out = torch.zeros((n,) + src.shape[1:], dtype=src.dtype)
    return out.index_add_(0, seg, src)
def _pad(x, pw):
    flat = tuple(v for pair in reversed(pw) for v in pair)
    return torch.nn.functional.pad(x, flat)

kernel_name = 'interleave_layers__ssm_conv_s4d__dense_activation_relu__prompt'

def setup_inputs():

    _w = (lambda a: (lambda t: t.to(torch.bfloat16) if t.is_floating_point() else t)(torch.as_tensor(a)))
    def _A_setup():
        Bsz, L, D, N = 1, 2048, 512, 128
        return {
            "u": _w((lambda *s: torch.randn(*s, dtype=torch.bfloat16) * 0.05)(Bsz, L, D)),
            "log_A_real": _w((lambda *s: torch.randn(*s, dtype=torch.bfloat16) * 3.2)(D, N) * 0.5),
            "A_imag": _w((lambda *s: torch.randn(*s, dtype=torch.bfloat16) * 0.2)(D, N) * 3.14),
            "C_real": _w((lambda *s: torch.randn(*s, dtype=torch.bfloat16) * 0.2)(D, N) / N ** 0.5),
            "C_imag": _w((lambda *s: torch.randn(*s, dtype=torch.bfloat16) * 0.2)(D, N) / N ** 0.5),
            "log_dt": _w((lambda *s: torch.randn(*s, dtype=torch.bfloat16) * 0.2)(D) * 0.5 - 4.0),
            "D_skip": _w((lambda *s: torch.randn(*s, dtype=torch.bfloat16) * 0.2)(D)),
        }
    _A_in = _A_setup()

    def _B_setup():
        B, S, D, Dff = 1, 2048, 512, 1376
        return {
            "x": _w((lambda *s: torch.randn(*s, dtype=torch.bfloat16) * 0.05)(B, S, D)),
            "w1": _w((lambda *s: torch.randn(*s, dtype=torch.bfloat16) * 0.05)(D, Dff)),
            "w2": _w((lambda *s: torch.randn(*s, dtype=torch.bfloat16) * 0.05)(Dff, D)),
        }
    _B_in = _B_setup()

    return {
        "A_u": _A_in["u"],
        "A_log_A_real": _A_in["log_A_real"],
        "A_A_imag": _A_in["A_imag"],
        "A_C_real": _A_in["C_real"],
        "A_C_imag": _A_in["C_imag"],
        "A_log_dt": _A_in["log_dt"],
        "A_D_skip": _A_in["D_skip"],
        "B_x": _B_in["x"],
        "B_w1": _B_in["w1"],
        "B_w2": _B_in["w2"],
    }

def reference(A_u, A_log_A_real, A_A_imag, A_C_real, A_C_imag, A_log_dt, A_D_skip, B_x, B_w1, B_w2):
    def _A_ref(u, log_A_real, A_imag, C_real, C_imag, log_dt, D_skip):
        L = u.shape[1]
        dt = torch.exp(log_dt)
        A = -torch.exp(log_A_real) + 1j * A_imag
        C = (C_real + 1j * C_imag) * dt[:, None]
        pos = (lambda x, dt: x.to(dt))(torch.arange(L), log_dt.dtype)
        P = torch.exp((A * dt[:, None])[:, :, None] * pos[None, None, :])
        K = 2.0 * torch.einsum("dn,dnl->dl", C, P).real
        L2 = 2 * L
        u_t = (lambda x, *d: x.permute(*d))(u, 0, 2, 1)
        Kf = (lambda x, *a, **k: torch.fft.rfft(x.float(), *a, **k))(K, L2)
        Uf = (lambda x, *a, **k: torch.fft.rfft(x.float(), *a, **k))(u_t, L2)
        y = (lambda x, *a, **k: torch.fft.irfft(x, *a, **k).to(torch.bfloat16))(Uf * Kf[None, :, :], L2)[:, :, :L]
        y = (lambda x, *d: x.permute(*d))(y, 0, 2, 1)
        return y + u * D_skip[None, None, :]

    def _B_ref(x, w1, w2):
        h = torch.einsum("bsd,df->bsf", x, w1)
        zero = torch.zeros_like(h)
        h = torch.maximum(h, zero)
        return torch.einsum("bsf,fd->bsd", h, w2)

    x = A_u
    x = x + _A_ref(_layernorm(x, axis=-1), A_log_A_real, A_A_imag, A_C_real, A_C_imag, A_log_dt, A_D_skip)
    x = x + _B_ref(_layernorm(x, axis=-1), B_w1, B_w2)
    x = x + _A_ref(_layernorm(x, axis=-1), A_log_A_real, A_A_imag, A_C_real, A_C_imag, A_log_dt, A_D_skip)
    x = x + _B_ref(_layernorm(x, axis=-1), B_w1, B_w2)
    return x
```

```asm
; @launch grid=(256,1,1) block=(256,1,1) lds=163840
.amdgcn_target "amdgcn-amd-amdhsa--gfx950"
.text
.globl interleave_layers__ssm_conv_s4d__dense_activation_relu__prompt_kernel
.p2align 12
.p2align 8
.type interleave_layers__ssm_conv_s4d__dense_activation_relu__prompt_kernel,@function
.set CODESZ, Lcodeend-interleave_layers__ssm_conv_s4d__dense_activation_relu__prompt_kernel-64
interleave_layers__ssm_conv_s4d__dense_activation_relu__prompt_kernel:
  s_cmp_ge_u32 s2, 256
  s_cbranch_scc1 Lend
  s_load_dwordx16 s[32:47], s[0:1], 0
  s_load_dwordx8 s[48:55], s[0:1], 64
  s_load_dwordx2 s[56:57], s[0:1], 96
  s_getpc_b64 s[58:59]
  v_mov_b32 v64, v0
  v_lshrrev_b32_e64 v12, 6, v0
  v_and_b32_e64 v65, 63, v0
  v_readfirstlane_b32 s3, v12
  s_lshr_b32 s76, s2, 3
  s_mul_i32 s76, s76, 10
  v_min_u32_e64 v16, 9, v65
  v_add_lshl_u32 v16, v16, s76, 7
  v_min_u32 v16, CODESZ, v16
  s_cmp_lg_u32 s3, 3
  s_cbranch_scc1 Lnopf
  global_load_dword v66, v16, s[58:59]
Lnopf:
  v_lshlrev_b32_e64 v3, 4, v0
  v_lshlrev_b32_e64 v4, 4, v65
  v_lshlrev_b32_e64 v5, 3, v65
  s_and_b32 s76, s2, 7
  s_lshr_b32 s77, s2, 3
  s_lshl_b32 s6, s76, 5
  s_add_u32 s6, s6, s77
  s_lshr_b32 s4, s76, 0
  s_lshl_b32 s4, s4, 2
  s_lshr_b32 s78, s77, 3
  s_add_u32 s4, s4, s78
  s_and_b32 s5, s76, 0
  s_lshl_b32 s5, s5, 3
  s_and_b32 s78, s77, 7
  s_add_u32 s5, s5, s78
  s_mov_b32 s70, 0xffff0000
  s_mov_b32 s74, 100000
  s_nop 0
  s_nop 0
  v_mov_b32_e64 v252, -1
  v_mov_b32_e64 v253, -1
  v_mov_b32 v254, -1
  v_mov_b32 v255, -1
  v_mov_b32 v11, 0
  s_lshl_b32 s69, s2, 13
  s_lshl_b32 s77, s3, 11
  s_add_u32 s76, s69, s77
  s_lshr_b32 s77, s3, 1
  s_lshl_b32 s77, s77, 12
  s_and_b32 s78, s3, 1
  s_lshl_b32 s78, s78, 9
  s_add_u32 s77, s77, s78
  s_add_u32 s77, s77, s69
  v_lshlrev_b32 v13, 2, v65
  s_mov_b32 s81, 3031040
  s_waitcnt lgkmcnt(0)
  s_mov_b32 s12, s56
  s_and_b32 s13, s57, 0xffff
  s_mov_b32 s14, 0x1700000
  s_mov_b32 s15, 0x20000
  buffer_load_dword v38, off, s[12:15], s81 sc1
  s_mov_b32 s8, s32
  s_and_b32 s9, s33, 0xffff
  s_mov_b32 s10, 0x200000
  s_mov_b32 s11, 0x20000
  buffer_load_dwordx4 v[24:27], v4, s[8:11], s76 offen
  buffer_load_dwordx4 v[28:31], v4, s[8:11], s76 offen offset:1024
  buffer_load_dword v124, v13, s[8:11], s77 offen offset:0
  buffer_load_dword v125, v13, s[8:11], s77 offen offset:1024
  buffer_load_dword v126, v13, s[8:11], s77 offen offset:2048
  buffer_load_dword v127, v13, s[8:11], s77 offen offset:3072
  buffer_load_dword v128, v13, s[8:11], s77 offen offset:256
  buffer_load_dword v129, v13, s[8:11], s77 offen offset:1280
  buffer_load_dword v130, v13, s[8:11], s77 offen offset:2304
  buffer_load_dword v131, v13, s[8:11], s77 offen offset:3328
  s_lshl_b32 s78, s6, 9
  v_lshl_add_u32 v12, v64, 1, s78
  global_load_ushort v32, v12, s[34:35]
  global_load_ushort v33, v12, s[36:37]
  global_load_ushort v34, v12, s[38:39]
  global_load_ushort v35, v12, s[40:41]
  v_lshrrev_b32 v12, 7, v12
  v_and_b32 v12, -2, v12
  global_load_ushort v36, v12, s[42:43]
  s_lshl_b32 s78, s6, 2
  v_mov_b32_e64 v12, s78
  global_load_dword v37, v12, s[44:45]
  s_mov_b32 s16, s52
  s_and_b32 s17, s53, 0xffff
  s_mov_b32 s18, 0x200000
  s_mov_b32 s19, 0x20000
  s_cmp_ge_u32 s3, 2
  s_cselect_b32 s20, s50, s48
  s_cselect_b32 s21, s51, s49
  s_and_b32 s21, s21, 0xffff
  s_mov_b32 s22, 1409024
  s_mov_b32 s23, 0x20000
  s_mul_i32 s79, s2, 8192
  s_add_u32 s79, s79, 4194304
  buffer_store_dwordx4 v[252:255], v3, s[12:15], s79 offen sc1
  s_add_u32 s79, s79, 4096
  buffer_store_dwordx4 v[252:255], v3, s[12:15], s79 offen sc1
  s_and_b32 s76, s3, 1
  s_lshl_b32 s77, s4, 1
  s_add_u32 s76, s76, s77
  s_and_b32 s77, s76, 3
  s_mul_i32 s77, s77, 20
  s_lshr_b32 s78, s76, 2
  s_xor_b32 s77, s77, s78
  s_cmp_lt_u32 s3, 2
  s_cselect_b32 s76, s77, s76
  s_lshl_b32 s92, s5, 7
  s_lshr_b32 s93, s3, 1
  s_lshl_b32 s93, s93, 6
  s_add_u32 s92, s92, s93
  s_add_u32 s92, s92, s76
  s_lshl_b32 s92, s92, 2
  s_add_u32 s92, s92, 3035136
  s_mul_i32 s85, s3, 5120
  s_add_u32 s85, s85, 65536
  s_mov_b64 s[100:101], 0
  s_cmp_ge_u32 s3, 2
  s_cselect_b32 s93, 0x80008000, 0
  s_cbranch_scc1 Lw21
  s_lshr_b32 s77, s76, 4
  s_lshl_b32 s78, s77, 2
  s_xor_b32 s78, s78, s76
  s_and_b32 s78, s78, 15
  s_mul_i32 s78, s78, 88064
  s_mul_i32 s79, s5, 344
  s_add_u32 s78, s78, s79
  s_mul_i32 s79, s77, 88
  s_add_u32 s78, s78, s79
  s_lshl_b32 s84, s5, 6
  s_add_u32 s84, s84, s76
  s_mul_i32 s84, s84, 3072
  s_add_u32 s84, s84, 18874368
  s_mov_b32 s91, 2146435072
  s_mov_b32 s90, 0
  s_mov_b32 s86, 0xf000f000
  s_mov_b32 s87, 0xf000f000
  s_cmp_eq_u32 s77, 3
  s_cselect_b32 s88, 0x0f000f00, 0
  s_mov_b32 s89, s88
  v_add_u32 v20, 0, v65
  v_mul_u32_u24 v21, 171, v20
  v_lshrrev_b32 v21, 10, v21
  v_lshlrev_b32 v20, 4, v20
  v_mul_u32_u24 v22, 2656, v21
  v_add3_u32 v132, v22, v20, s78
  v_lshlrev_b32 v22, 6, v21
  v_add3_u32 v140, v22, v20, s85
  v_add_u32 v20, 64, v65
  v_mul_u32_u24 v21, 171, v20
  v_lshrrev_b32 v21, 10, v21
  v_lshlrev_b32 v20, 4, v20
  v_mul_u32_u24 v22, 2656, v21
  v_add3_u32 v133, v22, v20, s78
  v_lshlrev_b32_e64 v22, 6, v21
  v_add3_u32 v141, v22, v20, s85
  v_add_u32 v20, 128, v65
  v_mul_u32_u24 v21, 171, v20
  v_lshrrev_b32 v21, 10, v21
  v_lshlrev_b32 v20, 4, v20
  v_mul_u32_u24 v22, 2656, v21
  v_add3_u32 v134, v22, v20, s78
  v_lshlrev_b32_e64 v22, 6, v21
  v_add3_u32 v142, v22, v20, s85
  v_mov_b32 v135, 2146435072
  v_mov_b32 v143, 160512
  s_branch Lwj2
Lw21:
  s_mul_i32 s77, s76, 187
  s_lshr_b32 s77, s77, 11
  s_mul_i32 s78, s77, 11
  s_sub_u32 s78, s76, s78
  s_mul_i32 s84, s5, 44
  s_add_u32 s84, s84, s76
  s_lshl_b32 s84, s84, 12
  s_add_u32 s84, s84, 1572864
  s_cmp_ge_u32 s76, 44
  s_cselect_b32 s91, 2146435072, 0
  s_mov_b32 s90, s91
  s_mov_b64 s[86:87], 0
  s_mov_b64 s[88:89], 0
  s_mul_i32 s77, s77, 352256
  s_lshl_b32 s79, s5, 7
  s_add_u32 s77, s77, s79
  v_lshrrev_b32 v20, 3, v65
  v_and_b32 v21, 0x70, v4
  v_mul_u32_u24 v22, 160, v20
  v_add3_u32 v140, v22, v21, s85
  v_add_u32 v141, 1280, v140
  v_add_u32 v142, 2560, v140
  v_add_u32 v143, 3840, v140
  s_cmp_ge_u32 s78, 8
  s_cselect_b32 s100, 0, s93
  s_cselect_b32 s101, s93, 0
  s_cbranch_scc1 Lw33
  s_lshr_b32 s79, s78, 2
  s_mul_i32 s79, s79, 176128
  s_and_b32 s78, s78, 3
  s_mul_i32 s78, s78, 45056
  s_add_u32 s77, s77, s79
  s_add_u32 s77, s77, s78
  v_lshlrev_b32_e64 v22, 10, v20
  v_add3_u32 v132, v22, v21, s77
  v_add_u32 v133, 0x2000, v132
  v_add_u32 v134, 0x4000, v132
  v_add_u32 v135, 0x6000, v132
  s_branch Lwj2
Lw33:
  s_sub_u32 s78, s78, 8
  s_lshl_b32 s78, s78, 3
  v_and_b32 v22, 3, v20
  v_lshlrev_b32 v22, 10, v22
  v_add3_u32 v21, v21, v22, s77
  v_lshrrev_b32 v20, 2, v20
  v_add_u32 v20, s78, v20
  v_mov_b32 v57, 0x100000
  v_add_u32 v22, 0, v20
  v_mul_u32_u24 v23, 43, v22
  v_lshrrev_b32 v23, 7, v23
  v_lshrrev_b32 v56, 2, v23
  v_lshl_add_u32 v23, v23, 3, v22
  v_sub_u32 v23, v23, v56
  v_lshl_add_u32 v23, v23, 2, 32
  v_mul_u32_u24 v56, 12, v56
  v_sub_u32 v22, v22, v56
  v_cmp_eq_u32 vcc, 11, v22
  s_nop 1
  v_cndmask_b32 v23, v23, v57, vcc
  v_lshl_add_u32 v132, v23, 10, v21
  v_add_u32 v22, 2, v20
  v_mul_u32_u24 v23, 43, v22
  v_lshrrev_b32 v23, 7, v23
  v_lshrrev_b32 v56, 2, v23
  v_lshl_add_u32 v23, v23, 3, v22
  v_sub_u32 v23, v23, v56
  v_lshl_add_u32 v23, v23, 2, 32
  v_mul_u32_u24 v56, 12, v56
  v_sub_u32 v22, v22, v56
  v_cmp_eq_u32 vcc, 11, v22
  s_nop 1
  v_cndmask_b32 v23, v23, v57, vcc
  v_lshl_add_u32 v133, v23, 10, v21
  v_add_u32 v22, 4, v20
  v_mul_u32_u24 v23, 43, v22
  v_lshrrev_b32 v23, 7, v23
  v_lshrrev_b32 v56, 2, v23
  v_lshl_add_u32 v23, v23, 3, v22
  v_sub_u32 v23, v23, v56
  v_lshl_add_u32 v23, v23, 2, 32
  v_mul_u32_u24 v56, 12, v56
  v_sub_u32 v22, v22, v56
  v_cmp_eq_u32 vcc, 11, v22
  s_nop 1
  v_cndmask_b32 v23, v23, v57, vcc
  v_lshl_add_u32 v134, v23, 10, v21
  v_add_u32 v22, 6, v20
  v_mul_u32_u24 v23, 43, v22
  v_lshrrev_b32 v23, 7, v23
  v_lshrrev_b32 v56, 2, v23
  v_lshl_add_u32 v23, v23, 3, v22
  v_sub_u32 v23, v23, v56
  v_lshl_add_u32 v23, v23, 2, 32
  v_mul_u32_u24 v56, 12, v56
  v_sub_u32 v22, v22, v56
  v_cmp_eq_u32 vcc, 11, v22
  s_nop 1
  v_cndmask_b32_e64 v23, v23, v57, vcc
  v_lshl_add_u32 v135, v23, 10, v21
Lwj2:
  s_mov_b32 s71, 0x05040100
  s_mov_b32 s72, 0x07060302
  s_mov_b32 s73, 0x3727c5ac
  s_mov_b32 s75, 0x80008000
  s_mov_b32 s67, 0x41000000
  s_mov_b32 s60, 0x22222222
  s_mov_b32 s61, 0x22222222
  s_mov_b32 s62, 0x44444444
  s_mov_b32 s63, 0x44444444
  s_mov_b32 s64, 0x88888888
  s_mov_b32 s65, 0x88888888
  s_mov_b32 s38, 0x00020002
  s_mov_b32 s39, 0x00020002
  s_lshl_b32 s32, s6, 6
  s_lshl_b32 s33, s4, 14
  s_and_b32 s7, s6, 31
  s_lshl_b32 s7, s7, 4
  s_lshr_b32 s76, s6, 5
  s_lshl_b32 s76, s76, 18
  s_add_u32 s7, s7, s76
  s_lshl_b32 s76, s4, 4
  s_add_u32 s26, s76, s3
  s_mul_i32 s26, s26, 11264
  s_add_u32 s26, s26, 10485760
  s_lshr_b32 s77, s5, 1
  s_add_u32 s76, s76, s77
  s_mul_i32 s76, s76, 11264
  s_add_u32 s76, s76, 10485760
  s_and_b32 s77, s5, 1
  s_lshl_b32 s77, s77, 2
  s_add_u32 s77, s77, s3
  s_lshl_b32 s24, s77, 10
  s_add_u32 s24, s24, s76
  s_mul_i32 s25, s77, 384
  s_add_u32 s25, s25, s76
  s_add_u32 s25, s25, 8192
  s_lshl_b32 s76, s4, 2
  s_add_u32 s76, s76, s3
  s_mul_i32 s46, s76, 64
  s_add_u32 s46, s46, 3080192
  s_lshl_b32 s27, s76, 9
  s_lshl_b32 s76, s76, 12
  s_lshl_b32 s77, s5, 7
  s_add_u32 s47, s76, s77
  s_lshl_b32 s77, s5, 18
  s_add_u32 s27, s27, s77
  s_add_u32 s27, s27, 8388608
  s_lshl_b32 s76, s5, 2
  s_add_u32 s76, s76, s3
  s_mul_i32 s34, s76, 49152
  s_add_u32 s34, s34, 18874368
  s_mul_i32 s35, s76, 45056
  s_add_u32 s35, s35, 1572864
  s_lshl_b32 s76, s3, 12
  v_add_u32 v0, s76, v5
  s_add_u32 s76, s76, 141312
  v_lshrrev_b32 v12, 4, v65
  v_lshlrev_b32 v13, 6, v12
  v_xor_b32 v13, v4, v13
  v_add_u32 v2, s76, v13
  v_mov_b32 v13, 2146435072
  v_cmp_gt_u32 vcc, 48, v65
  s_nop 1
  v_cndmask_b32 v1, v13, v5, vcc
  v_bfe_u32 v13, v65, 2, 2
  v_cmp_eq_u32_e64 vcc, v13, v12
  s_lshl_b32 s76, s3, 2
  s_add_u32 s76, s76, 157696
  v_and_b32 v13, 0xf0, v4
  v_add_u32_e64 v13, s76, v13
  v_mov_b32 v12, 160512
  v_cndmask_b32_e64 v9, v12, v13, vcc
  s_lshl_b32 s76, s5, 11
  s_lshl_b32 s77, s3, 3
  s_add_u32 s76, s76, s77
  s_lshl_b32 s77, s3, 6
  v_and_b32 v12, 0xf0, v4
  v_xor_b32 v12, s77, v12
  v_lshl_add_u32 v7, v4, 1, s76
  s_lshl_b32 s77, s3, 8
  s_add_u32 s77, s77, 141312
  v_lshrrev_b32 v13, 8, v4
  v_lshlrev_b32 v13, 10, v13
  v_add3_u32 v6, v12, v13, s77
  v_lshrrev_b32 v12, 8, v4
  v_lshlrev_b32 v12, 4, v12
  v_bfe_u32 v13, v4, 7, 1
  v_lshl_add_u32 v12, v13, 2, v12
  v_bfe_u32 v13, v4, 4, 1
  v_lshl_add_u32 v12, v13, 3, v12
  v_mov_b32 v13, 2146435072
  s_mov_b32 s76, 0x01030103
  s_mov_b32 s77, s76
  v_cndmask_b32 v8, v13, v12, s[76:77]
  v_lshlrev_b32 v12, 3, v64
  v_mov_b32 v15, 1023
  s_mov_b32 s76, 141312
  v_add_u32 v13, 7, v12
  v_cvt_f32_i32 v14, v13
  v_cvt_pk_bf16_f32 v14, v14, 0
  v_subrev_u32 v14, 17024, v14
  v_min_i32 v100, 0x80, v13
  v_max_i32 v100, v100, v14
  v_lshl_add_u32 v100, v100, 2, s76
  v_add_u32 v13, 6, v12
  v_cvt_f32_i32_e64 v14, v13
  v_cvt_pk_bf16_f32 v14, v14, 0
  v_subrev_u32 v14, 17024, v14
  v_min_i32 v101, 0x80, v13
  v_max_i32 v101, v101, v14
  v_lshl_add_u32 v101, v101, 2, s76
  v_add_u32 v13, 5, v12
  v_cvt_f32_i32 v14, v13
  v_cvt_pk_bf16_f32 v14, v14, 0
  v_subrev_u32 v14, 17024, v14
  v_min_i32 v102, 0x80, v13
  v_max_i32 v102, v102, v14
  v_lshl_add_u32 v102, v102, 2, s76
  v_add_u32 v13, 4, v12
  v_cvt_f32_i32 v14, v13
  v_cvt_pk_bf16_f32 v14, v14, 0
  v_subrev_u32 v14, 17024, v14
  v_min_i32 v103, 0x80, v13
  v_max_i32 v103, v103, v14
  v_lshl_add_u32 v103, v103, 2, s76
  v_add_u32 v13, 3, v12
  v_cvt_f32_i32_e64 v14, v13
  v_cvt_pk_bf16_f32 v14, v14, 0
  v_subrev_u32 v14, 17024, v14
  v_min_i32 v104, 0x80, v13
  v_max_i32_e64 v104, v104, v14
  v_lshl_add_u32 v104, v104, 2, s76
  v_add_u32 v13, 2, v12
  v_cvt_f32_i32 v14, v13
  v_cvt_pk_bf16_f32 v14, v14, 0
  v_subrev_u32 v14, 17024, v14
  v_min_i32 v105, 0x80, v13
  v_max_i32 v105, v105, v14
  v_lshl_add_u32 v105, v105, 2, s76
  v_add_u32 v13, 1, v12
  v_cvt_f32_i32_e64 v14, v13
  v_cvt_pk_bf16_f32 v14, v14, 0
  v_subrev_u32 v14, 17024, v14
  v_min_i32 v106, 0x80, v13
  v_max_i32_e64 v106, v106, v14
  v_lshl_add_u32 v106, v106, 2, s76
  v_add_u32 v13, 0, v12
  v_cvt_f32_i32 v14, v13
  v_cvt_pk_bf16_f32 v14, v14, 0
  v_subrev_u32 v14, 17024, v14
  v_min_i32 v107, 0x80, v13
  v_max_i32 v107, v107, v14
  v_lshl_add_u32 v107, v107, 2, s76
  v_add_u32 v13, -1, v12
  v_cvt_f32_i32_e64 v14, v13
  v_cvt_pk_bf16_f32 v14, v14, 0
  v_subrev_u32 v14, 17024, v14
  v_min_i32 v108, 0x80, v13
  v_max_i32 v108, v108, v14
  v_cmp_gt_i32 vcc, 0, v13
  s_nop 1
  v_cndmask_b32 v108, v108, v15, vcc
  v_lshl_add_u32 v108, v108, 2, s76
  v_add_u32 v13, -2, v12
  v_cvt_f32_i32 v14, v13
  v_cvt_pk_bf16_f32 v14, v14, 0
  v_subrev_u32 v14, 17024, v14
  v_min_i32 v109, 0x80, v13
  v_max_i32 v109, v109, v14
  v_cmp_gt_i32 vcc, 0, v13
  s_nop 1
  v_cndmask_b32 v109, v109, v15, vcc
  v_lshl_add_u32 v109, v109, 2, s76
  v_add_u32 v13, -3, v12
  v_cvt_f32_i32 v14, v13
  v_cvt_pk_bf16_f32 v14, v14, 0
  v_subrev_u32 v14, 17024, v14
  v_min_i32 v110, 0x80, v13
  v_max_i32 v110, v110, v14
  v_cmp_gt_i32 vcc, 0, v13
  s_nop 1
  v_cndmask_b32 v110, v110, v15, vcc
  v_lshl_add_u32 v110, v110, 2, s76
  v_add_u32 v13, -4, v12
  v_cvt_f32_i32 v14, v13
  v_cvt_pk_bf16_f32 v14, v14, 0
  v_subrev_u32 v14, 17024, v14
  v_min_i32 v111, 0x80, v13
  v_max_i32 v111, v111, v14
  v_cmp_gt_i32 vcc, 0, v13
  s_nop 1
  v_cndmask_b32 v111, v111, v15, vcc
  v_lshl_add_u32 v111, v111, 2, s76
  v_add_u32 v13, -5, v12
  v_cvt_f32_i32 v14, v13
  v_cvt_pk_bf16_f32 v14, v14, 0
  v_subrev_u32 v14, 17024, v14
  v_min_i32 v112, 0x80, v13
  v_max_i32 v112, v112, v14
  v_cmp_gt_i32 vcc, 0, v13
  s_nop 1
  v_cndmask_b32 v112, v112, v15, vcc
  v_lshl_add_u32 v112, v112, 2, s76
  v_add_u32 v13, -6, v12
  v_cvt_f32_i32 v14, v13
  v_cvt_pk_bf16_f32 v14, v14, 0
  v_subrev_u32 v14, 17024, v14
  v_min_i32 v113, 0x80, v13
  v_max_i32 v113, v113, v14
  v_cmp_gt_i32 vcc, 0, v13
  s_nop 1
  v_cndmask_b32 v113, v113, v15, vcc
  v_lshl_add_u32 v113, v113, 2, s76
  v_add_u32 v13, -7, v12
  v_cvt_f32_i32 v14, v13
  v_cvt_pk_bf16_f32 v14, v14, 0
  v_subrev_u32 v14, 17024, v14
  v_min_i32 v114, 0x80, v13
  v_max_i32 v114, v114, v14
  v_cmp_gt_i32 vcc, 0, v13
  s_nop 1
  v_cndmask_b32 v114, v114, v15, vcc
  v_lshl_add_u32 v114, v114, 2, s76
  v_mov_b32 v14, 0
  v_and_b32 v12, 127, v64
  v_lshrrev_b32 v13, 7, v64
  v_mul_u32_u24 v13, 4608, v13
  v_lshl_add_u32 v12, v12, 2, v13
  v_add_u32 v12, 132096, v12
  ds_write_b32 v12, v14
  buffer_load_dwordx4 v[40:43], v132, s[20:23], 0 offen
  buffer_load_dwordx4 v[44:47], v133, s[20:23], 0 offen
  buffer_load_dwordx4 v[48:51], v134, s[20:23], 0 offen
  buffer_load_dwordx4 v[52:55], v135, s[20:23], 0 offen
  s_waitcnt vmcnt(21)
  v_lshlrev_b32 v72, 16, v24
  v_and_b32 v73, s70, v24
  v_lshlrev_b32 v74, 16, v25
  v_and_b32 v75, s70, v25
  v_lshlrev_b32 v76, 16, v26
  v_and_b32 v77, s70, v26
  v_lshlrev_b32 v78, 16, v27
  v_and_b32 v79, s70, v27
  v_add_f32 v80, v72, v73
  v_mul_f32 v82, v72, v72
  v_fmac_f32 v82, v73, v73
  v_add_f32 v80, v80, v74
  v_fmac_f32 v82, v74, v74
  v_add_f32 v80, v80, v75
  v_fmac_f32 v82, v75, v75
  v_add_f32 v80, v80, v76
  v_fmac_f32 v82, v76, v76
  v_add_f32 v80, v80, v77
  v_fmac_f32 v82, v77, v77
  v_add_f32 v80, v80, v78
  v_fmac_f32 v82, v78, v78
  v_add_f32 v80, v80, v79
  v_fmac_f32 v82, v79, v79
  s_waitcnt vmcnt(20)
  v_lshlrev_b32 v72, 16, v28
  v_and_b32 v73, s70, v28
  v_lshlrev_b32 v74, 16, v29
  v_and_b32 v75, s70, v29
  v_lshlrev_b32 v76, 16, v30
  v_and_b32 v77, s70, v30
  v_lshlrev_b32 v78, 16, v31
  v_and_b32 v79, s70, v31
  v_add_f32 v81, v72, v73
  v_mul_f32 v83, v72, v72
  v_fmac_f32 v83, v73, v73
  v_add_f32 v81, v81, v74
  v_fmac_f32 v83, v74, v74
  v_add_f32 v81, v81, v75
  v_fmac_f32 v83, v75, v75
  v_add_f32 v81, v81, v76
  v_fmac_f32 v83, v76, v76
  v_add_f32 v81, v81, v77
  v_fmac_f32 v83, v77, v77
  v_add_f32 v81, v81, v78
  v_fmac_f32 v83, v78, v78
  v_add_f32 v81, v81, v79
  v_fmac_f32 v83, v79, v79
  s_nop 0
  v_permlane32_swap_b32 v80, v81
  v_permlane32_swap_b32 v82, v83
  v_add_f32 v80, v80, v81
  v_add_f32 v82, v82, v83
  v_lshrrev_b32 v74, 2, v65
  s_nop 0
  v_permlane16_swap_b32 v80, v82
  v_add_f32 v80, v80, v82
  v_mov_b32 v75, 2146435072
  v_and_b32 v76, 31, v65
  v_add_f32_dpp v80, v80, v80 row_ror:8 row_mask:0xf bank_mask:0xf
  v_cmp_eq_u32 vcc, 0, v76
  s_lshl_b32 s76, s2, 6
  v_add_f32_dpp v80, v80, v80 row_half_mirror row_mask:0xf bank_mask:0xf
  v_cndmask_b32_e64 v74, v75, v74, vcc
  s_lshl_b32 s77, s3, 4
  v_add_f32_dpp v80, v80, v80 quad_perm:[2,3,0,1] row_mask:0xf bank_mask:0xf
  s_add_u32 s76, s76, s77
  s_add_u32 s76, s76, 3014656
  v_add_f32_dpp v80, v80, v80 quad_perm:[1,0,3,2] row_mask:0xf bank_mask:0xf
  v_mul_f32 v72, 0x3b000000, v80
  v_mul_f32 v82, 0x3b000000, v80
  s_nop 1
  v_permlane16_swap_b32 v72, v82
  v_fma_f32 v82, -v72, v72, v82
  v_max_f32_e64 v82, 0, v82
  v_cvt_pk_bf16_f32 v82, v82, v82
  v_and_b32 v82, s70, v82
  v_add_f32 v82, s73, v82
  v_cvt_pk_bf16_f32 v82, v82, v82
  v_and_b32 v82, s70, v82
  v_sqrt_f32 v82, v82
  s_nop 0
  v_cvt_pk_bf16_f32 v120, v72, v82
  v_mov_b32 v122, v74
  s_mov_b32 s82, s76
  v_readfirstlane_b32 s41, v38
  s_nop 0
  s_mul_i32 s40, s41, 0x9e3779b1
  s_add_u32 s40, s40, 0x7f4a7c15
  v_mov_b32_e64 v121, s40
  s_lshr_b32 s76, s3, 1
  s_lshl_b32 s77, s2, 1
  s_add_u32 s76, s76, s77
  s_lshl_b32 s76, s76, 9
  s_and_b32 s77, s3, 1
  s_lshl_b32 s77, s77, 20
  s_add_u32 s76, s76, s77
  s_add_u32 s76, s76, 16777216
  s_add_u32 s77, s76, 0x80000
  v_lshrrev_b32_e64 v12, 5, v65
  v_and_b32 v13, 0x1f0, v4
  v_lshl_add_u32 v12, v12, 18, v13
  s_waitcnt vmcnt(18)
  v_perm_b32 v76, v125, v124, s71
  s_waitcnt vmcnt(16)
  v_perm_b32 v77, v127, v126, s71
  v_perm_b32 v78, v125, v124, s72
  v_perm_b32 v79, v127, v126, s72
  buffer_store_dwordx4 v[76:79], v12, s[12:15], s76 offen sc1
  s_waitcnt vmcnt(15)
  v_perm_b32 v80, v129, v128, s71
  s_waitcnt vmcnt(13)
  v_perm_b32 v81, v131, v130, s71
  v_perm_b32 v82, v129, v128, s72
  v_perm_b32 v83, v131, v130, s72
  buffer_store_dwordx4 v[80:83], v12, s[12:15], s77 offen sc1
  s_waitcnt vmcnt(8)
  v_readfirstlane_b32 s66, v37
  v_lshlrev_b32 v32, 16, v32
  v_lshlrev_b32 v33, 16, v33
  v_lshlrev_b32 v34, 16, v34
  v_lshlrev_b32 v35, 16, v35
  v_lshlrev_b32_e64 v36, 16, v36
  v_mul_f32 v32, 0x3fb8aa3b, v32
  v_mul_f32 v36, 0x3fb8aa3b, v36
  v_exp_f32 v32, v32
  v_exp_f32 v36, v36
  v_cvt_pk_bf16_f32 v32, v32, v32
  v_and_b32 v32, s70, v32
  v_cvt_pk_bf16_f32 v36, v36, v36
  v_and_b32 v36, s70, v36
  v_mul_f32 v32, v32, v36
  v_mul_f32 v33, v33, v36
  v_add_f32_e64 v36, v36, v36
  v_mul_f32 v32, 0xbfb8aa3b, v32
  v_mul_f32 v33, 0.15915494, v33
  v_mul_f32 v34, v34, v36
  v_mul_f32 v35, v35, v36
  v_mul_f32 v13, 0x3f800000, v33
  v_mul_f32 v12, 0x3f800000, v32
  v_fract_f32 v13, v13
  v_exp_f32 v12, v12
  v_cos_f32 v68, v13
  v_sin_f32 v69, v13
  v_mul_f32 v68, v68, v12
  v_mul_f32_e64 v69, v69, v12
  v_mul_f32 v15, 0x41000000, v33
  v_mul_f32 v14, 0x41000000, v32
  v_fract_f32 v15, v15
  v_exp_f32 v14, v14
  v_cos_f32 v70, v15
  v_sin_f32 v71, v15
  v_mul_f32 v70, v70, v14
  v_mul_f32 v71, v71, v14
  v_mul_f32 v13, 0x42800000, v33
  v_mul_f32 v12, 0x42800000, v32
  v_fract_f32 v13, v13
  v_exp_f32 v12, v12
  v_cos_f32 v72, v13
  v_sin_f32 v73, v13
  v_mul_f32 v72, v72, v12
  v_mul_f32 v73, v73, v12
  v_mul_f32 v15, 0x43000000, v33
  v_mul_f32 v14, 0x43000000, v32
  v_fract_f32 v15, v15
  v_exp_f32 v14, v14
  v_cos_f32 v74, v15
  v_sin_f32 v75, v15
  v_mul_f32 v74, v74, v14
  v_mul_f32 v75, v75, v14
  v_mul_f32 v13, 0x43400000, v33
  v_mul_f32 v12, 0x43400000, v32
  v_fract_f32 v13, v13
  v_exp_f32 v12, v12
  v_cos_f32 v76, v13
  v_sin_f32 v77, v13
  v_mul_f32 v76, v76, v12
  v_mul_f32 v77, v77, v12
  v_mul_f32 v15, 0x43800000, v33
  v_mul_f32 v14, 0x43800000, v32
  v_fract_f32 v15, v15
  v_exp_f32 v14, v14
  v_cos_f32 v78, v15
  v_sin_f32 v79, v15
  v_mul_f32 v78, v78, v14
  v_mul_f32 v79, v79, v14
  v_lshrrev_b32 v12, 7, v64
  v_lshlrev_b32 v12, 15, v12
  v_and_b32 v13, 127, v64
  v_lshl_add_u32 v12, v13, 5, v12
  v_mov_b32 v14, 1.0
  v_mov_b32 v15, 0
  v_cvt_pk_bf16_f32 v80, v14, v70
  v_cvt_pk_bf16_f32 v84, v15, v71
  v_pk_mul_f32 v[16:17], v[70:71], v[70:71] op_sel_hi:[1,0]
  v_pk_fma_f32 v[16:17], v[70:71], v[70:71], v[16:17] op_sel:[1,1,0] op_sel_hi:[0,1,1] neg_lo:[0,1,0]
  v_pk_mul_f32 v[18:19], v[16:17], v[70:71] op_sel_hi:[1,0]
  v_pk_fma_f32 v[18:19], v[16:17], v[70:71], v[18:19] op_sel:[1,1,0] op_sel_hi:[0,1,1] neg_lo:[0,1,0]
  v_cvt_pk_bf16_f32 v81, v16, v18
  v_cvt_pk_bf16_f32 v85, v17, v19
  v_pk_mul_f32 v[16:17], v[18:19], v[70:71] op_sel_hi:[1,0]
  v_pk_fma_f32 v[16:17], v[18:19], v[70:71], v[16:17] op_sel:[1,1,0] op_sel_hi:[0,1,1] neg_lo:[0,1,0]
  v_pk_mul_f32 v[18:19], v[16:17], v[70:71] op_sel_hi:[1,0]
  v_pk_fma_f32 v[18:19], v[16:17], v[70:71], v[18:19] op_sel:[1,1,0] op_sel_hi:[0,1,1] neg_lo:[0,1,0]
  v_cvt_pk_bf16_f32 v82, v16, v18
  v_cvt_pk_bf16_f32 v86, v17, v19
  v_pk_mul_f32 v[16:17], v[18:19], v[70:71] op_sel_hi:[1,0]
  v_pk_fma_f32 v[16:17], v[18:19], v[70:71], v[16:17] op_sel:[1,1,0] op_sel_hi:[0,1,1] neg_lo:[0,1,0]
  v_pk_mul_f32 v[18:19], v[16:17], v[70:71] op_sel_hi:[1,0]
  v_pk_fma_f32 v[18:19], v[16:17], v[70:71], v[18:19] op_sel:[1,1,0] op_sel_hi:[0,1,1] neg_lo:[0,1,0]
  v_cvt_pk_bf16_f32 v83, v16, v18
  v_cvt_pk_bf16_f32 v87, v17, v19
  ds_write_b128 v12, v[80:83] offset:16384
  ds_write_b128 v12, v[84:87] offset:20480
  v_pk_mul_f32 v[18:19], v[72:73], v[70:71] op_sel_hi:[1,0]
  v_pk_fma_f32 v[18:19], v[72:73], v[70:71], v[18:19] op_sel:[1,1,0] op_sel_hi:[0,1,1] neg_lo:[0,1,0]
  v_cvt_pk_bf16_f32 v88, v72, v18
  v_cvt_pk_bf16_f32 v92, v73, v19
  v_pk_mul_f32 v[16:17], v[18:19], v[70:71] op_sel_hi:[1,0]
  v_pk_fma_f32 v[16:17], v[18:19], v[70:71], v[16:17] op_sel:[1,1,0] op_sel_hi:[0,1,1] neg_lo:[0,1,0]
  v_pk_mul_f32 v[18:19], v[16:17], v[70:71] op_sel_hi:[1,0]
  v_pk_fma_f32 v[18:19], v[16:17], v[70:71], v[18:19] op_sel:[1,1,0] op_sel_hi:[0,1,1] neg_lo:[0,1,0]
  v_cvt_pk_bf16_f32 v89, v16, v18
  v_cvt_pk_bf16_f32 v93, v17, v19
  v_pk_mul_f32 v[16:17], v[18:19], v[70:71] op_sel_hi:[1,0]
  v_pk_fma_f32 v[16:17], v[18:19], v[70:71], v[16:17] op_sel:[1,1,0] op_sel_hi:[0,1,1] neg_lo:[0,1,0]
  v_pk_mul_f32 v[18:19], v[16:17], v[70:71] op_sel_hi:[1,0]
  v_pk_fma_f32 v[18:19], v[16:17], v[70:71], v[18:19] op_sel:[1,1,0] op_sel_hi:[0,1,1] neg_lo:[0,1,0]
  v_cvt_pk_bf16_f32 v90, v16, v18
  v_cvt_pk_bf16_f32 v94, v17, v19
  v_pk_mul_f32 v[16:17], v[18:19], v[70:71] op_sel_hi:[1,0]
  v_pk_fma_f32 v[16:17], v[18:19], v[70:71], v[16:17] op_sel:[1,1,0] op_sel_hi:[0,1,1] neg_lo:[0,1,0]
  v_pk_mul_f32 v[18:19], v[16:17], v[70:71] op_sel_hi:[1,0]
  v_pk_fma_f32 v[18:19], v[16:17], v[70:71], v[18:19] op_sel:[1,1,0] op_sel_hi:[0,1,1] neg_lo:[0,1,0]
  v_cvt_pk_bf16_f32 v91, v16, v18
  v_cvt_pk_bf16_f32 v95, v17, v19
  ds_write_b128 v12, v[88:91] offset:16400
  ds_write_b128 v12, v[92:95] offset:20496
  v_pk_mul_f32 v[18:19], v[74:75], v[70:71] op_sel_hi:[1,0]
  v_pk_fma_f32 v[18:19], v[74:75], v[70:71], v[18:19] op_sel:[1,1,0] op_sel_hi:[0,1,1] neg_lo:[0,1,0]
  v_cvt_pk_bf16_f32 v80, v74, v18
  v_cvt_pk_bf16_f32 v84, v75, v19
  v_pk_mul_f32 v[16:17], v[18:19], v[70:71] op_sel_hi:[1,0]
  v_pk_fma_f32 v[16:17], v[18:19], v[70:71], v[16:17] op_sel:[1,1,0] op_sel_hi:[0,1,1] neg_lo:[0,1,0]
  v_pk_mul_f32 v[18:19], v[16:17], v[70:71] op_sel_hi:[1,0]
  v_pk_fma_f32 v[18:19], v[16:17], v[70:71], v[18:19] op_sel:[1,1,0] op_sel_hi:[0,1,1] neg_lo:[0,1,0]
  v_cvt_pk_bf16_f32 v81, v16, v18
  v_cvt_pk_bf16_f32 v85, v17, v19
  v_pk_mul_f32 v[16:17], v[18:19], v[70:71] op_sel_hi:[1,0]
  v_pk_fma_f32 v[16:17], v[18:19], v[70:71], v[16:17] op_sel:[1,1,0] op_sel_hi:[0,1,1] neg_lo:[0,1,0]
  v_pk_mul_f32 v[18:19], v[16:17], v[70:71] op_sel_hi:[1,0]
  v_pk_fma_f32 v[18:19], v[16:17], v[70:71], v[18:19] op_sel:[1,1,0] op_sel_hi:[0,1,1] neg_lo:[0,1,0]
  v_cvt_pk_bf16_f32 v82, v16, v18
  v_cvt_pk_bf16_f32 v86, v17, v19
  v_pk_mul_f32 v[16:17], v[18:19], v[70:71] op_sel_hi:[1,0]
  v_pk_fma_f32 v[16:17], v[18:19], v[70:71], v[16:17] op_sel:[1,1,0] op_sel_hi:[0,1,1] neg_lo:[0,1,0]
  v_pk_mul_f32 v[18:19], v[16:17], v[70:71] op_sel_hi:[1,0]
  v_pk_fma_f32 v[18:19], v[16:17], v[70:71], v[18:19] op_sel:[1,1,0] op_sel_hi:[0,1,1] neg_lo:[0,1,0]
  v_cvt_pk_bf16_f32 v83, v16, v18
  v_cvt_pk_bf16_f32 v87, v17, v19
  ds_write_b128 v12, v[80:83] offset:24576
  ds_write_b128 v12, v[84:87] offset:28672
  v_pk_mul_f32 v[18:19], v[76:77], v[70:71] op_sel_hi:[1,0]
  v_pk_fma_f32 v[18:19], v[76:77], v[70:71], v[18:19] op_sel:[1,1,0] op_sel_hi:[0,1,1] neg_lo:[0,1,0]
  v_cvt_pk_bf16_f32 v88, v76, v18
  v_cvt_pk_bf16_f32 v92, v77, v19
  v_pk_mul_f32 v[16:17], v[18:19], v[70:71] op_sel_hi:[1,0]
  v_pk_fma_f32 v[16:17], v[18:19], v[70:71], v[16:17] op_sel:[1,1,0] op_sel_hi:[0,1,1] neg_lo:[0,1,0]
  v_pk_mul_f32 v[18:19], v[16:17], v[70:71] op_sel_hi:[1,0]
  v_pk_fma_f32 v[18:19], v[16:17], v[70:71], v[18:19] op_sel:[1,1,0] op_sel_hi:[0,1,1] neg_lo:[0,1,0]
  v_cvt_pk_bf16_f32 v89, v16, v18
  v_cvt_pk_bf16_f32 v93, v17, v19
  v_pk_mul_f32 v[16:17], v[18:19], v[70:71] op_sel_hi:[1,0]
  v_pk_fma_f32 v[16:17], v[18:19], v[70:71], v[16:17] op_sel:[1,1,0] op_sel_hi:[0,1,1] neg_lo:[0,1,0]
  v_pk_mul_f32 v[18:19], v[16:17], v[70:71] op_sel_hi:[1,0]
  v_pk_fma_f32 v[18:19], v[16:17], v[70:71], v[18:19] op_sel:[1,1,0] op_sel_hi:[0,1,1] neg_lo:[0,1,0]
  v_cvt_pk_bf16_f32 v90, v16, v18
  v_cvt_pk_bf16_f32 v94, v17, v19
  v_pk_mul_f32 v[16:17], v[18:19], v[70:71] op_sel_hi:[1,0]
  v_pk_fma_f32 v[16:17], v[18:19], v[70:71], v[16:17] op_sel:[1,1,0] op_sel_hi:[0,1,1] neg_lo:[0,1,0]
  v_pk_mul_f32 v[18:19], v[16:17], v[70:71] op_sel_hi:[1,0]
  v_pk_fma_f32 v[18:19], v[16:17], v[70:71], v[18:19] op_sel:[1,1,0] op_sel_hi:[0,1,1] neg_lo:[0,1,0]
  v_cvt_pk_bf16_f32 v91, v16, v18
  v_cvt_pk_bf16_f32 v95, v17, v19
  ds_write_b128 v12, v[88:91] offset:24592
  ds_write_b128 v12, v[92:95] offset:28688
  v_pk_mul_f32 v[18:19], v[34:35], v[68:69] op_sel_hi:[1,0]
  v_pk_fma_f32 v[18:19], v[34:35], v[68:69], v[18:19] op_sel:[1,1,0] op_sel_hi:[0,1,1] neg_lo:[0,1,0]
  v_cvt_pk_bf16_f32 v80, v34, v18
  v_cvt_pk_bf16_f32 v84, -v35, -v19
  v_pk_mul_f32 v[16:17], v[18:19], v[68:69] op_sel_hi:[1,0]
  v_pk_fma_f32 v[16:17], v[18:19], v[68:69], v[16:17] op_sel:[1,1,0] op_sel_hi:[0,1,1] neg_lo:[0,1,0]
  v_pk_mul_f32 v[18:19], v[16:17], v[68:69] op_sel_hi:[1,0]
  v_pk_fma_f32 v[18:19], v[16:17], v[68:69], v[18:19] op_sel:[1,1,0] op_sel_hi:[0,1,1] neg_lo:[0,1,0]
  v_cvt_pk_bf16_f32 v81, v16, v18
  v_cvt_pk_bf16_f32 v85, -v17, -v19
  v_pk_mul_f32 v[16:17], v[18:19], v[68:69] op_sel_hi:[1,0]
  v_pk_fma_f32 v[16:17], v[18:19], v[68:69], v[16:17] op_sel:[1,1,0] op_sel_hi:[0,1,1] neg_lo:[0,1,0]
  v_pk_mul_f32 v[18:19], v[16:17], v[68:69] op_sel_hi:[1,0]
  v_pk_fma_f32 v[18:19], v[16:17], v[68:69], v[18:19] op_sel:[1,1,0] op_sel_hi:[0,1,1] neg_lo:[0,1,0]
  v_cvt_pk_bf16_f32 v82, v16, v18
  v_cvt_pk_bf16_f32 v86, -v17, -v19
  v_pk_mul_f32 v[16:17], v[18:19], v[68:69] op_sel_hi:[1,0]
  v_pk_fma_f32 v[16:17], v[18:19], v[68:69], v[16:17] op_sel:[1,1,0] op_sel_hi:[0,1,1] neg_lo:[0,1,0]
  v_pk_mul_f32 v[18:19], v[16:17], v[68:69] op_sel_hi:[1,0]
  v_pk_fma_f32 v[18:19], v[16:17], v[68:69], v[18:19] op_sel:[1,1,0] op_sel_hi:[0,1,1] neg_lo:[0,1,0]
  v_cvt_pk_bf16_f32 v83, v16, v18
  v_cvt_pk_bf16_f32 v87, -v17, -v19
  ds_write_b128 v12, v[80:83] offset:0
  ds_write_b128 v12, v[84:87] offset:4096
  v_pk_mul_f32 v[24:25], v[68:69], v[68:69] op_sel_hi:[1,0]
  v_pk_fma_f32 v[24:25], v[68:69], v[68:69], v[24:25] op_sel:[1,1,0] op_sel_hi:[0,1,1] neg_lo:[0,1,0]
  v_pk_mul_f32 v[28:29], v[34:35], v[78:79] op_sel_hi:[1,0]
  v_pk_fma_f32 v[28:29], v[34:35], v[78:79], v[28:29] op_sel:[1,1,0] op_sel_hi:[0,1,1] neg_lo:[0,1,0]
  v_pk_mul_f32 v[26:27], v[24:25], v[24:25] op_sel_hi:[1,0]
  v_pk_fma_f32 v[26:27], v[24:25], v[24:25], v[26:27] op_sel:[1,1,0] op_sel_hi:[0,1,1] neg_lo:[0,1,0]
  v_pk_mul_f32 v[16:17], v[28:29], v[24:25] op_sel_hi:[1,0]
  v_pk_fma_f32 v[16:17], v[28:29], v[24:25], v[16:17] op_sel:[1,1,0] op_sel_hi:[0,1,1] neg_lo:[0,1,0]
  v_cvt_pk_bf16_f32 v88, v28, v16
  v_cvt_pk_bf16_f32 v92, -v29, -v17
  v_pk_mul_f32 v[18:19], v[16:17], v[24:25] op_sel_hi:[1,0]
  v_pk_fma_f32 v[18:19], v[16:17], v[24:25], v[18:19] op_sel:[1,1,0] op_sel_hi:[0,1,1] neg_lo:[0,1,0]
  v_pk_mul_f32 v[16:17], v[18:19], v[24:25] op_sel_hi:[1,0]
  v_pk_fma_f32 v[16:17], v[18:19], v[24:25], v[16:17] op_sel:[1,1,0] op_sel_hi:[0,1,1] neg_lo:[0,1,0]
  v_cvt_pk_bf16_f32 v89, v18, v16
  v_cvt_pk_bf16_f32 v93, -v19, -v17
  v_pk_mul_f32 v[30:31], v[28:29], v[78:79] op_sel_hi:[1,0]
  v_pk_fma_f32 v[30:31], v[28:29], v[78:79], v[30:31] op_sel:[1,1,0] op_sel_hi:[0,1,1] neg_lo:[0,1,0]
  v_pk_mul_f32 v[16:17], v[30:31], v[26:27] op_sel_hi:[1,0]
  v_pk_fma_f32 v[16:17], v[30:31], v[26:27], v[16:17] op_sel:[1,1,0] op_sel_hi:[0,1,1] neg_lo:[0,1,0]
  v_cvt_pk_bf16_f32 v90, v30, v16
  v_cvt_pk_bf16_f32 v94, -v31, -v17
  v_pk_mul_f32 v[28:29], v[30:31], v[78:79] op_sel_hi:[1,0]
  v_pk_fma_f32 v[28:29], v[30:31], v[78:79], v[28:29] op_sel:[1,1,0] op_sel_hi:[0,1,1] neg_lo:[0,1,0]
  v_pk_mul_f32 v[16:17], v[28:29], v[26:27] op_sel_hi:[1,0]
  v_pk_fma_f32 v[16:17], v[28:29], v[26:27], v[16:17] op_sel:[1,1,0] op_sel_hi:[0,1,1] neg_lo:[0,1,0]
  v_cvt_pk_bf16_f32 v91, v28, v16
  v_cvt_pk_bf16_f32 v95, -v29, -v17
  ds_write_b128 v12, v[88:91] offset:16
  ds_write_b128 v12, v[92:95] offset:4112
  v_pk_mul_f32 v[30:31], v[28:29], v[78:79] op_sel_hi:[1,0]
  v_pk_fma_f32 v[30:31], v[28:29], v[78:79], v[30:31] op_sel:[1,1,0] op_sel_hi:[0,1,1] neg_lo:[0,1,0]
  v_pk_mul_f32 v[28:29], v[30:31], v[78:79] op_sel_hi:[1,0]
  v_pk_fma_f32 v[28:29], v[30:31], v[78:79], v[28:29] op_sel:[1,1,0] op_sel_hi:[0,1,1] neg_lo:[0,1,0]
  v_cvt_pk_bf16_f32 v80, v30, v28
  v_cvt_pk_bf16_f32 v84, -v31, -v29
  v_pk_mul_f32 v[30:31], v[28:29], v[78:79] op_sel_hi:[1,0]
  v_pk_fma_f32 v[30:31], v[28:29], v[78:79], v[30:31] op_sel:[1,1,0] op_sel_hi:[0,1,1] neg_lo:[0,1,0]
  v_pk_mul_f32 v[28:29], v[30:31], v[78:79] op_sel_hi:[1,0]
  v_pk_fma_f32 v[28:29], v[30:31], v[78:79], v[28:29] op_sel:[1,1,0] op_sel_hi:[0,1,1] neg_lo:[0,1,0]
  v_cvt_pk_bf16_f32 v81, v30, v28
  v_cvt_pk_bf16_f32 v85, -v31, -v29
  v_pk_mul_f32 v[30:31], v[28:29], v[78:79] op_sel_hi:[1,0]
  v_pk_fma_f32 v[30:31], v[28:29], v[78:79], v[30:31] op_sel:[1,1,0] op_sel_hi:[0,1,1] neg_lo:[0,1,0]
  v_cvt_pk_bf16_f32 v82, v30, v30
  v_cvt_pk_bf16_f32 v86, -v31, -v31
  ds_write_b128 v12, v[80:83] offset:8192
  ds_write_b128 v12, v[84:87] offset:12288
  s_mov_b64 exec, 0
  s_cmp_eq_u32 s3, 0
  s_cbranch_scc1 Lpad0
  s_cmp_eq_u32 s3, 1
  s_cbranch_scc1 Lpad1
  s_cmp_eq_u32 s3, 2
  s_cbranch_scc1 Lpad2
  s_branch Lpad3
Lpadret:
  s_mov_b64 exec, -1
  s_waitcnt vmcnt(0)
  buffer_store_dwordx2 v[120:121], v122, s[12:15], s82 offen sc1
  ds_write_b128 v140, v[40:43]
  ds_write_b128 v141, v[44:47]
  ds_write_b128 v142, v[48:51]
  ds_write_b128 v143, v[52:55]
  v_lshrrev_b32 v136, 2, v65
  v_mul_u32_u24 v136, 160, v136
  v_and_b32 v137, 24, v5
  v_add3_u32 v136, v136, v137, s85
  v_mov_b32 v137, 0x3f803f80
  v_or_b32 v138, s90, v4
  v_or_b32 v139, s91, v4
  ds_read_b64_tr_b16 v[40:41], v136 offset:0
  ds_read_b64_tr_b16 v[42:43], v136 offset:2560
  ds_read_b64_tr_b16 v[44:45], v136 offset:32
  ds_read_b64_tr_b16 v[46:47], v136 offset:2592
  ds_read_b64_tr_b16 v[48:49], v136 offset:64
  ds_read_b64_tr_b16 v[50:51], v136 offset:2624
  ds_read_b64_tr_b16 v[52:53], v136 offset:96
  ds_read_b64_tr_b16 v[54:55], v136 offset:2656
  s_waitcnt lgkmcnt(3)
  v_cndmask_b32 v48, v48, v137, s[86:87]
  v_cndmask_b32 v48, v48, 0, s[88:89]
  v_cndmask_b32 v49, v49, v137, s[86:87]
  v_cndmask_b32 v49, v49, 0, s[88:89]
  s_waitcnt lgkmcnt(2)
  v_cndmask_b32 v50, v50, v137, s[86:87]
  v_cndmask_b32 v50, v50, 0, s[88:89]
  v_cndmask_b32 v51, v51, v137, s[86:87]
  v_cndmask_b32 v51, v51, 0, s[88:89]
  v_xor_b32 v41, s93, v41
  v_xor_b32 v42, s100, v42
  v_xor_b32_e64 v43, s101, v43
  buffer_store_dwordx4 v[40:43], v138, s[12:15], s84 offen offset:0 sc1
  v_xor_b32 v45, s93, v45
  v_xor_b32 v46, s100, v46
  v_xor_b32_e64 v47, s101, v47
  buffer_store_dwordx4 v[44:47], v138, s[12:15], s84 offen offset:1024 sc1
  v_xor_b32_e64 v49, s93, v49
  v_xor_b32 v50, s100, v50
  v_xor_b32 v51, s101, v51
  buffer_store_dwordx4 v[48:51], v138, s[12:15], s84 offen offset:2048 sc1
  s_waitcnt lgkmcnt(0)
  v_xor_b32 v53, s93, v53
  v_xor_b32 v54, s100, v54
  v_xor_b32 v55, s101, v55
  buffer_store_dwordx4 v[52:55], v139, s[12:15], s84 offen offset:3072 sc1
  s_barrier
  s_nop 0
  s_lshr_b32 s76, s3, 1
  s_lshl_b32 s76, s76, 15
  s_and_b32 s77, s3, 1
  s_lshl_b32 s78, s77, 13
  v_add_u32 v12, s76, v5
  v_add_u32 v13, s78, v12
  ds_read_b64_tr_b16 v[16:17], v12 offset:0
  ds_read_b64_tr_b16 v[18:19], v12 offset:512
  ds_read_b64_tr_b16 v[20:21], v12 offset:8192
  ds_read_b64_tr_b16 v[22:23], v12 offset:8704
  ds_read_b64_tr_b16 v[24:25], v13 offset:16384
  ds_read_b64_tr_b16 v[26:27], v13 offset:16896
  ds_read_b64_tr_b16 v[28:29], v12 offset:1024
  ds_read_b64_tr_b16 v[30:31], v12 offset:1536
  ds_read_b64_tr_b16 v[32:33], v12 offset:9216
  ds_read_b64_tr_b16 v[34:35], v12 offset:9728
  ds_read_b64_tr_b16 v[36:37], v13 offset:17408
  ds_read_b64_tr_b16 v[38:39], v13 offset:17920
  ds_read_b64_tr_b16 v[144:145], v12 offset:2048
  ds_read_b64_tr_b16 v[146:147], v12 offset:2560
  ds_read_b64_tr_b16 v[148:149], v12 offset:10240
  ds_read_b64_tr_b16 v[150:151], v12 offset:10752
  ds_read_b64_tr_b16 v[152:153], v13 offset:18432
  ds_read_b64_tr_b16 v[154:155], v13 offset:18944
  s_waitcnt lgkmcnt(12)
  v_mfma_f32_16x16x32_bf16 v[80:83], v[16:19], v[24:27], 0
  v_mfma_f32_16x16x32_bf16 v[84:87], v[20:23], v[24:27], 0
  ds_read_b64_tr_b16 v[68:69], v12 offset:3072
  ds_read_b64_tr_b16 v[70:71], v12 offset:3584
  ds_read_b64_tr_b16 v[72:73], v12 offset:11264
  ds_read_b64_tr_b16 v[74:75], v12 offset:11776
  ds_read_b64_tr_b16 v[76:77], v13 offset:19456
  ds_read_b64_tr_b16 v[78:79], v13 offset:19968
  s_waitcnt lgkmcnt(11)
  v_mfma_f32_16x16x32_bf16 v[80:83], v[28:31], v[36:39], v[80:83]
  v_mfma_f32_16x16x32_bf16 v[84:87], v[32:35], v[36:39], v[84:87]
  ds_read_b64_tr_b16 v[16:17], v12 offset:4096
  ds_read_b64_tr_b16 v[18:19], v12 offset:4608
  ds_read_b64_tr_b16 v[20:21], v12 offset:12288
  ds_read_b64_tr_b16 v[22:23], v12 offset:12800
  ds_read_b64_tr_b16 v[24:25], v13 offset:20480
  ds_read_b64_tr_b16 v[26:27], v13 offset:20992
  s_waitcnt lgkmcnt(11)
  v_mfma_f32_16x16x32_bf16 v[80:83], v[144:147], v[152:155], v[80:83]
  v_mfma_f32_16x16x32_bf16 v[84:87], v[148:151], v[152:155], v[84:87]
  ds_read_b64_tr_b16 v[28:29], v12 offset:5120
  ds_read_b64_tr_b16 v[30:31], v12 offset:5632
  ds_read_b64_tr_b16 v[32:33], v12 offset:13312
  ds_read_b64_tr_b16 v[34:35], v12 offset:13824
  ds_read_b64_tr_b16 v[36:37], v13 offset:21504
  ds_read_b64_tr_b16 v[38:39], v13 offset:22016
  s_waitcnt lgkmcnt(11)
  v_mfma_f32_16x16x32_bf16 v[80:83], v[68:71], v[76:79], v[80:83]
  v_mfma_f32_16x16x32_bf16 v[84:87], v[72:75], v[76:79], v[84:87]
  ds_read_b64_tr_b16 v[144:145], v12 offset:6144
  ds_read_b64_tr_b16 v[146:147], v12 offset:6656
  ds_read_b64_tr_b16 v[148:149], v12 offset:14336
  ds_read_b64_tr_b16 v[150:151], v12 offset:14848
  ds_read_b64_tr_b16 v[152:153], v13 offset:22528
  ds_read_b64_tr_b16 v[154:155], v13 offset:23040
  s_waitcnt lgkmcnt(11)
  v_mfma_f32_16x16x32_bf16 v[80:83], v[16:19], v[24:27], v[80:83]
  v_mfma_f32_16x16x32_bf16 v[84:87], v[20:23], v[24:27], v[84:87]
  ds_read_b64_tr_b16 v[68:69], v12 offset:7168
  ds_read_b64_tr_b16 v[70:71], v12 offset:7680
  ds_read_b64_tr_b16 v[72:73], v12 offset:15360
  ds_read_b64_tr_b16 v[74:75], v12 offset:15872
  ds_read_b64_tr_b16 v[76:77], v13 offset:23552
  ds_read_b64_tr_b16 v[78:79], v13 offset:24064
  s_waitcnt lgkmcnt(11)
  v_mfma_f32_16x16x32_bf16 v[80:83], v[28:31], v[36:39], v[80:83]
  v_mfma_f32_16x16x32_bf16 v[84:87], v[32:35], v[36:39], v[84:87]
  s_waitcnt lgkmcnt(6)
  v_mfma_f32_16x16x32_bf16 v[80:83], v[144:147], v[152:155], v[80:83]
  v_mfma_f32_16x16x32_bf16 v[84:87], v[148:151], v[152:155], v[84:87]
  s_waitcnt lgkmcnt(0)
  v_mfma_f32_16x16x32_bf16 v[80:83], v[68:71], v[76:79], v[80:83]
  v_mfma_f32_16x16x32_bf16 v[84:87], v[72:75], v[76:79], v[84:87]
  v_mov_b32 v122, s40
  v_lshlrev_b32 v123, 25, v65
  v_min_u32 v123, 2146435072, v123
  v_or_b32 v123, s90, v123
  s_waitcnt vmcnt(0)
  buffer_store_dword v122, v123, s[12:15], s92 offen sc1
  s_lshl_b32 s77, s77, 4
  s_and_b32 s76, s3, 2
  s_add_u32 s76, s76, 141312
  v_and_b32 v13, 15, v65
  v_lshrrev_b32 v14, 4, v65
  v_add_u32 v13, s77, v13
  v_max_u32 v15, 1, v14
  v_sub_u32 v15, 4, v15
  v_lshlrev_b32 v15, v15, v13
  v_lshlrev_b32 v16, 2, v14
  v_lshlrev_b32 v17, 7, v14
  v_cmp_gt_u32 vcc, 2, v14
  s_nop 1
  v_cndmask_b32 v16, v17, v16, vcc
  v_add_u32 v15, v15, v16
  v_lshl_add_u32 v15, v15, 2, s76
  v_cmp_eq_u32 vcc, 3, v14
  v_mov_b32 v16, 8
  v_mov_b32 v18, 0x100
  v_cndmask_b32 v16, v16, v18, vcc
  v_add_u32 v16, v16, v15
  v_add_u32 v17, v17, v13
  v_lshl_add_u32 v17, v17, 2, s76
  v_cmp_eq_u32 vcc, 63, v65
  v_cvt_pk_bf16_f32 v80, v80, v81
  v_cvt_pk_bf16_f32 v82, v82, v83
  v_cvt_pk_bf16_f32 v84, v84, v85
  v_cvt_pk_bf16_f32 v86, v86, v87
  v_cndmask_b32 v86, v86, 0, vcc
  ds_write_b16 v15, v80
  ds_write_b16_d16_hi v15, v80 offset:4
  ds_write_b16 v16, v82
  ds_write_b16_d16_hi v16, v82 offset:4
  ds_write_b16 v17, v84 offset:2048
  ds_write_b16_d16_hi v17, v84 offset:2176
  ds_write_b16 v17, v86 offset:2304
  ds_write_b16_d16_hi v17, v86 offset:2432
  v_mov_b32 v12, 0
  s_lshr_b32 s76, s3, 1
  s_and_b32 s77, s3, 1
  s_lshl_b32 s77, s77, 8
  s_mul_i32 s78, s76, 33280
  s_add_u32 s78, s78, s77
  s_add_u32 s78, s78, 65584
  s_mul_i32 s76, s76, 4608
  s_sub_u32 s76, s76, s77
  s_add_u32 s76, s76, 132384
  v_bfe_u32 v18, v3, 4, 1
  v_lshrrev_b32 v19, 5, v3
  v_lshlrev_b32 v61, 9, v19
  v_lshl_add_u32 v61, v18, 3, v61
  v_mul_u32_u24_e64 v63, 64, v19
  v_lshl_add_u32 v63, v18, 5, v63
  v_mul_u32_u24 v58, 4608, v18
  v_lshl_add_u32 v58, v19, 3, v58
  v_add_u32 v58, 132608, v58
  v_lshlrev_b32 v20, 4, v18
  v_sub_u32 v20, 16, v20
  v_lshlrev_b32_e64 v62, v20, s66
  v_and_b32 v62, s70, v62
  v_and_b32 v19, 3, v19
  v_lshrrev_b32 v20, 7, v3
  v_lshlrev_b32 v60, 14, v20
  v_lshl_add_u32 v60, v18, 5, v60
  v_lshl_add_u32 v60, v19, 3, v60
  v_lshlrev_b32 v59, 13, v18
  v_lshl_add_u32 v59, v19, 8, v59
  v_lshlrev_b32 v19, 2, v19
  v_and_b32 v18, 15, v20
  v_xor_b32 v18, v18, v19
  v_lshl_add_u32 v59, v18, 4, v59
  v_lshrrev_b32_e64 v20, 4, v20
  v_lshl_add_u32 v59, v20, 10, v59
  v_add_u32 v59, 141312, v59
  v_bfe_u32 v18, v5, 3, 3
  v_mul_u32_u24 v56, 4160, v18
  v_bfe_u32 v18, v5, 6, 1
  v_lshrrev_b32 v19, 7, v5
  v_sub_u32 v18, v18, v19
  v_lshlrev_b32 v18, 4, v18
  v_add3_u32 v56, v56, v18, s78
  v_bfe_u32 v18, v5, 3, 4
  v_lshlrev_b32 v18, 5, v18
  v_lshlrev_b32_e64 v19, 4, v19
  v_add3_u32 v57, v18, v19, s76
  s_waitcnt lgkmcnt(0)
  s_barrier
  ds_read_b32 v24, v100
  ds_read_b32 v25, v101
  ds_read_b32 v26, v102
  ds_read_b32 v27, v103
  ds_read_b32 v28, v104
  ds_read_b32 v29, v105
  ds_read_b32 v30, v106
  ds_read_b32 v31, v107
  ds_read_b32 v32, v108
  ds_read_b32 v33, v109
  ds_read_b32 v34, v110
  ds_read_b32 v35, v111
  ds_read_b32 v36, v112
  ds_read_b32 v37, v113
  ds_read_b32 v38, v114
  v_lshrrev_b32_e64 v13, 2, v65
  v_mul_u32_u24 v13, 4160, v13
  v_and_b32_e64 v14, 3, v65
  v_lshl_add_u32 v13, v14, 2, v13
  v_add_u32 v13, 65536, v13
  v_add_u32 v14, 65536, v3
  ds_write_b32 v13, v12
  s_waitcnt lgkmcnt(7)
  v_perm_b32 v40, v32, v31, s71
  s_waitcnt lgkmcnt(5)
  v_perm_b32 v41, v34, v33, s71
  s_waitcnt lgkmcnt(3)
  v_perm_b32 v42, v36, v35, s71
  s_waitcnt lgkmcnt(1)
  v_perm_b32 v43, v38, v37, s71
  ds_write_b128 v14, v[40:43] offset:16
  v_perm_b32 v44, v31, v30, s71
  v_perm_b32 v45, v33, v32, s71
  v_perm_b32 v46, v35, v34, s71
  v_perm_b32 v47, v37, v36, s71
  ds_write_b128 v14, v[44:47] offset:4176
  v_perm_b32 v48, v30, v29, s71
  v_perm_b32 v49, v32, v31, s71
  v_perm_b32 v50, v34, v33, s71
  v_perm_b32 v51, v36, v35, s71
  ds_write_b128 v14, v[48:51] offset:8336
  v_perm_b32 v52, v29, v28, s71
  v_perm_b32 v53, v31, v30, s71
  v_perm_b32 v54, v33, v32, s71
  v_perm_b32 v55, v35, v34, s71
  ds_write_b128 v14, v[52:55] offset:12496
  v_perm_b32 v100, v28, v27, s71
  v_perm_b32 v101, v30, v29, s71
  v_perm_b32 v102, v32, v31, s71
  v_perm_b32 v103, v34, v33, s71
  ds_write_b128 v14, v[100:103] offset:16656
  v_perm_b32 v104, v27, v26, s71
  v_perm_b32 v105, v29, v28, s71
  v_perm_b32 v106, v31, v30, s71
  v_perm_b32 v107, v33, v32, s71
  ds_write_b128 v14, v[104:107] offset:20816
  s_mov_b32 s76, 3014656
  buffer_load_dwordx4 v[124:127], v3, s[12:15], s76 offen sc1
  s_mov_b32 s76, 3018752
  buffer_load_dwordx4 v[128:131], v3, s[12:15], s76 offen sc1
  s_mov_b32 s76, 3022848
  buffer_load_dwordx4 v[132:135], v3, s[12:15], s76 offen sc1
  s_mov_b32 s76, 3026944
  buffer_load_dwordx4 v[136:139], v3, s[12:15], s76 offen sc1
  v_perm_b32 v108, v26, v25, s71
  v_perm_b32 v109, v28, v27, s71
  v_perm_b32 v110, v30, v29, s71
  v_perm_b32 v111, v32, v31, s71
  ds_write_b128 v14, v[108:111] offset:24976
  v_perm_b32 v112, v25, v24, s71
  v_perm_b32 v113, v27, v26, s71
  v_perm_b32 v114, v29, v28, s71
  v_perm_b32 v115, v31, v30, s71
  ds_write_b128 v14, v[112:115] offset:29136
  v_perm_b32 v40, v32, v31, s72
  v_perm_b32 v41, v34, v33, s72
  v_perm_b32 v42, v36, v35, s72
  v_perm_b32 v43, v38, v37, s72
  ds_write_b128 v14, v[40:43] offset:33296
  v_perm_b32 v44, v31, v30, s72
  v_perm_b32 v45, v33, v32, s72
  v_perm_b32 v46, v35, v34, s72
  v_perm_b32 v47, v37, v36, s72
  ds_write_b128 v14, v[44:47] offset:37456
  v_perm_b32 v48, v30, v29, s72
  v_perm_b32 v49, v32, v31, s72
  v_perm_b32 v50, v34, v33, s72
Lpad0:
  s_cbranch_execz Lpad4
  s_nop 0
  v_perm_b32 v51, v36, v35, s72
  ds_write_b128 v14, v[48:51] offset:41616
  v_perm_b32 v52, v29, v28, s72
  v_perm_b32 v53, v31, v30, s72
  v_perm_b32 v54, v33, v32, s72
  v_perm_b32 v55, v35, v34, s72
  ds_write_b128 v14, v[52:55] offset:45776
  v_perm_b32 v100, v28, v27, s72
  v_perm_b32 v101, v30, v29, s72
  v_perm_b32 v102, v32, v31, s72
  v_perm_b32 v103, v34, v33, s72
  ds_write_b128 v14, v[100:103] offset:49936
  v_perm_b32 v104, v27, v26, s72
  v_perm_b32 v105, v29, v28, s72
  v_perm_b32 v106, v31, v30, s72
  v_perm_b32 v107, v33, v32, s72
  ds_write_b128 v14, v[104:107] offset:54096
  s_lshl_b32 s42, s5, 9
  s_add_u32 s42, s42, 3035136
  s_lshl_b32 s76, s3, 6
  v_bfe_u32 v10, v5, 1, 6
  v_add_u32 v10, s76, v10
  s_waitcnt vmcnt(3)
  v_xor_b32 v22, s40, v125
  v_bitop3_b32 v22, v22, v127, s40 bitop3:0xf6
  s_waitcnt vmcnt(2)
  v_bitop3_b32 v22, v22, v129, s40 bitop3:0xf6
  v_bitop3_b32 v22, v22, v131, s40 bitop3:0xf6
  s_waitcnt vmcnt(1)
  v_bitop3_b32 v22, v22, v133, s40 bitop3:0xf6
  v_bitop3_b32 v22, v22, v135, s40 bitop3:0xf6
  s_waitcnt vmcnt(0)
  v_bitop3_b32 v22, v22, v137, s40 bitop3:0xf6
  v_bitop3_b32 v22, v22, v139, s40 bitop3:0xf6
  v_cmp_ne_u32_e64 vcc, 0, v22
  s_nop 0
  s_cbranch_vccnz Lretry4
Lback5:
  s_add_u32 s76, s7, 16777216
  buffer_load_dwordx2 v[68:69], v61, s[12:15], s76 offen sc1
  buffer_load_dword v23, v10, s[12:15], s42 offen sc1
  s_add_u32 s76, s7, 16842752
  buffer_load_dwordx2 v[70:71], v61, s[12:15], s76 offen sc1
  s_add_u32 s76, s7, 16908288
  buffer_load_dwordx2 v[72:73], v61, s[12:15], s76 offen sc1
  s_add_u32 s76, s7, 16973824
  buffer_load_dwordx2 v[74:75], v61, s[12:15], s76 offen sc1
  v_mov_b32 v76, v124
  v_mov_b32 v77, v126
  v_mov_b32 v78, v128
  v_mov_b32 v79, v130
  v_mov_b32 v80, v132
  v_mov_b32 v81, v134
  v_mov_b32 v82, v136
  v_mov_b32_e64 v83, v138
  v_perm_b32 v108, v26, v25, s72
  v_perm_b32 v109, v28, v27, s72
  v_perm_b32 v110, v30, v29, s72
  v_perm_b32 v111, v32, v31, s72
  ds_write_b128 v14, v[108:111] offset:58256
  v_perm_b32 v112, v25, v24, s72
  v_perm_b32 v113, v27, v26, s72
  v_perm_b32 v114, v29, v28, s72
  v_perm_b32 v115, v31, v30, s72
  ds_write_b128 v14, v[112:115] offset:62416
  s_waitcnt vmcnt(3)
  v_cmp_ne_u32 s[92:93], s40, v23
  s_nop 0
  s_cmp_lg_u64 s[92:93], 0
  s_cbranch_scc1 Lretry6
Lback7:
  s_add_u32 s90, s34, 0
  buffer_load_dwordx4 a[0:3], v4, s[12:15], s90 offen offset:0 sc1
  buffer_load_dwordx4 a[4:7], v4, s[12:15], s90 offen offset:1024 sc1
  buffer_load_dwordx4 a[8:11], v4, s[12:15], s90 offen offset:2048 sc1
  buffer_load_dwordx4 a[12:15], v4, s[12:15], s90 offen offset:3072 sc1
  s_add_u32 s90, s34, 4096
  buffer_load_dwordx4 a[16:19], v4, s[12:15], s90 offen offset:0 sc1
  buffer_load_dwordx4 a[20:23], v4, s[12:15], s90 offen offset:1024 sc1
  buffer_load_dwordx4 a[24:27], v4, s[12:15], s90 offen offset:2048 sc1
  buffer_load_dwordx4 a[28:31], v4, s[12:15], s90 offen offset:3072 sc1
  v_and_b32 v17, s70, v76
  v_and_b32 v19, s70, v77
  v_rcp_f32 v17, v17
  v_rcp_f32 v19, v19
  v_lshlrev_b32 v16, 16, v76
  v_lshlrev_b32 v18, 16, v77
  v_lshlrev_b32 v88, 16, v68
  v_and_b32 v89, s70, v68
  v_lshlrev_b32 v90, 16, v69
  v_and_b32 v91, s70, v69
  v_subrev_f32_dpp v12, v16, v88 quad_perm:[0,0,2,2] row_mask:0xf bank_mask:0xf
  v_subrev_f32_dpp v13, v18, v89 quad_perm:[0,0,2,2] row_mask:0xf bank_mask:0xf
  v_subrev_f32_dpp v14, v16, v90 quad_perm:[1,1,3,3] row_mask:0xf bank_mask:0xf
  v_subrev_f32_dpp v15, v18, v91 quad_perm:[1,1,3,3] row_mask:0xf bank_mask:0xf
  v_mul_f32_dpp v12, v17, v12 quad_perm:[0,0,2,2] row_mask:0xf bank_mask:0xf
  v_mul_f32_dpp v13, v19, v13 quad_perm:[0,0,2,2] row_mask:0xf bank_mask:0xf
  v_mul_f32_dpp v14, v17, v14 quad_perm:[1,1,3,3] row_mask:0xf bank_mask:0xf
  v_mul_f32_dpp v15, v19, v15 quad_perm:[1,1,3,3] row_mask:0xf bank_mask:0xf
  v_cvt_pk_bf16_f32 v68, v12, v13
  v_cvt_pk_bf16_f32 v69, v14, v15
  ds_write_b64 v58, v[68:69] offset:0
  v_fmac_f32 v88, v62, v12
  v_fmac_f32 v89, v62, v13
  v_fmac_f32 v90, v62, v14
  v_fmac_f32 v91, v62, v15
  s_waitcnt lgkmcnt(0)
  s_barrier
  ds_read_b128 v[92:95], v56 offset:0
  ds_read_b128 v[96:99], v57 offset:192
  ds_read_b128 v[116:119], v57 offset:704
  ds_read_b128 v[120:123], v56 offset:512
  ds_read_b128 v[124:127], v56 offset:64
  ds_read_b128 v[128:131], v57 offset:128
  s_waitcnt lgkmcnt(4)
  v_mfma_f32_16x16x32_bf16 v[24:27], v[92:95], v[96:99], 0
  ds_read_b128 v[132:135], v57 offset:640
  s_add_u32 s43, s69, 8388608
  buffer_store_dwordx4 v[252:255], v3, s[12:15], s43 offen sc1
  v_and_b32 v17, s70, v78
  v_and_b32 v19, s70, v79
  v_rcp_f32 v17, v17
  v_rcp_f32 v19, v19
  v_lshlrev_b32 v16, 16, v78
  v_lshlrev_b32 v18, 16, v79
  s_waitcnt vmcnt(11)
  v_lshlrev_b32 v64, 16, v70
  s_waitcnt lgkmcnt(2)
  v_mfma_f32_16x16x32_bf16 v[28:31], v[92:95], v[116:119], 0
  ds_read_b128 v[136:139], v56 offset:576
  v_and_b32_e64 v65, s70, v70
  v_lshlrev_b32 v66, 16, v71
  s_add_u32 s41, s41, 1
  v_mov_b32 v22, s41
  s_or_b32 s84, s2, s3
  v_mfma_f32_16x16x32_bf16 v[28:31], v[120:123], v[96:99], v[28:31]
  ds_read_b128 v[140:143], v56 offset:128
  s_cmp_lg_u32 s84, 0
  s_cbranch_scc1 Lnoep
  s_mov_b32 s84, 3031040
  buffer_store_dword v22, off, s[12:15], s84 sc1
Lnoep:
  v_and_b32 v67, s70, v71
  v_subrev_f32_dpp v12, v16, v64 quad_perm:[0,0,2,2] row_mask:0xf bank_mask:0xf
  s_waitcnt lgkmcnt(1)
  v_mfma_f32_16x16x32_bf16 v[24:27], v[124:127], v[128:131], v[24:27]
  ds_read_b128 v[40:43], v57 offset:64
  v_subrev_f32_dpp v13, v18, v65 quad_perm:[0,0,2,2] row_mask:0xf bank_mask:0xf
  v_subrev_f32_dpp v14, v16, v66 quad_perm:[1,1,3,3] row_mask:0xf bank_mask:0xf
  v_mfma_f32_16x16x32_bf16 v[28:31], v[124:127], v[132:135], v[28:31]
  ds_read_b128 v[44:47], v57 offset:576
  v_subrev_f32_dpp v15, v18, v67 quad_perm:[1,1,3,3] row_mask:0xf bank_mask:0xf
  v_mul_f32_dpp v12, v17, v12 quad_perm:[0,0,2,2] row_mask:0xf bank_mask:0xf
  v_mfma_f32_16x16x32_bf16 v[28:31], v[136:139], v[128:131], v[28:31]
  ds_read_b128 v[48:51], v56 offset:640
  s_add_u32 s90, s34, 8192
  buffer_load_dwordx4 a[32:35], v4, s[12:15], s90 offen offset:0 sc1
  v_mul_f32_dpp v13, v19, v13 quad_perm:[0,0,2,2] row_mask:0xf bank_mask:0xf
  v_mul_f32_dpp v14, v17, v14 quad_perm:[1,1,3,3] row_mask:0xf bank_mask:0xf
  s_waitcnt lgkmcnt(2)
  v_mfma_f32_16x16x32_bf16 v[24:27], v[140:143], v[40:43], v[24:27]
  ds_read_b128 v[52:55], v56 offset:192
  v_mul_f32_dpp v15, v19, v15 quad_perm:[1,1,3,3] row_mask:0xf bank_mask:0xf
  v_cvt_pk_bf16_f32 v70, v12, v13
  s_waitcnt lgkmcnt(2)
  v_mfma_f32_16x16x32_bf16 v[28:31], v[140:143], v[44:47], v[28:31]
  ds_read_b128 v[140:143], v57 offset:0
  v_cvt_pk_bf16_f32 v71, v14, v15
  s_waitcnt lgkmcnt(2)
  v_mfma_f32_16x16x32_bf16 v[28:31], v[48:51], v[40:43], v[28:31]
  ds_read_b128 v[124:127], v57 offset:512
  ds_write_b64 v58, v[70:71] offset:1024
  v_fmac_f32 v64, v62, v12
  s_waitcnt lgkmcnt(2)
  v_mfma_f32_16x16x32_bf16 v[24:27], v[52:55], v[140:143], v[24:27]
  ds_read_b128 v[92:95], v56 offset:704
  buffer_load_dwordx4 a[36:39], v4, s[12:15], s90 offen offset:1024 sc1
  v_fmac_f32 v65, v62, v13
  v_fmac_f32 v66, v62, v14
  s_waitcnt lgkmcnt(2)
  v_mfma_f32_16x16x32_bf16 v[28:31], v[52:55], v[124:127], v[28:31]
  ds_read_b128 v[52:55], v56 offset:1216
  v_fmac_f32 v67, v62, v15
  s_waitcnt lgkmcnt(2)
  s_barrier
  s_waitcnt lgkmcnt(1)
  v_mfma_f32_16x16x32_bf16 v[28:31], v[92:95], v[140:143], v[28:31]
  ds_read_b128 v[96:99], v56 offset:1728
  v_mfma_f32_16x16x32_bf16 v[32:35], v[92:95], v[124:127], 0
  ds_read_b128 v[92:95], v56 offset:2240
  buffer_load_dwordx4 a[40:43], v4, s[12:15], s90 offen offset:2048 sc1
  s_add_u32 s43, s69, 8392704
  buffer_store_dwordx4 v[252:255], v3, s[12:15], s43 offen sc1
  s_waitcnt lgkmcnt(2)
  v_mfma_f32_16x16x32_bf16 v[32:35], v[52:55], v[140:143], v[32:35]
  ds_read_b128 v[116:119], v56 offset:2752
  v_mfma_f32_16x16x32_bf16 v[36:39], v[52:55], v[124:127], 0
  ds_read_b128 v[52:55], v56 offset:3264
  s_waitcnt lgkmcnt(3)
  v_mfma_f32_16x16x32_bf16 v[36:39], v[96:99], v[140:143], v[36:39]
  ds_read_b128 v[120:123], v56 offset:3776
  buffer_load_dwordx4 a[44:47], v4, s[12:15], s90 offen offset:3072 sc1
  v_mfma_f32_16x16x32_bf16 v[100:103], v[96:99], v[124:127], 0
  ds_read_b128 v[96:99], v56 offset:1152
  s_waitcnt lgkmcnt(4)
  v_mfma_f32_16x16x32_bf16 v[100:103], v[92:95], v[140:143], v[100:103]
  v_mfma_f32_16x16x32_bf16 v[104:107], v[92:95], v[124:127], 0
  ds_read_b128 v[92:95], v56 offset:1664
  s_add_u32 s90, s34, 12288
  buffer_load_dwordx4 a[48:51], v4, s[12:15], s90 offen offset:0 sc1
  s_waitcnt lgkmcnt(4)
  v_mfma_f32_16x16x32_bf16 v[104:107], v[116:119], v[140:143], v[104:107]
  ds_write_b128 v2, v[24:27] offset:0
  v_mfma_f32_16x16x32_bf16 v[108:111], v[116:119], v[124:127], 0
  ds_read_b128 v[116:119], v56 offset:2176
  s_waitcnt lgkmcnt(4)
  v_mfma_f32_16x16x32_bf16 v[108:111], v[52:55], v[140:143], v[108:111]
  ds_write_b128 v2, v[28:31] offset:1024
  buffer_load_dwordx4 a[52:55], v4, s[12:15], s90 offen offset:1024 sc1
  v_mfma_f32_16x16x32_bf16 v[112:115], v[52:55], v[124:127], 0
  ds_read_b128 v[52:55], v56 offset:2688
  v_mfma_f32_16x16x32_bf16 v[112:115], v[120:123], v[140:143], v[112:115]
  v_mfma_f32_16x16x32_bf16 v[32:35], v[48:51], v[44:47], v[32:35]
  ds_read_b128 v[124:127], v56 offset:3200
  buffer_load_dwordx4 a[56:59], v4, s[12:15], s90 offen offset:2048 sc1
  v_mov_b32_e64 v248, 0
  s_waitcnt lgkmcnt(5)
  v_mfma_f32_16x16x32_bf16 v[32:35], v[96:99], v[40:43], v[32:35]
  s_waitcnt lgkmcnt(2)
  s_barrier
  v_mfma_f32_16x16x32_bf16 v[36:39], v[96:99], v[44:47], v[36:39]
  ds_read_b128 v[120:123], v56 offset:3712
  ds_read_b128 v[12:15], v59 offset:0
  ds_read_b128 v[16:19], v59 offset:4096
  v_mfma_f32_16x16x32_bf16 v[36:39], v[92:95], v[40:43], v[36:39]
  buffer_load_dwordx4 a[60:63], v4, s[12:15], s90 offen offset:3072 sc1
  v_mfma_f32_16x16x32_bf16 v[100:103], v[92:95], v[44:47], v[100:103]
  ds_read_b128 v[140:143], v56 offset:1088
  v_mfma_f32_16x16x32_bf16 v[100:103], v[116:119], v[40:43], v[100:103]
  s_waitcnt lgkmcnt(2)
  v_add_f32 v88, v88, v12
  v_lshrrev_b32_e64 v249, 9, v3
  v_mfma_f32_16x16x32_bf16 v[104:107], v[116:119], v[44:47], v[104:107]
  ds_read_b128 v[116:119], v56 offset:1600
  s_mul_i32 s90, s3, 44
  v_add_f32 v89, v89, v13
  v_lshrrev_b32_e64 v10, 1, v5
  v_mfma_f32_16x16x32_bf16 v[104:107], v[52:55], v[40:43], v[104:107]
  v_add_f32 v90, v90, v14
  v_add_f32 v91, v91, v15
  v_mfma_f32_16x16x32_bf16 v[108:111], v[52:55], v[44:47], v[108:111]
  ds_read_b128 v[52:55], v56 offset:2112
  s_waitcnt lgkmcnt(2)
  v_add_f32 v88, v88, v16
  v_min_u32 v10, 40, v10
  v_add_f32 v89, v89, v17
  v_mfma_f32_16x16x32_bf16 v[108:111], v[124:127], v[40:43], v[108:111]
  v_add_f32 v90, v90, v18
  v_add_f32 v91, v91, v19
  v_add_u32_e64 v10, s90, v10
  v_mfma_f32_16x16x32_bf16 v[112:115], v[124:127], v[44:47], v[112:115]
  ds_read_b128 v[124:127], v56 offset:2624
  v_cvt_pk_bf16_f32 v20, v88, v89
  v_cvt_pk_bf16_f32 v21, v90, v91
  v_lshlrev_b32 v249, 25, v249
  v_mfma_f32_16x16x32_bf16 v[112:115], v[120:123], v[40:43], v[112:115]
  buffer_load_dword v23, v10, s[12:15], s42 offen offset:256 sc1
  v_min_u32 v20, -2, v20
  v_mfma_f32_16x16x32_bf16 v[32:35], v[136:139], v[132:135], v[32:35]
  ds_read_b128 v[44:47], v56 offset:3136
  s_add_u32 s76, s32, 4194304
  buffer_store_dwordx2 v[20:21], v60, s[12:15], s76 offen sc1
  v_mfma_f32_16x16x32_bf16 v[32:35], v[140:143], v[128:131], v[32:35]
  v_mfma_f32_16x16x32_bf16 v[36:39], v[140:143], v[132:135], v[36:39]
  ds_read_b128 v[120:123], v56 offset:3648
  s_add_u32 s90, s34, 16384
  buffer_load_dwordx4 a[64:67], v4, s[12:15], s90 offen offset:0 sc1
  s_waitcnt lgkmcnt(2)
  v_mfma_f32_16x16x32_bf16 v[36:39], v[116:119], v[128:131], v[36:39]
  ds_read_b128 v[40:43], v56 offset:512
  v_bfe_u32 v250, v3, 2, 6
  v_mfma_f32_16x16x32_bf16 v[100:103], v[116:119], v[132:135], v[100:103]
  ds_read_b128 v[116:119], v57 offset:704
  v_mfma_f32_16x16x32_bf16 v[100:103], v[52:55], v[128:131], v[100:103]
  ds_read_b128 v[140:143], v56 offset:1024
  buffer_load_dwordx4 a[68:71], v4, s[12:15], s90 offen offset:1024 sc1
  v_and_b32 v17, s70, v80
  v_mfma_f32_16x16x32_bf16 v[104:107], v[52:55], v[132:135], v[104:107]
  ds_read_b128 v[52:55], v57 offset:192
  v_and_b32 v19, s70, v81
  v_mfma_f32_16x16x32_bf16 v[104:107], v[124:127], v[128:131], v[104:107]
  ds_read_b128 v[92:95], v56 offset:1536
  v_rcp_f32 v17, v17
  v_mfma_f32_16x16x32_bf16 v[108:111], v[124:127], v[132:135], v[108:111]
  ds_read_b128 v[124:127], v56 offset:2048
  buffer_load_dwordx4 a[72:75], v4, s[12:15], s90 offen offset:2048 sc1
  v_add_u32 v249, v249, v250
  s_waitcnt lgkmcnt(4)
  v_mfma_f32_16x16x32_bf16 v[108:111], v[44:47], v[128:131], v[108:111]
  v_rcp_f32_e64 v19, v19
  v_mfma_f32_16x16x32_bf16 v[112:115], v[44:47], v[132:135], v[112:115]
  ds_read_b128 v[44:47], v56 offset:2560
  v_mfma_f32_16x16x32_bf16 v[112:115], v[120:123], v[128:131], v[112:115]
  buffer_load_dwordx4 a[76:79], v4, s[12:15], s90 offen offset:3072 sc1
  v_lshlrev_b32 v16, 16, v80
  v_lshlrev_b32 v18, 16, v81
  v_mfma_f32_16x16x32_bf16 v[32:35], v[40:43], v[116:119], v[32:35]
  ds_read_b128 v[132:135], v56 offset:3072
  s_waitcnt vmcnt(25)
  v_lshlrev_b32 v88, 16, v72
  s_waitcnt lgkmcnt(2)
  v_mfma_f32_16x16x32_bf16 v[32:35], v[140:143], v[52:55], v[32:35]
  v_and_b32 v89, s70, v72
  v_bfe_u32 v250, v3, 8, 1
  v_mfma_f32_16x16x32_bf16 v[36:39], v[140:143], v[116:119], v[36:39]
  ds_read_b128 v[120:123], v56 offset:3584
  s_add_u32 s90, s34, 20480
  buffer_load_dwordx4 a[80:83], v4, s[12:15], s90 offen offset:0 sc1
  v_lshlrev_b32_e64 v90, 16, v73
  v_mfma_f32_16x16x32_bf16 v[36:39], v[92:95], v[52:55], v[36:39]
  ds_read_b128 v[128:131], v56 offset:0
  v_and_b32_e64 v91, s70, v73
  v_mfma_f32_16x16x32_bf16 v[100:103], v[92:95], v[116:119], v[100:103]
  v_subrev_f32_dpp v12, v16, v88 quad_perm:[0,0,2,2] row_mask:0xf bank_mask:0xf
  ds_read_b128 v[92:95], v57 offset:1216
  v_mfma_f32_16x16x32_bf16 v[100:103], v[124:127], v[52:55], v[100:103]
  ds_read_b128 v[140:143], v57 offset:1728
  buffer_load_dwordx4 a[84:87], v4, s[12:15], s90 offen offset:1024 sc1
  v_subrev_f32_dpp v13, v18, v89 quad_perm:[0,0,2,2] row_mask:0xf bank_mask:0xf
  v_subrev_f32_dpp v14, v16, v90 quad_perm:[1,1,3,3] row_mask:0xf bank_mask:0xf
  v_mfma_f32_16x16x32_bf16 v[104:107], v[124:127], v[116:119], v[104:107]
  ds_read_b128 v[124:127], v56 offset:64
  v_subrev_f32_dpp v15, v18, v91 quad_perm:[1,1,3,3] row_mask:0xf bank_mask:0xf
  v_mul_u32_u24 v250, 64, v250
  s_waitcnt lgkmcnt(4)
  v_mfma_f32_16x16x32_bf16 v[104:107], v[44:47], v[52:55], v[104:107]
  ds_read_b128 v[96:99], v57 offset:1152
  v_mul_f32_dpp v12, v17, v12 quad_perm:[0,0,2,2] row_mask:0xf bank_mask:0xf
  v_mfma_f32_16x16x32_bf16 v[108:111], v[44:47], v[116:119], v[108:111]
  ds_read_b128 v[44:47], v57 offset:1664
  buffer_load_dwordx4 a[88:91], v4, s[12:15], s90 offen offset:2048 sc1
  v_mul_f32_dpp v13, v19, v13 quad_perm:[0,0,2,2] row_mask:0xf bank_mask:0xf
  v_mfma_f32_16x16x32_bf16 v[108:111], v[132:135], v[52:55], v[108:111]
  ds_read_b128 v[48:51], v56 offset:128
  v_mul_f32_dpp v14, v17, v14 quad_perm:[1,1,3,3] row_mask:0xf bank_mask:0xf
  v_mfma_f32_16x16x32_bf16 v[112:115], v[132:135], v[116:119], v[112:115]
  ds_read_b128 v[132:135], v57 offset:1088
  v_mul_f32_dpp v15, v19, v15 quad_perm:[1,1,3,3] row_mask:0xf bank_mask:0xf
  v_mfma_f32_16x16x32_bf16 v[112:115], v[120:123], v[52:55], v[112:115]
  ds_read_b128 v[116:119], v57 offset:1600
  buffer_load_dwordx4 a[92:95], v4, s[12:15], s90 offen offset:3072 sc1
  v_cvt_pk_bf16_f32 v72, v12, v13
  v_cvt_pk_bf16_f32 v73, v14, v15
  v_add_u32 v249, v249, v250
  s_waitcnt lgkmcnt(3)
  v_mfma_f32_16x16x32_bf16 v[32:35], v[128:131], v[92:95], v[32:35]
  ds_read_b128 v[120:123], v56 offset:640
  ds_write_b64 v58, v[72:73] offset:2048
  v_mfma_f32_16x16x32_bf16 v[36:39], v[128:131], v[140:143], v[36:39]
  ds_read_b128 v[52:55], v56 offset:192
  v_mfma_f32_16x16x32_bf16 v[36:39], v[40:43], v[92:95], v[36:39]
  ds_read_b128 v[128:131], v57 offset:1024
  s_add_u32 s90, s34, 24576
  buffer_load_dwordx4 a[96:99], v4, s[12:15], s90 offen offset:0 sc1
  v_fmac_f32_e64 v88, v62, v12
  v_mfma_f32_16x16x32_bf16 v[32:35], v[124:127], v[96:99], v[32:35]
  ds_read_b128 v[92:95], v57 offset:1536
  v_fmac_f32_e64 v89, v62, v13
  v_mfma_f32_16x16x32_bf16 v[36:39], v[124:127], v[44:47], v[36:39]
  ds_read_b128 v[124:127], v56 offset:704
  v_fmac_f32_e64 v90, v62, v14
  s_mul_i32 s43, s2, 128
  v_mfma_f32_16x16x32_bf16 v[36:39], v[136:139], v[96:99], v[36:39]
  ds_read_b128 v[40:43], v56 offset:1216
  buffer_load_dwordx4 a[100:103], v4, s[12:15], s90 offen offset:1024 sc1
  v_fmac_f32 v91, v62, v15
  s_waitcnt lgkmcnt(5)
  s_barrier
  v_mfma_f32_16x16x32_bf16 v[32:35], v[48:51], v[132:135], v[32:35]
  ds_read_b128 v[140:143], v56 offset:1728
  v_mfma_f32_16x16x32_bf16 v[36:39], v[48:51], v[116:119], v[36:39]
  s_add_u32 s43, s43, 3080192
  v_mfma_f32_16x16x32_bf16 v[36:39], v[120:123], v[132:135], v[36:39]
  ds_read_b128 v[48:51], v56 offset:2240
  buffer_load_dwordx4 a[104:107], v4, s[12:15], s90 offen offset:2048 sc1
  s_waitcnt lgkmcnt(3)
  v_mfma_f32_16x16x32_bf16 v[32:35], v[52:55], v[128:131], v[32:35]
  buffer_store_dword v248, v249, s[12:15], s43 offen sc1
  v_mfma_f32_16x16x32_bf16 v[36:39], v[52:55], v[92:95], v[36:39]
  ds_read_b128 v[52:55], v56 offset:2752
  v_mfma_f32_16x16x32_bf16 v[36:39], v[124:127], v[128:131], v[36:39]
  buffer_load_dwordx4 a[108:111], v4, s[12:15], s90 offen offset:3072 sc1
  v_mfma_f32_16x16x32_bf16 v[100:103], v[124:127], v[92:95], v[100:103]
  ds_read_b128 v[124:127], v56 offset:1152
  s_waitcnt lgkmcnt(3)
  v_mfma_f32_16x16x32_bf16 v[100:103], v[40:43], v[128:131], v[100:103]
  ds_write_b128 v2, v[32:35] offset:2048
  v_mfma_f32_16x16x32_bf16 v[104:107], v[40:43], v[92:95], v[104:107]
  ds_read_b128 v[40:43], v56 offset:1664
  s_add_u32 s90, s34, 28672
  buffer_load_dwordx4 a[112:115], v4, s[12:15], s90 offen offset:0 sc1
  v_mfma_f32_16x16x32_bf16 v[104:107], v[140:143], v[128:131], v[104:107]
  ds_write_b128 v2, v[36:39] offset:3072
  v_mfma_f32_16x16x32_bf16 v[108:111], v[140:143], v[92:95], v[108:111]
  ds_read_b128 v[140:143], v56 offset:2176
  s_waitcnt lgkmcnt(5)
  v_mfma_f32_16x16x32_bf16 v[108:111], v[48:51], v[128:131], v[108:111]
  v_mfma_f32_16x16x32_bf16 v[112:115], v[48:51], v[92:95], v[112:115]
  ds_read_b128 v[48:51], v56 offset:2688
  buffer_load_dwordx4 a[116:119], v4, s[12:15], s90 offen offset:1024 sc1
  v_mfma_f32_16x16x32_bf16 v[112:115], v[52:55], v[128:131], v[112:115]
  s_waitcnt lgkmcnt(2)
  s_barrier
  v_mfma_f32_16x16x32_bf16 v[100:103], v[120:123], v[116:119], v[100:103]
  ds_read_b128 v[92:95], v56 offset:1088
  ds_read_b128 v[12:15], v59 offset:2048
  ds_read_b128 v[16:19], v59 offset:6144
  buffer_load_dwordx4 a[120:123], v4, s[12:15], s90 offen offset:2048 sc1
  v_mfma_f32_16x16x32_bf16 v[100:103], v[124:127], v[132:135], v[100:103]
  v_mfma_f32_16x16x32_bf16 v[104:107], v[124:127], v[116:119], v[104:107]
  ds_read_b128 v[52:55], v56 offset:1600
  v_mfma_f32_16x16x32_bf16 v[104:107], v[40:43], v[132:135], v[104:107]
  buffer_load_dwordx4 a[124:127], v4, s[12:15], s90 offen offset:3072 sc1
  s_waitcnt lgkmcnt(2)
  v_add_f32 v64, v64, v12
  v_mfma_f32_16x16x32_bf16 v[108:111], v[40:43], v[116:119], v[108:111]
  ds_read_b128 v[128:131], v56 offset:2112
  v_add_f32_e64 v65, v65, v13
  v_mfma_f32_16x16x32_bf16 v[108:111], v[140:143], v[132:135], v[108:111]
  v_add_f32_e64 v66, v66, v14
  v_add_f32_e64 v67, v67, v15
  v_mfma_f32_16x16x32_bf16 v[112:115], v[140:143], v[116:119], v[112:115]
  ds_read_b128 v[140:143], v56 offset:2624
  s_add_u32 s90, s34, 32768
  buffer_load_dwordx4 a[128:131], v4, s[12:15], s90 offen offset:0 sc1
  s_waitcnt lgkmcnt(2)
  v_add_f32 v64, v64, v16
  v_add_f32_e64 v65, v65, v17
  v_mfma_f32_16x16x32_bf16 v[112:115], v[48:51], v[132:135], v[112:115]
  ds_read_b128 v[116:119], v56 offset:512
  v_add_f32_e64 v66, v66, v18
  v_add_f32_e64 v67, v67, v19
  v_mfma_f32_16x16x32_bf16 v[100:103], v[136:139], v[44:47], v[100:103]
  ds_read_b128 v[48:51], v57 offset:1728
  v_cvt_pk_bf16_f32 v20, v64, v65
  v_cvt_pk_bf16_f32 v21, v66, v67
  v_mfma_f32_16x16x32_bf16 v[100:103], v[92:95], v[96:99], v[100:103]
  ds_read_b128 v[132:135], v56 offset:1024
  v_min_u32_e64 v20, -2, v20
  v_mfma_f32_16x16x32_bf16 v[104:107], v[92:95], v[44:47], v[104:107]
  ds_read_b128 v[92:95], v57 offset:1216
  s_add_u32 s76, s32, 4718592
  buffer_store_dwordx2 v[20:21], v60, s[12:15], s76 offen sc1
  buffer_load_dwordx4 a[132:135], v4, s[12:15], s90 offen offset:1024 sc1
  v_mfma_f32_16x16x32_bf16 v[104:107], v[52:55], v[96:99], v[104:107]
  ds_read_b128 v[40:43], v56 offset:1536
  v_mfma_f32_16x16x32_bf16 v[108:111], v[52:55], v[44:47], v[108:111]
  ds_read_b128 v[52:55], v56 offset:2048
  s_waitcnt lgkmcnt(4)
  v_mfma_f32_16x16x32_bf16 v[108:111], v[128:131], v[96:99], v[108:111]
  buffer_load_dwordx4 a[136:139], v4, s[12:15], s90 offen offset:2048 sc1
  v_and_b32 v17, s70, v82
  v_mfma_f32_16x16x32_bf16 v[112:115], v[128:131], v[44:47], v[112:115]
  ds_read_b128 v[128:131], v56 offset:2560
  v_and_b32_e64 v19, s70, v83
  v_mfma_f32_16x16x32_bf16 v[112:115], v[140:143], v[96:99], v[112:115]
  ds_read_b128 v[44:47], v56 offset:0
  buffer_load_dwordx4 a[140:143], v4, s[12:15], s90 offen offset:3072 sc1
  v_rcp_f32 v17, v17
  v_mfma_f32_16x16x32_bf16 v[100:103], v[116:119], v[48:51], v[100:103]
  ds_read_b128 v[140:143], v57 offset:2240
  s_waitcnt lgkmcnt(4)
  v_mfma_f32_16x16x32_bf16 v[100:103], v[132:135], v[92:95], v[100:103]
  ds_read_b128 v[96:99], v57 offset:2752
  v_rcp_f32_e64 v19, v19
  v_mfma_f32_16x16x32_bf16 v[104:107], v[132:135], v[48:51], v[104:107]
  ds_read_b128 v[132:135], v56 offset:64
  s_add_u32 s90, s34, 36864
  buffer_load_dwordx4 a[144:147], v4, s[12:15], s90 offen offset:0 sc1
  v_mfma_f32_16x16x32_bf16 v[104:107], v[40:43], v[92:95], v[104:107]
  ds_read_b128 v[124:127], v57 offset:2176
  v_lshlrev_b32_e64 v16, 16, v82
  v_mfma_f32_16x16x32_bf16 v[108:111], v[40:43], v[48:51], v[108:111]
  ds_read_b128 v[40:43], v57 offset:2688
  v_lshlrev_b32_e64 v18, 16, v83
  s_waitcnt lgkmcnt(4)
  v_mfma_f32_16x16x32_bf16 v[108:111], v[52:55], v[92:95], v[108:111]
  ds_read_b128 v[120:123], v56 offset:128
  s_waitcnt vmcnt(43)
  v_lshlrev_b32_e64 v64, 16, v74
  v_mfma_f32_16x16x32_bf16 v[112:115], v[52:55], v[48:51], v[112:115]
  ds_read_b128 v[52:55], v57 offset:2112
  buffer_load_dwordx4 a[148:151], v4, s[12:15], s90 offen offset:1024 sc1
  v_and_b32_e64 v65, s70, v74
  v_lshlrev_b32_e64 v66, 16, v75
  v_mfma_f32_16x16x32_bf16 v[112:115], v[128:131], v[92:95], v[112:115]
  ds_read_b128 v[48:51], v57 offset:2624
  v_and_b32 v67, s70, v75
  v_mfma_f32_16x16x32_bf16 v[100:103], v[44:47], v[140:143], v[100:103]
  ds_read_b128 v[128:131], v56 offset:640
  v_subrev_f32_dpp v12, v16, v64 quad_perm:[0,0,2,2] row_mask:0xf bank_mask:0xf
  s_waitcnt lgkmcnt(4)
  v_mfma_f32_16x16x32_bf16 v[104:107], v[44:47], v[96:99], v[104:107]
  ds_read_b128 v[92:95], v56 offset:192
  buffer_load_dwordx4 a[152:155], v4, s[12:15], s90 offen offset:2048 sc1
  v_subrev_f32_dpp v13, v18, v65 quad_perm:[0,0,2,2] row_mask:0xf bank_mask:0xf
  v_mfma_f32_16x16x32_bf16 v[104:107], v[116:119], v[140:143], v[104:107]
  ds_read_b128 v[44:47], v57 offset:2048
  v_subrev_f32_dpp v14, v16, v66 quad_perm:[1,1,3,3] row_mask:0xf bank_mask:0xf
  v_mfma_f32_16x16x32_bf16 v[100:103], v[132:135], v[124:127], v[100:103]
  ds_read_b128 v[140:143], v57 offset:2560
  v_subrev_f32_dpp v15, v18, v67 quad_perm:[1,1,3,3] row_mask:0xf bank_mask:0xf
  v_mfma_f32_16x16x32_bf16 v[104:107], v[132:135], v[40:43], v[104:107]
  ds_read_b128 v[132:135], v56 offset:704
  buffer_load_dwordx4 a[156:159], v4, s[12:15], s90 offen offset:3072 sc1
  v_mul_f32_dpp v12, v17, v12 quad_perm:[0,0,2,2] row_mask:0xf bank_mask:0xf
  v_mfma_f32_16x16x32_bf16 v[104:107], v[136:139], v[124:127], v[104:107]
  ds_read_b128 v[116:119], v56 offset:1216
  v_mul_f32_dpp v13, v19, v13 quad_perm:[0,0,2,2] row_mask:0xf bank_mask:0xf
  s_waitcnt lgkmcnt(4)
  v_mfma_f32_16x16x32_bf16 v[100:103], v[120:123], v[52:55], v[100:103]
  ds_read_b128 v[96:99], v56 offset:1728
  v_mul_f32_dpp v14, v17, v14 quad_perm:[1,1,3,3] row_mask:0xf bank_mask:0xf
  v_mul_f32_dpp v15, v19, v15 quad_perm:[1,1,3,3] row_mask:0xf bank_mask:0xf
  s_waitcnt vmcnt(27)
  v_cmp_ne_u32 s[92:93], s40, v23
  v_mfma_f32_16x16x32_bf16 v[104:107], v[120:123], v[48:51], v[104:107]
  s_add_u32 s84, s33, 4194304
  buffer_load_dwordx4 v[24:27], v3, s[12:15], s84 offen sc1
  v_cvt_pk_bf16_f32 v74, v12, v13
  v_mfma_f32_16x16x32_bf16 v[104:107], v[128:131], v[52:55], v[104:107]
  ds_read_b128 v[120:123], v56 offset:1152
  s_cmp_lg_u64 s[92:93], 0
  s_cbranch_scc1 Lretry8
Lback9:
  v_cvt_pk_bf16_f32 v75, v14, v15
  s_waitcnt lgkmcnt(1)
  v_mfma_f32_16x16x32_bf16 v[100:103], v[92:95], v[44:47], v[100:103]
  ds_write_b64 v58, v[74:75] offset:3072
  v_mfma_f32_16x16x32_bf16 v[104:107], v[92:95], v[140:143], v[104:107]
  ds_read_b128 v[92:95], v56 offset:1664
  s_add_u32 s90, s34, 40960
  buffer_load_dwordx4 a[160:163], v4, s[12:15], s90 offen offset:0 sc1
  v_mfma_f32_16x16x32_bf16 v[104:107], v[132:135], v[44:47], v[104:107]
  s_add_u32 s84, s33, 4198400
  buffer_load_dwordx4 v[28:31], v3, s[12:15], s84 offen sc1
  v_fmac_f32 v64, v62, v12
  v_mfma_f32_16x16x32_bf16 v[108:111], v[132:135], v[140:143], v[108:111]
  ds_read_b128 v[132:135], v56 offset:1088
  v_fmac_f32_e64 v65, v62, v13
  v_mfma_f32_16x16x32_bf16 v[108:111], v[116:119], v[44:47], v[108:111]
  v_fmac_f32_e64 v66, v62, v14
  v_mfma_f32_16x16x32_bf16 v[112:115], v[116:119], v[140:143], v[112:115]
  ds_read_b128 v[116:119], v56 offset:1600
  buffer_load_dwordx4 a[164:167], v4, s[12:15], s90 offen offset:1024 sc1
  v_fmac_f32_e64 v67, v62, v15
  s_waitcnt lgkmcnt(3)
  s_barrier
  ds_write_b128 v2, v[100:103] offset:0
  v_mfma_f32_16x16x32_bf16 v[112:115], v[96:99], v[44:47], v[112:115]
  ds_read_b128 v[140:143], v56 offset:512
  s_add_u32 s84, s33, 4202496
  buffer_load_dwordx4 v[32:35], v3, s[12:15], s84 offen sc1
  v_mfma_f32_16x16x32_bf16 v[108:111], v[128:131], v[48:51], v[108:111]
  ds_read_b128 v[96:99], v57 offset:2752
  ds_write_b128 v2, v[104:107] offset:1024
  buffer_load_dwordx4 a[168:171], v4, s[12:15], s90 offen offset:2048 sc1
  v_mfma_f32_16x16x32_bf16 v[108:111], v[120:123], v[52:55], v[108:111]
  ds_read_b128 v[44:47], v56 offset:1024
  v_mfma_f32_16x16x32_bf16 v[112:115], v[120:123], v[48:51], v[112:115]
  ds_read_b128 v[120:123], v57 offset:2240
  s_waitcnt lgkmcnt(6)
  v_mfma_f32_16x16x32_bf16 v[112:115], v[92:95], v[52:55], v[112:115]
  ds_read_b128 v[48:51], v56 offset:1536
  s_add_u32 s84, s33, 4206592
  buffer_load_dwordx4 v[36:39], v3, s[12:15], s84 offen sc1
  buffer_load_dwordx4 a[172:175], v4, s[12:15], s90 offen offset:3072 sc1
  v_mfma_f32_16x16x32_bf16 v[108:111], v[136:139], v[40:43], v[108:111]
  ds_read_b128 v[92:95], v56 offset:0
  s_waitcnt vmcnt(22)
  v_mfma_f32_16x16x32_bf16 v[108:111], v[132:135], v[124:127], v[108:111]
  s_waitcnt lgkmcnt(4)
  s_barrier
  ds_read_b128 v[12:15], v59 offset:0
Lpad1:
  s_cbranch_execz Lpad5
  s_nop 0
  ds_read_b128 v[52:55], v57 offset:3264
  v_mfma_f32_16x16x32_bf16 v[112:115], v[132:135], v[40:43], v[112:115]
  ds_read_b128 v[132:135], v57 offset:3776
  ds_read_b128 v[16:19], v59 offset:4096
  s_add_u32 s90, s34, 45056
  buffer_load_dwordx4 a[176:179], v4, s[12:15], s90 offen offset:0 sc1
  v_mfma_f32_16x16x32_bf16 v[112:115], v[116:119], v[124:127], v[112:115]
  ds_read_b128 v[40:43], v56 offset:64
  v_mfma_f32_16x16x32_bf16 v[108:111], v[140:143], v[96:99], v[108:111]
  ds_read_b128 v[116:119], v57 offset:3200
  s_waitcnt lgkmcnt(6)
  v_mfma_f32_16x16x32_bf16 v[108:111], v[44:47], v[120:123], v[108:111]
  ds_read_b128 v[124:127], v57 offset:3712
  v_mfma_f32_16x16x32_bf16 v[112:115], v[44:47], v[96:99], v[112:115]
  ds_read_b128 v[44:47], v56 offset:128
  buffer_load_dwordx4 a[180:183], v4, s[12:15], s90 offen offset:1024 sc1
  s_waitcnt lgkmcnt(6)
  v_add_f32_e64 v88, v88, v12
  v_mfma_f32_16x16x32_bf16 v[112:115], v[48:51], v[120:123], v[112:115]
  ds_read_b128 v[96:99], v57 offset:3136
  v_add_f32 v89, v89, v13
  v_add_f32 v90, v90, v14
  v_mfma_f32_16x16x32_bf16 v[108:111], v[92:95], v[52:55], v[108:111]
  ds_read_b128 v[48:51], v57 offset:3648
  v_add_f32 v91, v91, v15
  s_waitcnt lgkmcnt(4)
  v_mfma_f32_16x16x32_bf16 v[112:115], v[92:95], v[132:135], v[112:115]
  ds_read_b128 v[120:123], v56 offset:192
  buffer_load_dwordx4 a[184:187], v4, s[12:15], s90 offen offset:2048 sc1
  v_add_f32 v88, v88, v16
  v_add_f32 v89, v89, v17
  v_mfma_f32_16x16x32_bf16 v[112:115], v[140:143], v[52:55], v[112:115]
  ds_read_b128 v[92:95], v57 offset:3072
  v_add_f32_e64 v90, v90, v18
  v_mfma_f32_16x16x32_bf16 v[108:111], v[40:43], v[116:119], v[108:111]
  ds_read_b128 v[132:135], v57 offset:3584
  buffer_load_dwordx4 a[188:191], v4, s[12:15], s90 offen offset:3072 sc1
  v_add_f32 v91, v91, v19
  v_cvt_pk_bf16_f32 v20, v88, v89
  s_waitcnt lgkmcnt(3)
  v_mfma_f32_16x16x32_bf16 v[112:115], v[40:43], v[124:127], v[112:115]
  ds_read_b128 v[140:143], v56 offset:704
  v_cvt_pk_bf16_f32 v21, v90, v91
  v_mfma_f32_16x16x32_bf16 v[112:115], v[136:139], v[116:119], v[112:115]
  v_min_u32 v20, -2, v20
  v_mfma_f32_16x16x32_bf16 v[108:111], v[44:47], v[96:99], v[108:111]
  s_add_u32 s76, s32, 5242880
  buffer_store_dwordx2 v[20:21], v60, s[12:15], s76 offen sc1
  v_mfma_f32_16x16x32_bf16 v[112:115], v[44:47], v[48:51], v[112:115]
  v_mfma_f32_16x16x32_bf16 v[112:115], v[128:131], v[96:99], v[112:115]
  s_waitcnt lgkmcnt(1)
  v_mfma_f32_16x16x32_bf16 v[108:111], v[120:123], v[92:95], v[108:111]
  v_mfma_f32_16x16x32_bf16 v[112:115], v[120:123], v[132:135], v[112:115]
  s_waitcnt lgkmcnt(0)
  v_mfma_f32_16x16x32_bf16 v[112:115], v[140:143], v[92:95], v[112:115]
  s_nop 4
  ds_write_b128 v2, v[108:111] offset:2048
  v_mov_b32 v92, 0x3f803f80
  v_mov_b32 v93, 0x3f803f80
  v_mov_b32 v94, 0x3f803f80
  v_mov_b32 v95, 0x3f803f80
  s_nop 1
  v_mfma_f32_16x16x32_bf16 v[132:135], a[0:3], v[92:95], 0
  ds_write_b128 v2, v[112:115] offset:3072
  v_mfma_f32_16x16x32_bf16 v[136:139], a[4:7], v[92:95], 0
  v_mfma_f32_16x16x32_bf16 v[140:143], a[8:11], v[92:95], 0
  v_mfma_f32_16x16x32_bf16 v[132:135], a[12:15], v[92:95], v[132:135]
  s_add_u32 s90, s35, 0
  buffer_load_dwordx4 a[192:195], v4, s[12:15], s90 offen offset:0 sc1
  v_mfma_f32_16x16x32_bf16 v[136:139], a[16:19], v[92:95], v[136:139]
  v_mfma_f32_16x16x32_bf16 v[140:143], a[20:23], v[92:95], v[140:143]
  s_waitcnt lgkmcnt(0)
  s_barrier
  ds_read_b128 v[12:15], v59 offset:2048
  v_mfma_f32_16x16x32_bf16 v[132:135], a[24:27], v[92:95], v[132:135]
  ds_read_b128 v[16:19], v59 offset:6144
  v_mfma_f32_16x16x32_bf16 v[136:139], a[28:31], v[92:95], v[136:139]
  v_mfma_f32_16x16x32_bf16 v[140:143], a[32:35], v[92:95], v[140:143]
  buffer_load_dwordx4 a[196:199], v4, s[12:15], s90 offen offset:1024 sc1
  v_mfma_f32_16x16x32_bf16 v[132:135], a[36:39], v[92:95], v[132:135]
  v_mfma_f32_16x16x32_bf16 v[136:139], a[40:43], v[92:95], v[136:139]
  s_waitcnt lgkmcnt(1)
  v_add_f32 v64, v64, v12
  v_add_f32 v65, v65, v13
  v_mfma_f32_16x16x32_bf16 v[140:143], a[44:47], v[92:95], v[140:143]
  v_add_f32 v66, v66, v14
  v_mfma_f32_16x16x32_bf16 v[132:135], a[48:51], v[92:95], v[132:135]
  buffer_load_dwordx4 a[200:203], v4, s[12:15], s90 offen offset:2048 sc1
  v_add_f32 v67, v67, v15
  s_waitcnt lgkmcnt(0)
  v_add_f32 v64, v64, v16
  v_mfma_f32_16x16x32_bf16 v[136:139], a[52:55], v[92:95], v[136:139]
  v_add_f32 v65, v65, v17
  v_add_f32 v66, v66, v18
  v_mfma_f32_16x16x32_bf16 v[140:143], a[56:59], v[92:95], v[140:143]
  v_add_f32 v67, v67, v19
  v_mfma_f32_16x16x32_bf16 v[132:135], a[60:63], v[92:95], v[132:135]
  buffer_load_dwordx4 a[204:207], v4, s[12:15], s90 offen offset:3072 sc1
  v_cvt_pk_bf16_f32 v20, v64, v65
  v_cvt_pk_bf16_f32 v21, v66, v67
  v_mfma_f32_16x16x32_bf16 v[136:139], a[64:67], v[92:95], v[136:139]
  v_min_u32 v20, -2, v20
  v_mfma_f32_16x16x32_bf16 v[140:143], a[68:71], v[92:95], v[140:143]
  s_add_u32 s76, s32, 5767168
  buffer_store_dwordx2 v[20:21], v60, s[12:15], s76 offen sc1
  v_mfma_f32_16x16x32_bf16 v[132:135], a[72:75], v[92:95], v[132:135]
  v_mfma_f32_16x16x32_bf16 v[136:139], a[76:79], v[92:95], v[136:139]
  s_add_u32 s90, s35, 4096
  buffer_load_dwordx4 a[208:211], v4, s[12:15], s90 offen offset:0 sc1
  v_mfma_f32_16x16x32_bf16 v[140:143], a[80:83], v[92:95], v[140:143]
  v_mfma_f32_16x16x32_bf16 v[132:135], a[84:87], v[92:95], v[132:135]
  v_mfma_f32_16x16x32_bf16 v[136:139], a[88:91], v[92:95], v[136:139]
  v_mfma_f32_16x16x32_bf16 v[140:143], a[92:95], v[92:95], v[140:143]
  buffer_load_dwordx4 a[212:215], v4, s[12:15], s90 offen offset:1024 sc1
  v_mfma_f32_16x16x32_bf16 v[132:135], a[96:99], v[92:95], v[132:135]
  s_waitcnt vmcnt(17)
  v_max3_u32 v22, v24, v26, v28
  v_mfma_f32_16x16x32_bf16 v[136:139], a[100:103], v[92:95], v[136:139]
  s_add_u32 s84, s33, 4718592
  buffer_load_dwordx4 v[68:71], v3, s[12:15], s84 offen sc1
  s_waitcnt vmcnt(16)
  v_max3_u32 v22, v22, v30, v32
  v_mfma_f32_16x16x32_bf16 v[140:143], a[104:107], v[92:95], v[140:143]
  s_waitcnt vmcnt(14)
  v_max3_u32 v22, v22, v34, v36
  v_mfma_f32_16x16x32_bf16 v[132:135], a[108:111], v[92:95], v[132:135]
  s_add_u32 s84, s33, 4722688
  buffer_load_dwordx4 v[72:75], v3, s[12:15], s84 offen sc1
  buffer_load_dwordx4 a[216:219], v4, s[12:15], s90 offen offset:2048 sc1
  v_max_u32_e64 v22, v22, v38
  v_mfma_f32_16x16x32_bf16 v[136:139], a[112:115], v[92:95], v[136:139]
  s_add_u32 s84, s33, 4726784
  buffer_load_dwordx4 v[76:79], v3, s[12:15], s84 offen sc1
  v_cmp_eq_u32 vcc, -1, v22
  v_mfma_f32_16x16x32_bf16 v[140:143], a[116:119], v[92:95], v[140:143]
  s_add_u32 s84, s33, 4730880
  buffer_load_dwordx4 v[80:83], v3, s[12:15], s84 offen sc1
  s_cbranch_vccnz Lretry18
Lback19:
  v_mfma_f32_16x16x32_bf16 v[132:135], a[120:123], v[92:95], v[132:135]
  ds_write_b128 v3, v[24:27] offset:0
  v_mfma_f32_16x16x32_bf16 v[136:139], a[124:127], v[92:95], v[136:139]
  buffer_load_dwordx4 a[220:223], v4, s[12:15], s90 offen offset:3072 sc1
  v_mfma_f32_16x16x32_bf16 v[140:143], a[128:131], v[92:95], v[140:143]
  v_mfma_f32_16x16x32_bf16 v[132:135], a[132:135], v[92:95], v[132:135]
  ds_write_b128 v3, v[28:31] offset:4096
  v_mfma_f32_16x16x32_bf16 v[136:139], a[136:139], v[92:95], v[136:139]
  s_add_u32 s90, s35, 8192
  buffer_load_dwordx4 a[224:227], v4, s[12:15], s90 offen offset:0 sc1
  v_mfma_f32_16x16x32_bf16 v[140:143], a[140:143], v[92:95], v[140:143]
  ds_write_b128 v3, v[32:35] offset:8192
  v_mfma_f32_16x16x32_bf16 v[132:135], a[144:147], v[92:95], v[132:135]
  v_mfma_f32_16x16x32_bf16 v[136:139], a[148:151], v[92:95], v[136:139]
  v_mfma_f32_16x16x32_bf16 v[140:143], a[152:155], v[92:95], v[140:143]
  ds_write_b128 v3, v[36:39] offset:12288
  v_mfma_f32_16x16x32_bf16 v[132:135], a[156:159], v[92:95], v[132:135]
  buffer_load_dwordx4 a[228:231], v4, s[12:15], s90 offen offset:1024 sc1
  v_mfma_f32_16x16x32_bf16 v[136:139], a[160:163], v[92:95], v[136:139]
  v_mfma_f32_16x16x32_bf16 v[140:143], a[164:167], v[92:95], v[140:143]
  v_mfma_f32_16x16x32_bf16 v[132:135], a[168:171], v[92:95], v[132:135]
  s_waitcnt vmcnt(20)
  v_mfma_f32_16x16x32_bf16 v[136:139], a[172:175], v[92:95], v[136:139]
  buffer_load_dwordx4 a[232:235], v4, s[12:15], s90 offen offset:2048 sc1
  s_waitcnt vmcnt(20)
  v_mfma_f32_16x16x32_bf16 v[140:143], a[176:179], v[92:95], v[140:143]
  s_waitcnt lgkmcnt(0)
  s_barrier
  s_waitcnt vmcnt(19)
  v_mfma_f32_16x16x32_bf16 v[132:135], a[180:183], v[92:95], v[132:135]
  s_waitcnt vmcnt(18)
  v_mfma_f32_16x16x32_bf16 v[136:139], a[184:187], v[92:95], v[136:139]
  buffer_load_dwordx4 a[236:239], v4, s[12:15], s90 offen offset:3072 sc1
  s_waitcnt vmcnt(18)
  v_mfma_f32_16x16x32_bf16 v[140:143], a[188:191], v[92:95], v[140:143]
  ds_read_b64_tr_b16 v[116:117], v0 offset:0
  ds_read_b64_tr_b16 v[118:119], v0 offset:512
  ds_read_b64_tr_b16 v[120:121], v0 offset:1024
  ds_read_b64_tr_b16 v[122:123], v0 offset:1536
  ds_read_b64_tr_b16 v[124:125], v0 offset:2048
  ds_read_b64_tr_b16 v[126:127], v0 offset:2560
  s_waitcnt lgkmcnt(4)
  v_mfma_f32_16x16x32_bf16 v[24:27], a[0:3], v[116:119], 0
  ds_read_b64_tr_b16 v[128:129], v0 offset:3072
  v_mfma_f32_16x16x32_bf16 v[28:31], a[4:7], v[116:119], 0
  ds_read_b64_tr_b16 v[130:131], v0 offset:3584
  s_mul_i32 s76, s3, 192
  v_xor_b32 v0, 4096, v0
  v_mfma_f32_16x16x32_bf16 v[32:35], a[8:11], v[116:119], 0
  s_add_u32 s90, s35, 12288
  buffer_load_dwordx4 a[240:243], v4, s[12:15], s90 offen offset:0 sc1
  s_add_u32 s76, s76, 159744
  v_lshrrev_b32 v12, 8, v4
  v_mfma_f32_16x16x32_bf16 v[36:39], v[116:119], v[116:119], 0
  v_lshl_add_u32 v12, v12, 4, s76
  s_waitcnt lgkmcnt(2)
  v_mfma_f32_16x16x32_bf16 v[24:27], a[12:15], v[120:123], v[24:27]
  ds_read_b64_tr_b16 v[116:117], v0 offset:0
  ds_write_b128 v12, v[132:135] offset:0
  v_mfma_f32_16x16x32_bf16 v[28:31], a[16:19], v[120:123], v[28:31]
  ds_read_b64_tr_b16 v[118:119], v0 offset:512
  ds_write_b128 v12, v[136:139] offset:64
  v_mfma_f32_16x16x32_bf16 v[32:35], a[20:23], v[120:123], v[32:35]
  buffer_load_dwordx4 a[244:247], v4, s[12:15], s90 offen offset:1024 sc1
  v_mfma_f32_16x16x32_bf16 v[36:39], v[120:123], v[120:123], v[36:39]
  ds_write_b128 v12, v[140:143] offset:128
  v_mfma_f32_16x16x32_bf16 v[24:27], a[24:27], v[124:127], v[24:27]
  ds_read_b64_tr_b16 v[120:121], v0 offset:1024
  v_mfma_f32_16x16x32_bf16 v[28:31], a[28:31], v[124:127], v[28:31]
  ds_read_b64_tr_b16 v[122:123], v0 offset:1536
  v_mfma_f32_16x16x32_bf16 v[32:35], a[32:35], v[124:127], v[32:35]
  buffer_load_dwordx4 a[248:251], v4, s[12:15], s90 offen offset:2048 sc1
  v_mfma_f32_16x16x32_bf16 v[36:39], v[124:127], v[124:127], v[36:39]
  s_waitcnt lgkmcnt(5)
  v_mfma_f32_16x16x32_bf16 v[24:27], a[36:39], v[128:131], v[24:27]
  ds_read_b64_tr_b16 v[124:125], v0 offset:2048
  v_mfma_f32_16x16x32_bf16 v[28:31], a[40:43], v[128:131], v[28:31]
  ds_read_b64_tr_b16 v[126:127], v0 offset:2560
  v_mfma_f32_16x16x32_bf16 v[32:35], a[44:47], v[128:131], v[32:35]
  buffer_load_dwordx4 a[252:255], v4, s[12:15], s90 offen offset:3072 sc1
  v_mfma_f32_16x16x32_bf16 v[36:39], v[128:131], v[128:131], v[36:39]
  s_waitcnt lgkmcnt(4)
  v_mfma_f32_16x16x32_bf16 v[24:27], a[48:51], v[116:119], v[24:27]
  ds_read_b64_tr_b16 v[128:129], v0 offset:3072
  v_mfma_f32_16x16x32_bf16 v[28:31], a[52:55], v[116:119], v[28:31]
  ds_read_b64_tr_b16 v[130:131], v0 offset:3584
  s_add_u32 s90, s35, 16384
  buffer_load_dwordx4 v[144:147], v4, s[12:15], s90 offen offset:0 sc1
  v_xor_b32 v0, 12288, v0
  v_mfma_f32_16x16x32_bf16 v[32:35], a[56:59], v[116:119], v[32:35]
  s_waitcnt lgkmcnt(3)
  v_mfma_f32_16x16x32_bf16 v[24:27], a[60:63], v[120:123], v[24:27]
  ds_read_b64_tr_b16 v[116:117], v0 offset:0
  s_add_u32 s84, s33, 5242880
  buffer_load_dwordx4 v[100:103], v3, s[12:15], s84 offen sc1
  v_mfma_f32_16x16x32_bf16 v[28:31], a[64:67], v[120:123], v[28:31]
  ds_read_b64_tr_b16 v[118:119], v0 offset:512
  v_mfma_f32_16x16x32_bf16 v[32:35], a[68:71], v[120:123], v[32:35]
  s_waitcnt lgkmcnt(3)
  v_mfma_f32_16x16x32_bf16 v[24:27], a[72:75], v[124:127], v[24:27]
  ds_read_b64_tr_b16 v[120:121], v0 offset:1024
  s_add_u32 s84, s33, 5246976
  buffer_load_dwordx4 v[104:107], v3, s[12:15], s84 offen sc1
  buffer_load_dwordx4 v[148:151], v4, s[12:15], s90 offen offset:1024 sc1
  v_mfma_f32_16x16x32_bf16 v[28:31], a[76:79], v[124:127], v[28:31]
  ds_read_b64_tr_b16 v[122:123], v0 offset:1536
  v_mfma_f32_16x16x32_bf16 v[32:35], a[80:83], v[124:127], v[32:35]
  s_waitcnt lgkmcnt(3)
  v_mfma_f32_16x16x32_bf16 v[24:27], a[84:87], v[128:131], v[24:27]
  ds_read_b64_tr_b16 v[124:125], v0 offset:2048
  s_add_u32 s84, s33, 5251072
  buffer_load_dwordx4 v[108:111], v3, s[12:15], s84 offen sc1
  buffer_load_dwordx4 v[152:155], v4, s[12:15], s90 offen offset:2048 sc1
  s_waitcnt vmcnt(18)
  v_max3_u32 v22, v68, v70, v72
  v_mfma_f32_16x16x32_bf16 v[28:31], a[88:91], v[128:131], v[28:31]
  ds_read_b64_tr_b16 v[126:127], v0 offset:2560
  s_waitcnt vmcnt(16)
  v_max3_u32 v22, v22, v74, v76
  v_mfma_f32_16x16x32_bf16 v[32:35], a[92:95], v[128:131], v[32:35]
  s_add_u32 s84, s33, 5255168
  buffer_load_dwordx4 v[112:115], v3, s[12:15], s84 offen sc1
  s_waitcnt vmcnt(16)
  v_max3_u32 v22, v22, v78, v80
  s_waitcnt lgkmcnt(1)
  v_mfma_f32_16x16x32_bf16 v[24:27], a[96:99], v[116:119], v[24:27]
  ds_read_b64_tr_b16 v[128:129], v0 offset:3072
  v_max_u32 v22, v22, v82
  v_mfma_f32_16x16x32_bf16 v[28:31], a[100:103], v[116:119], v[28:31]
  ds_read_b64_tr_b16 v[130:131], v0 offset:3584
  buffer_load_dwordx4 v[156:159], v4, s[12:15], s90 offen offset:3072 sc1
  v_cmp_eq_u32_e64 vcc, -1, v22
  v_xor_b32 v0, 4096, v0
  v_mfma_f32_16x16x32_bf16 v[32:35], a[104:107], v[116:119], v[32:35]
  s_cbranch_vccnz Lretry20
Lback21:
  v_mfma_f32_16x16x32_bf16 v[24:27], a[108:111], v[120:123], v[24:27]
  ds_read_b64_tr_b16 v[116:117], v0 offset:0
  ds_write_b128 v3, v[68:71] offset:16384
  v_mfma_f32_16x16x32_bf16 v[28:31], a[112:115], v[120:123], v[28:31]
  ds_read_b64_tr_b16 v[118:119], v0 offset:512
  v_mfma_f32_16x16x32_bf16 v[32:35], a[116:119], v[120:123], v[32:35]
  s_add_u32 s90, s35, 20480
  buffer_load_dwordx4 v[160:163], v4, s[12:15], s90 offen offset:0 sc1
  s_waitcnt lgkmcnt(3)
  v_mfma_f32_16x16x32_bf16 v[24:27], a[120:123], v[124:127], v[24:27]
  ds_read_b64_tr_b16 v[120:121], v0 offset:1024
  ds_write_b128 v3, v[72:75] offset:20480
  v_mfma_f32_16x16x32_bf16 v[28:31], a[124:127], v[124:127], v[28:31]
  ds_read_b64_tr_b16 v[122:123], v0 offset:1536
  v_mfma_f32_16x16x32_bf16 v[32:35], a[128:131], v[124:127], v[32:35]
  ds_write_b128 v3, v[76:79] offset:24576
  v_mfma_f32_16x16x32_bf16 v[24:27], a[132:135], v[128:131], v[24:27]
  ds_read_b64_tr_b16 v[124:125], v0 offset:2048
  buffer_load_dwordx4 v[164:167], v4, s[12:15], s90 offen offset:1024 sc1
  v_mfma_f32_16x16x32_bf16 v[28:31], a[136:139], v[128:131], v[28:31]
  ds_read_b64_tr_b16 v[126:127], v0 offset:2560
  v_mfma_f32_16x16x32_bf16 v[32:35], a[140:143], v[128:131], v[32:35]
  ds_write_b128 v3, v[80:83] offset:28672
  s_waitcnt lgkmcnt(7)
  v_mfma_f32_16x16x32_bf16 v[24:27], a[144:147], v[116:119], v[24:27]
  ds_read_b64_tr_b16 v[128:129], v0 offset:3072
  v_mfma_f32_16x16x32_bf16 v[28:31], a[148:151], v[116:119], v[28:31]
  ds_read_b64_tr_b16 v[130:131], v0 offset:3584
  buffer_load_dwordx4 v[168:171], v4, s[12:15], s90 offen offset:2048 sc1
  v_xor_b32 v0, 12288, v0
  v_mfma_f32_16x16x32_bf16 v[32:35], a[152:155], v[116:119], v[32:35]
  s_waitcnt lgkmcnt(5)
  v_mfma_f32_16x16x32_bf16 v[24:27], a[156:159], v[120:123], v[24:27]
  s_add_u32 s84, s33, 5767168
  buffer_load_dwordx4 v[84:87], v3, s[12:15], s84 offen sc1
  s_waitcnt lgkmcnt(2)
  s_barrier
  ds_read_b64_tr_b16 v[116:117], v0 offset:16384
  v_mfma_f32_16x16x32_bf16 v[28:31], a[160:163], v[120:123], v[28:31]
  ds_read_b64_tr_b16 v[118:119], v0 offset:16896
  buffer_load_dwordx4 v[172:175], v4, s[12:15], s90 offen offset:3072 sc1
  v_mfma_f32_16x16x32_bf16 v[32:35], a[164:167], v[120:123], v[32:35]
  v_mfma_f32_16x16x32_bf16 v[24:27], a[168:171], v[124:127], v[24:27]
  ds_read_b64_tr_b16 v[120:121], v0 offset:17408
  v_mfma_f32_16x16x32_bf16 v[28:31], a[172:175], v[124:127], v[28:31]
  ds_read_b64_tr_b16 v[122:123], v0 offset:17920
  s_add_u32 s84, s33, 5771264
  buffer_load_dwordx4 v[88:91], v3, s[12:15], s84 offen sc1
  v_mfma_f32_16x16x32_bf16 v[32:35], a[176:179], v[124:127], v[32:35]
  s_add_u32 s90, s35, 24576
  buffer_load_dwordx4 v[176:179], v4, s[12:15], s90 offen offset:0 sc1
  s_waitcnt lgkmcnt(4)
  v_mfma_f32_16x16x32_bf16 v[24:27], a[180:183], v[128:131], v[24:27]
  ds_read_b64_tr_b16 v[124:125], v0 offset:18432
  v_mfma_f32_16x16x32_bf16 v[28:31], a[184:187], v[128:131], v[28:31]
  ds_read_b64_tr_b16 v[126:127], v0 offset:18944
  v_mfma_f32_16x16x32_bf16 v[32:35], a[188:191], v[128:131], v[32:35]
  s_add_u32 s84, s33, 5775360
  buffer_load_dwordx4 v[92:95], v3, s[12:15], s84 offen sc1
  s_nop 5
  v_mul_f32 v12, 0xbb000000, v32
  v_mul_f32 v13, 0xbb000000, v32
  v_cndmask_b32 v20, v36, v37, s[60:61]
  s_nop 0
  v_permlane32_swap_b32 v12, v13
  v_cndmask_b32 v20, v20, v38, s[62:63]
  v_mov_b32_e64 v12, v13
  v_cndmask_b32 v20, v20, v39, s[64:65]
  s_add_u32 s76, s24, 0
  v_permlane16_swap_b32 v12, v13
  v_fmac_f32 v24, v13, v132
  v_fmac_f32 v25, v13, v133
  v_cvt_pk_bf16_f32 v14, v24, v25
  v_pk_max_i16 v14, v14, 0
  v_fma_f32 v26, -v13, v134, -v26
  v_fma_f32 v27, -v13, v135, -v27
  v_cvt_pk_bf16_f32 v15, v26, v27
  v_pk_max_u16 v15, v15, s75
  v_fma_f32 v28, -v13, v136, -v28
  v_fma_f32 v29, -v13, v137, -v29
  v_cvt_pk_bf16_f32 v16, v28, v29
  v_pk_max_u16 v16, v16, s75
  v_fmac_f32 v30, v13, v138
  v_fmac_f32_e64 v31, v13, v139
  v_cvt_pk_bf16_f32 v17, v30, v31
  v_pk_max_i16 v17, v17, 0
  s_waitcnt lgkmcnt(0)
  v_mfma_f32_16x16x32_bf16 v[40:43], a[0:3], v[116:119], 0
  ds_read_b64_tr_b16 v[128:129], v0 offset:19456
  buffer_store_dwordx4 v[14:17], v4, s[12:15], s76 offen sc1
  v_mfma_f32_16x16x32_bf16 v[44:47], a[4:7], v[116:119], 0
  ds_read_b64_tr_b16 v[130:131], v0 offset:19968
  buffer_load_dwordx4 v[180:183], v4, s[12:15], s90 offen offset:1024 sc1
  s_add_u32 s76, s25, 0
  v_fmac_f32 v32, v13, v140
  v_xor_b32 v0, 4096, v0
  v_mfma_f32_16x16x32_bf16 v[48:51], a[8:11], v[116:119], 0
  v_fmac_f32_e64 v33, v13, v141
  v_cvt_pk_bf16_f32 v18, v32, v33
  v_mfma_f32_16x16x32_bf16 v[52:55], v[116:119], v[116:119], 0
  s_add_u32 s84, s33, 5779456
  buffer_load_dwordx4 v[96:99], v3, s[12:15], s84 offen sc1
  v_pk_max_i16 v18, v18, 0
  v_fma_f32 v34, -v13, v142, -v34
  v_mfma_f32_16x16x32_bf16 v[40:43], a[12:15], v[120:123], v[40:43]
  ds_read_b64_tr_b16 v[116:117], v0 offset:16384
  buffer_load_dwordx4 v[184:187], v4, s[12:15], s90 offen offset:2048 sc1
  v_fma_f32 v35, -v13, v143, -v35
  v_cvt_pk_bf16_f32 v19, v34, v35
  v_mfma_f32_16x16x32_bf16 v[44:47], a[16:19], v[120:123], v[44:47]
  ds_read_b64_tr_b16 v[118:119], v0 offset:16896
  v_pk_max_u16 v19, v19, s75
  v_mfma_f32_16x16x32_bf16 v[48:51], a[20:23], v[120:123], v[48:51]
  buffer_store_dwordx2 v[18:19], v1, s[12:15], s76 offen sc1
  ds_write_b32 v9, v20 offset:0
  v_mfma_f32_16x16x32_bf16 v[52:55], v[120:123], v[120:123], v[52:55]
  ds_write_b32 v9, v13 offset:1024
  v_mfma_f32_16x16x32_bf16 v[40:43], a[24:27], v[124:127], v[40:43]
  ds_read_b64_tr_b16 v[120:121], v0 offset:17408
  buffer_load_dwordx4 v[188:191], v4, s[12:15], s90 offen offset:3072 sc1
  v_mfma_f32_16x16x32_bf16 v[44:47], a[28:31], v[124:127], v[44:47]
  ds_read_b64_tr_b16 v[122:123], v0 offset:17920
  v_mfma_f32_16x16x32_bf16 v[48:51], a[32:35], v[124:127], v[48:51]
  v_mfma_f32_16x16x32_bf16 v[52:55], v[124:127], v[124:127], v[52:55]
  s_add_u32 s90, s35, 28672
  buffer_load_dwordx4 v[192:195], v4, s[12:15], s90 offen offset:0 sc1
  s_waitcnt lgkmcnt(4)
  v_mfma_f32_16x16x32_bf16 v[40:43], a[36:39], v[128:131], v[40:43]
  ds_read_b64_tr_b16 v[124:125], v0 offset:18432
  v_mfma_f32_16x16x32_bf16 v[44:47], a[40:43], v[128:131], v[44:47]
  ds_read_b64_tr_b16 v[126:127], v0 offset:18944
  v_mfma_f32_16x16x32_bf16 v[48:51], a[44:47], v[128:131], v[48:51]
  v_mfma_f32_16x16x32_bf16 v[52:55], v[128:131], v[128:131], v[52:55]
  v_mfma_f32_16x16x32_bf16 v[40:43], a[48:51], v[116:119], v[40:43]
  ds_read_b64_tr_b16 v[128:129], v0 offset:19456
  buffer_load_dwordx4 v[196:199], v4, s[12:15], s90 offen offset:1024 sc1
  v_mfma_f32_16x16x32_bf16 v[44:47], a[52:55], v[116:119], v[44:47]
  ds_read_b64_tr_b16 v[130:131], v0 offset:19968
  v_xor_b32 v0, 12288, v0
  v_mfma_f32_16x16x32_bf16 v[48:51], a[56:59], v[116:119], v[48:51]
  s_waitcnt vmcnt(21)
  v_max3_u32 v22, v100, v102, v104
  s_waitcnt lgkmcnt(4)
  v_mfma_f32_16x16x32_bf16 v[40:43], a[60:63], v[120:123], v[40:43]
  ds_read_b64_tr_b16 v[116:117], v0 offset:16384
  s_waitcnt vmcnt(19)
  v_max3_u32 v22, v22, v106, v108
  v_mfma_f32_16x16x32_bf16 v[44:47], a[64:67], v[120:123], v[44:47]
  ds_read_b64_tr_b16 v[118:119], v0 offset:16896
  buffer_load_dwordx4 v[200:203], v4, s[12:15], s90 offen offset:2048 sc1
  s_waitcnt vmcnt(18)
  v_max3_u32 v22, v22, v110, v112
  v_mfma_f32_16x16x32_bf16 v[48:51], a[68:71], v[120:123], v[48:51]
  v_max_u32_e64 v22, v22, v114
  s_waitcnt lgkmcnt(2)
  v_mfma_f32_16x16x32_bf16 v[40:43], a[72:75], v[124:127], v[40:43]
  ds_read_b64_tr_b16 v[120:121], v0 offset:17408
  v_cmp_eq_u32 vcc, -1, v22
  v_mfma_f32_16x16x32_bf16 v[44:47], a[76:79], v[124:127], v[44:47]
  ds_read_b64_tr_b16 v[122:123], v0 offset:17920
  buffer_load_dwordx4 v[204:207], v4, s[12:15], s90 offen offset:3072 sc1
  s_cbranch_vccnz Lretry22
Lback23:
  v_mfma_f32_16x16x32_bf16 v[48:51], a[80:83], v[124:127], v[48:51]
  ds_write_b128 v3, v[100:103] offset:32768
  v_mfma_f32_16x16x32_bf16 v[40:43], a[84:87], v[128:131], v[40:43]
  ds_read_b64_tr_b16 v[124:125], v0 offset:18432
  v_mfma_f32_16x16x32_bf16 v[44:47], a[88:91], v[128:131], v[44:47]
  ds_read_b64_tr_b16 v[126:127], v0 offset:18944
  v_mfma_f32_16x16x32_bf16 v[48:51], a[92:95], v[128:131], v[48:51]
  ds_write_b128 v3, v[104:107] offset:36864
  s_add_u32 s90, s35, 32768
  buffer_load_dwordx4 v[208:211], v4, s[12:15], s90 offen offset:0 sc1
  s_waitcnt lgkmcnt(5)
  v_mfma_f32_16x16x32_bf16 v[40:43], a[96:99], v[116:119], v[40:43]
  ds_read_b64_tr_b16 v[128:129], v0 offset:19456
  v_mfma_f32_16x16x32_bf16 v[44:47], a[100:103], v[116:119], v[44:47]
  ds_read_b64_tr_b16 v[130:131], v0 offset:19968
  ds_write_b128 v3, v[108:111] offset:40960
  v_xor_b32 v0, 4096, v0
  v_mfma_f32_16x16x32_bf16 v[48:51], a[104:107], v[116:119], v[48:51]
  s_waitcnt lgkmcnt(5)
  v_mfma_f32_16x16x32_bf16 v[40:43], a[108:111], v[120:123], v[40:43]
  ds_read_b64_tr_b16 v[116:117], v0 offset:16384
  buffer_load_dwordx4 v[212:215], v4, s[12:15], s90 offen offset:1024 sc1
  v_mfma_f32_16x16x32_bf16 v[44:47], a[112:115], v[120:123], v[44:47]
  ds_read_b64_tr_b16 v[118:119], v0 offset:16896
  ds_write_b128 v3, v[112:115] offset:45056
  v_mfma_f32_16x16x32_bf16 v[48:51], a[116:119], v[120:123], v[48:51]
  s_waitcnt lgkmcnt(6)
  v_mfma_f32_16x16x32_bf16 v[40:43], a[120:123], v[124:127], v[40:43]
  ds_read_b64_tr_b16 v[120:121], v0 offset:17408
  v_mfma_f32_16x16x32_bf16 v[44:47], a[124:127], v[124:127], v[44:47]
  ds_read_b64_tr_b16 v[122:123], v0 offset:17920
  buffer_load_dwordx4 v[216:219], v4, s[12:15], s90 offen offset:2048 sc1
  v_mfma_f32_16x16x32_bf16 v[48:51], a[128:131], v[124:127], v[48:51]
  s_waitcnt lgkmcnt(5)
  v_mfma_f32_16x16x32_bf16 v[40:43], a[132:135], v[128:131], v[40:43]
  ds_read_b64_tr_b16 v[124:125], v0 offset:18432
  v_mfma_f32_16x16x32_bf16 v[44:47], a[136:139], v[128:131], v[44:47]
  ds_read_b64_tr_b16 v[126:127], v0 offset:18944
  s_waitcnt lgkmcnt(4)
  s_barrier
  v_mfma_f32_16x16x32_bf16 v[48:51], a[140:143], v[128:131], v[48:51]
  buffer_load_dwordx4 v[220:223], v4, s[12:15], s90 offen offset:3072 sc1
  v_mfma_f32_16x16x32_bf16 v[40:43], a[144:147], v[116:119], v[40:43]
  ds_read_b64_tr_b16 v[128:129], v0 offset:19456
  v_mfma_f32_16x16x32_bf16 v[44:47], a[148:151], v[116:119], v[44:47]
  ds_read_b64_tr_b16 v[130:131], v0 offset:19968
  v_xor_b32 v0, 12288, v0
  v_mfma_f32_16x16x32_bf16 v[48:51], a[152:155], v[116:119], v[48:51]
  s_add_u32 s90, s35, 36864
  buffer_load_dwordx4 v[224:227], v4, s[12:15], s90 offen offset:0 sc1
  s_waitcnt lgkmcnt(3)
  v_mfma_f32_16x16x32_bf16 v[40:43], a[156:159], v[120:123], v[40:43]
  ds_read_b64_tr_b16 v[116:117], v0 offset:32768
  v_mfma_f32_16x16x32_bf16 v[44:47], a[160:163], v[120:123], v[44:47]
  ds_read_b64_tr_b16 v[118:119], v0 offset:33280
  v_mfma_f32_16x16x32_bf16 v[48:51], a[164:167], v[120:123], v[48:51]
  s_waitcnt lgkmcnt(4)
  v_mfma_f32_16x16x32_bf16 v[40:43], a[168:171], v[124:127], v[40:43]
  ds_read_b64_tr_b16 v[120:121], v0 offset:33792
  v_mfma_f32_16x16x32_bf16 v[44:47], a[172:175], v[124:127], v[44:47]
  ds_read_b64_tr_b16 v[122:123], v0 offset:34304
  buffer_load_dwordx4 v[228:231], v4, s[12:15], s90 offen offset:1024 sc1
  v_mfma_f32_16x16x32_bf16 v[48:51], a[176:179], v[124:127], v[48:51]
  s_waitcnt lgkmcnt(4)
  v_mfma_f32_16x16x32_bf16 v[40:43], a[180:183], v[128:131], v[40:43]
  ds_read_b64_tr_b16 v[124:125], v0 offset:34816
  v_mfma_f32_16x16x32_bf16 v[44:47], a[184:187], v[128:131], v[44:47]
  ds_read_b64_tr_b16 v[126:127], v0 offset:35328
  buffer_load_dwordx4 v[232:235], v4, s[12:15], s90 offen offset:2048 sc1
  v_mfma_f32_16x16x32_bf16 v[48:51], a[188:191], v[128:131], v[48:51]
  s_nop 7
  v_mul_f32 v12, 0xbb000000, v48
  v_mul_f32 v13, 0xbb000000, v48
  v_cndmask_b32 v20, v52, v53, s[60:61]
  s_nop 0
  v_permlane32_swap_b32 v12, v13
  v_cndmask_b32 v20, v20, v54, s[62:63]
  v_mov_b32 v12, v13
  v_cndmask_b32 v20, v20, v55, s[64:65]
  s_add_u32 s76, s24, 45056
  v_permlane16_swap_b32 v12, v13
  v_fmac_f32 v40, v13, v132
  v_fmac_f32 v41, v13, v133
  v_cvt_pk_bf16_f32 v14, v40, v41
  v_pk_max_i16 v14, v14, 0
  v_fma_f32 v42, -v13, v134, -v42
  v_fma_f32 v43, -v13, v135, -v43
  v_cvt_pk_bf16_f32 v15, v42, v43
  v_pk_max_u16 v15, v15, s75
  v_fma_f32 v44, -v13, v136, -v44
  v_fma_f32 v45, -v13, v137, -v45
  v_cvt_pk_bf16_f32 v16, v44, v45
  v_pk_max_u16 v16, v16, s75
  v_fmac_f32 v46, v13, v138
  v_fmac_f32 v47, v13, v139
  v_cvt_pk_bf16_f32 v17, v46, v47
  v_pk_max_i16 v17, v17, 0
  buffer_store_dwordx4 v[14:17], v4, s[12:15], s76 offen sc1
  s_add_u32 s76, s25, 45056
  v_fmac_f32 v48, v13, v140
  v_fmac_f32_e64 v49, v13, v141
  v_cvt_pk_bf16_f32 v18, v48, v49
  v_pk_max_i16 v18, v18, 0
  v_fma_f32 v50, -v13, v142, -v50
  v_fma_f32 v51, -v13, v143, -v51
  v_cvt_pk_bf16_f32 v19, v50, v51
  v_pk_max_u16 v19, v19, s75
  buffer_store_dwordx2 v[18:19], v1, s[12:15], s76 offen sc1
  ds_write_b32 v9, v20 offset:256
  s_waitcnt lgkmcnt(1)
  v_mfma_f32_16x16x32_bf16 v[24:27], a[0:3], v[116:119], 0
  ds_read_b64_tr_b16 v[128:129], v0 offset:35840
  ds_write_b32 v9, v13 offset:1280
  v_mfma_f32_16x16x32_bf16 v[28:31], a[4:7], v[116:119], 0
  ds_read_b64_tr_b16 v[130:131], v0 offset:36352
  v_xor_b32 v0, 4096, v0
  v_mfma_f32_16x16x32_bf16 v[32:35], a[8:11], v[116:119], 0
  buffer_load_dwordx4 v[236:239], v4, s[12:15], s90 offen offset:3072 sc1
  v_mfma_f32_16x16x32_bf16 v[36:39], v[116:119], v[116:119], 0
  v_mfma_f32_16x16x32_bf16 v[24:27], a[12:15], v[120:123], v[24:27]
  ds_read_b64_tr_b16 v[116:117], v0 offset:32768
  v_mfma_f32_16x16x32_bf16 v[28:31], a[16:19], v[120:123], v[28:31]
  ds_read_b64_tr_b16 v[118:119], v0 offset:33280
  v_mfma_f32_16x16x32_bf16 v[32:35], a[20:23], v[120:123], v[32:35]
  s_add_u32 s90, s35, 40960
  buffer_load_dwordx4 v[240:243], v4, s[12:15], s90 offen offset:0 sc1
Lpad2:
  s_cbranch_execz Lpad6
  s_nop 0
  v_mfma_f32_16x16x32_bf16 v[36:39], v[120:123], v[120:123], v[36:39]
  v_mfma_f32_16x16x32_bf16 v[24:27], a[24:27], v[124:127], v[24:27]
  ds_read_b64_tr_b16 v[120:121], v0 offset:33792
  v_mfma_f32_16x16x32_bf16 v[28:31], a[28:31], v[124:127], v[28:31]
  ds_read_b64_tr_b16 v[122:123], v0 offset:34304
  v_mfma_f32_16x16x32_bf16 v[32:35], a[32:35], v[124:127], v[32:35]
  buffer_load_dwordx4 v[244:247], v4, s[12:15], s90 offen offset:1024 sc1
  v_mfma_f32_16x16x32_bf16 v[36:39], v[124:127], v[124:127], v[36:39]
  s_waitcnt lgkmcnt(4)
  v_mfma_f32_16x16x32_bf16 v[24:27], a[36:39], v[128:131], v[24:27]
  ds_read_b64_tr_b16 v[124:125], v0 offset:34816
  v_mfma_f32_16x16x32_bf16 v[28:31], a[40:43], v[128:131], v[28:31]
  ds_read_b64_tr_b16 v[126:127], v0 offset:35328
  v_mfma_f32_16x16x32_bf16 v[32:35], a[44:47], v[128:131], v[32:35]
  buffer_load_dwordx4 v[248:251], v4, s[12:15], s90 offen offset:2048 sc1
  v_mfma_f32_16x16x32_bf16 v[36:39], v[128:131], v[128:131], v[36:39]
  s_waitcnt lgkmcnt(4)
  v_mfma_f32_16x16x32_bf16 v[24:27], a[48:51], v[116:119], v[24:27]
  ds_read_b64_tr_b16 v[128:129], v0 offset:35840
  s_waitcnt vmcnt(25)
  v_max3_u32 v22, v84, v86, v88
  v_mfma_f32_16x16x32_bf16 v[28:31], a[52:55], v[116:119], v[28:31]
  ds_read_b64_tr_b16 v[130:131], v0 offset:36352
  buffer_load_dwordx4 v[252:255], v4, s[12:15], s90 offen offset:3072 sc1
  s_waitcnt vmcnt(24)
  v_max3_u32 v22, v22, v90, v92
  v_xor_b32 v0, 12288, v0
  v_mfma_f32_16x16x32_bf16 v[32:35], a[56:59], v[116:119], v[32:35]
  s_waitcnt vmcnt(21)
  v_max3_u32 v22, v22, v94, v96
  s_waitcnt lgkmcnt(2)
  v_mfma_f32_16x16x32_bf16 v[24:27], a[60:63], v[120:123], v[24:27]
  ds_read_b64_tr_b16 v[116:117], v0 offset:32768
  v_max_u32 v22, v22, v98
  v_mov_b32 v100, -1
  v_mfma_f32_16x16x32_bf16 v[28:31], a[64:67], v[120:123], v[28:31]
  ds_read_b64_tr_b16 v[118:119], v0 offset:33280
  v_cmp_eq_u32_e64 vcc, -1, v22
  v_mfma_f32_16x16x32_bf16 v[32:35], a[68:71], v[120:123], v[32:35]
  v_mov_b32 v101, -1
  s_cbranch_vccnz Lretry24
Lback25:
  v_mfma_f32_16x16x32_bf16 v[24:27], a[72:75], v[124:127], v[24:27]
  ds_read_b64_tr_b16 v[120:121], v0 offset:33792
  ds_write_b128 v3, v[84:87] offset:49152
  v_mov_b32_e64 v102, -1
  v_mfma_f32_16x16x32_bf16 v[28:31], a[76:79], v[124:127], v[28:31]
  ds_read_b64_tr_b16 v[122:123], v0 offset:34304
  v_mov_b32 v103, -1
  v_mfma_f32_16x16x32_bf16 v[32:35], a[80:83], v[124:127], v[32:35]
  s_add_u32 s90, s69, 6291456
  buffer_store_dwordx4 v[100:103], v3, s[12:15], s90 offen sc1
  s_waitcnt lgkmcnt(3)
  v_mfma_f32_16x16x32_bf16 v[24:27], a[84:87], v[128:131], v[24:27]
  ds_read_b64_tr_b16 v[124:125], v0 offset:34816
  ds_write_b128 v3, v[88:91] offset:53248
  v_mfma_f32_16x16x32_bf16 v[28:31], a[88:91], v[128:131], v[28:31]
  ds_read_b64_tr_b16 v[126:127], v0 offset:35328
  s_add_u32 s90, s69, 6295552
  buffer_store_dwordx4 v[100:103], v3, s[12:15], s90 offen sc1
  v_mfma_f32_16x16x32_bf16 v[32:35], a[92:95], v[128:131], v[32:35]
  ds_write_b128 v3, v[92:95] offset:57344
  v_mfma_f32_16x16x32_bf16 v[24:27], a[96:99], v[116:119], v[24:27]
  ds_read_b64_tr_b16 v[128:129], v0 offset:35840
  v_mfma_f32_16x16x32_bf16 v[28:31], a[100:103], v[116:119], v[28:31]
  ds_read_b64_tr_b16 v[130:131], v0 offset:36352
  v_xor_b32 v0, 4096, v0
  v_mfma_f32_16x16x32_bf16 v[32:35], a[104:107], v[116:119], v[32:35]
  ds_write_b128 v3, v[96:99] offset:61440
  s_waitcnt lgkmcnt(6)
  v_mfma_f32_16x16x32_bf16 v[24:27], a[108:111], v[120:123], v[24:27]
  ds_read_b64_tr_b16 v[116:117], v0 offset:32768
  v_mfma_f32_16x16x32_bf16 v[28:31], a[112:115], v[120:123], v[28:31]
  ds_read_b64_tr_b16 v[118:119], v0 offset:33280
  v_mfma_f32_16x16x32_bf16 v[32:35], a[116:119], v[120:123], v[32:35]
  s_waitcnt lgkmcnt(6)
  v_mfma_f32_16x16x32_bf16 v[24:27], a[120:123], v[124:127], v[24:27]
  ds_read_b64_tr_b16 v[120:121], v0 offset:33792
  v_mfma_f32_16x16x32_bf16 v[28:31], a[124:127], v[124:127], v[28:31]
  ds_read_b64_tr_b16 v[122:123], v0 offset:34304
  v_mfma_f32_16x16x32_bf16 v[32:35], a[128:131], v[124:127], v[32:35]
  s_waitcnt lgkmcnt(4)
  s_barrier
  v_mfma_f32_16x16x32_bf16 v[24:27], a[132:135], v[128:131], v[24:27]
  ds_read_b64_tr_b16 v[124:125], v0 offset:34816
  s_add_u32 s84, s26, 0
  buffer_load_dwordx4 v[56:59], v4, s[12:15], s84 offen offset:0 sc1
  v_mfma_f32_16x16x32_bf16 v[28:31], a[136:139], v[128:131], v[28:31]
  ds_read_b64_tr_b16 v[126:127], v0 offset:35328
  v_mfma_f32_16x16x32_bf16 v[32:35], a[140:143], v[128:131], v[32:35]
  s_waitcnt lgkmcnt(4)
  v_mfma_f32_16x16x32_bf16 v[24:27], a[144:147], v[116:119], v[24:27]
  ds_read_b64_tr_b16 v[128:129], v0 offset:35840
  buffer_load_dwordx4 v[60:63], v4, s[12:15], s84 offen offset:1024 sc1
  v_mfma_f32_16x16x32_bf16 v[28:31], a[148:151], v[116:119], v[28:31]
  ds_read_b64_tr_b16 v[130:131], v0 offset:36352
  v_xor_b32 v0, 12288, v0
  v_mfma_f32_16x16x32_bf16 v[32:35], a[152:155], v[116:119], v[32:35]
  buffer_load_dwordx4 v[64:67], v4, s[12:15], s84 offen offset:2048 sc1
  s_waitcnt lgkmcnt(3)
  v_mfma_f32_16x16x32_bf16 v[24:27], a[156:159], v[120:123], v[24:27]
  buffer_load_dwordx4 v[68:71], v4, s[12:15], s84 offen offset:3072 sc1
  ds_read_b64_tr_b16 v[116:117], v0 offset:49152
  v_mfma_f32_16x16x32_bf16 v[28:31], a[160:163], v[120:123], v[28:31]
  ds_read_b64_tr_b16 v[118:119], v0 offset:49664
  v_mfma_f32_16x16x32_bf16 v[32:35], a[164:167], v[120:123], v[32:35]
  s_add_u32 s84, s26, 4096
  buffer_load_dwordx4 v[72:75], v4, s[12:15], s84 offen offset:0 sc1
  s_waitcnt lgkmcnt(3)
  v_mfma_f32_16x16x32_bf16 v[24:27], a[168:171], v[124:127], v[24:27]
  ds_read_b64_tr_b16 v[120:121], v0 offset:50176
  v_mfma_f32_16x16x32_bf16 v[28:31], a[172:175], v[124:127], v[28:31]
  ds_read_b64_tr_b16 v[122:123], v0 offset:50688
  buffer_load_dwordx4 v[76:79], v4, s[12:15], s84 offen offset:1024 sc1
  v_mfma_f32_16x16x32_bf16 v[32:35], a[176:179], v[124:127], v[32:35]
  s_waitcnt lgkmcnt(4)
  v_mfma_f32_16x16x32_bf16 v[24:27], a[180:183], v[128:131], v[24:27]
  ds_read_b64_tr_b16 v[124:125], v0 offset:51200
  v_mfma_f32_16x16x32_bf16 v[28:31], a[184:187], v[128:131], v[28:31]
  ds_read_b64_tr_b16 v[126:127], v0 offset:51712
  v_mfma_f32_16x16x32_bf16 v[32:35], a[188:191], v[128:131], v[32:35]
  s_nop 7
  v_mul_f32 v12, 0xbb000000, v32
  v_mul_f32 v13, 0xbb000000, v32
  v_cndmask_b32 v20, v36, v37, s[60:61]
  s_nop 0
  v_permlane32_swap_b32 v12, v13
  v_cndmask_b32 v20, v20, v38, s[62:63]
  v_mov_b32 v12, v13
  v_cndmask_b32 v20, v20, v39, s[64:65]
  s_add_u32 s76, s24, 90112
  v_permlane16_swap_b32 v12, v13
  v_fmac_f32 v24, v13, v132
  v_fmac_f32_e64 v25, v13, v133
  v_cvt_pk_bf16_f32 v14, v24, v25
  v_pk_max_i16 v14, v14, 0
  s_waitcnt lgkmcnt(0)
  v_mfma_f32_16x16x32_bf16 v[40:43], a[0:3], v[116:119], 0
  ds_read_b64_tr_b16 v[128:129], v0 offset:52224
  v_fma_f32 v26, -v13, v134, -v26
  v_fma_f32 v27, -v13, v135, -v27
  v_mfma_f32_16x16x32_bf16 v[44:47], a[4:7], v[116:119], 0
  ds_read_b64_tr_b16 v[130:131], v0 offset:52736
  v_cvt_pk_bf16_f32 v15, v26, v27
  v_pk_max_u16 v15, v15, s75
  v_xor_b32 v0, 4096, v0
  v_mfma_f32_16x16x32_bf16 v[48:51], a[8:11], v[116:119], 0
  v_fma_f32 v28, -v13, v136, -v28
  v_fma_f32 v29, -v13, v137, -v29
  v_cvt_pk_bf16_f32 v16, v28, v29
  v_mfma_f32_16x16x32_bf16 v[52:55], v[116:119], v[116:119], 0
  v_pk_max_u16 v16, v16, s75
  v_fmac_f32_e64 v30, v13, v138
  v_mfma_f32_16x16x32_bf16 v[40:43], a[12:15], v[120:123], v[40:43]
  ds_read_b64_tr_b16 v[116:117], v0 offset:49152
  v_fmac_f32_e64 v31, v13, v139
  v_cvt_pk_bf16_f32 v17, v30, v31
  v_mfma_f32_16x16x32_bf16 v[44:47], a[16:19], v[120:123], v[44:47]
  ds_read_b64_tr_b16 v[118:119], v0 offset:49664
  v_pk_max_i16 v17, v17, 0
  v_mfma_f32_16x16x32_bf16 v[48:51], a[20:23], v[120:123], v[48:51]
  buffer_store_dwordx4 v[14:17], v4, s[12:15], s76 offen sc1
  s_add_u32 s76, s25, 90112
  v_fmac_f32 v32, v13, v140
  v_mfma_f32_16x16x32_bf16 v[52:55], v[120:123], v[120:123], v[52:55]
  v_fmac_f32 v33, v13, v141
  v_cvt_pk_bf16_f32 v18, v32, v33
  v_mfma_f32_16x16x32_bf16 v[40:43], a[24:27], v[124:127], v[40:43]
  ds_read_b64_tr_b16 v[120:121], v0 offset:50176
  v_pk_max_i16 v18, v18, 0
  v_fma_f32 v34, -v13, v142, -v34
  v_fma_f32 v35, -v13, v143, -v35
  v_mfma_f32_16x16x32_bf16 v[44:47], a[28:31], v[124:127], v[44:47]
  ds_read_b64_tr_b16 v[122:123], v0 offset:50688
  v_cvt_pk_bf16_f32 v19, v34, v35
  v_pk_max_u16 v19, v19, s75
  v_mfma_f32_16x16x32_bf16 v[48:51], a[32:35], v[124:127], v[48:51]
  buffer_store_dwordx2 v[18:19], v1, s[12:15], s76 offen sc1
  v_mfma_f32_16x16x32_bf16 v[52:55], v[124:127], v[124:127], v[52:55]
  ds_write_b32 v9, v20 offset:512
  ds_write_b32 v9, v13 offset:1536
  s_waitcnt lgkmcnt(4)
  v_mfma_f32_16x16x32_bf16 v[40:43], a[36:39], v[128:131], v[40:43]
  ds_read_b64_tr_b16 v[124:125], v0 offset:51200
  v_mfma_f32_16x16x32_bf16 v[44:47], a[40:43], v[128:131], v[44:47]
  ds_read_b64_tr_b16 v[126:127], v0 offset:51712
  v_mfma_f32_16x16x32_bf16 v[48:51], a[44:47], v[128:131], v[48:51]
  v_mfma_f32_16x16x32_bf16 v[52:55], v[128:131], v[128:131], v[52:55]
  v_mfma_f32_16x16x32_bf16 v[40:43], a[48:51], v[116:119], v[40:43]
  ds_read_b64_tr_b16 v[128:129], v0 offset:52224
  s_add_u32 s84, s26, 4096
  buffer_load_dwordx4 v[80:83], v4, s[12:15], s84 offen offset:2048 sc1
  v_mfma_f32_16x16x32_bf16 v[44:47], a[52:55], v[116:119], v[44:47]
  ds_read_b64_tr_b16 v[130:131], v0 offset:52736
  v_xor_b32 v0, 12288, v0
  v_mfma_f32_16x16x32_bf16 v[48:51], a[56:59], v[116:119], v[48:51]
  s_waitcnt lgkmcnt(4)
  v_mfma_f32_16x16x32_bf16 v[40:43], a[60:63], v[120:123], v[40:43]
  ds_read_b64_tr_b16 v[116:117], v0 offset:49152
  buffer_load_dwordx4 v[84:87], v4, s[12:15], s84 offen offset:3072 sc1
  v_mfma_f32_16x16x32_bf16 v[44:47], a[64:67], v[120:123], v[44:47]
  ds_read_b64_tr_b16 v[118:119], v0 offset:49664
  v_mfma_f32_16x16x32_bf16 v[48:51], a[68:71], v[120:123], v[48:51]
  s_add_u32 s84, s26, 8192
  buffer_load_dwordx2 v[88:89], v5, s[12:15], s84 offen offset:0 sc1
  s_waitcnt lgkmcnt(3)
  v_mfma_f32_16x16x32_bf16 v[40:43], a[72:75], v[124:127], v[40:43]
  ds_read_b64_tr_b16 v[120:121], v0 offset:50176
  v_mfma_f32_16x16x32_bf16 v[44:47], a[76:79], v[124:127], v[44:47]
  ds_read_b64_tr_b16 v[122:123], v0 offset:50688
  v_mfma_f32_16x16x32_bf16 v[48:51], a[80:83], v[124:127], v[48:51]
  buffer_load_dwordx2 v[90:91], v5, s[12:15], s84 offen offset:512 sc1
  s_waitcnt lgkmcnt(4)
  v_mfma_f32_16x16x32_bf16 v[40:43], a[84:87], v[128:131], v[40:43]
  ds_read_b64_tr_b16 v[124:125], v0 offset:51200
  v_mfma_f32_16x16x32_bf16 v[44:47], a[88:91], v[128:131], v[44:47]
  ds_read_b64_tr_b16 v[126:127], v0 offset:51712
  buffer_load_dwordx2 v[92:93], v5, s[12:15], s84 offen offset:1024 sc1
  v_mfma_f32_16x16x32_bf16 v[48:51], a[92:95], v[128:131], v[48:51]
  s_waitcnt lgkmcnt(4)
  v_mfma_f32_16x16x32_bf16 v[40:43], a[96:99], v[116:119], v[40:43]
  ds_read_b64_tr_b16 v[128:129], v0 offset:52224
  buffer_load_dwordx2 v[94:95], v5, s[12:15], s84 offen offset:1536 sc1
  v_mfma_f32_16x16x32_bf16 v[44:47], a[100:103], v[116:119], v[44:47]
  ds_read_b64_tr_b16 v[130:131], v0 offset:52736
  v_xor_b32 v0, 4096, v0
  v_mfma_f32_16x16x32_bf16 v[48:51], a[104:107], v[116:119], v[48:51]
  buffer_load_dwordx2 v[96:97], v5, s[12:15], s84 offen offset:2048 sc1
  s_waitcnt lgkmcnt(4)
  v_mfma_f32_16x16x32_bf16 v[40:43], a[108:111], v[120:123], v[40:43]
  ds_read_b64_tr_b16 v[116:117], v0 offset:49152
  v_mfma_f32_16x16x32_bf16 v[44:47], a[112:115], v[120:123], v[44:47]
  ds_read_b64_tr_b16 v[118:119], v0 offset:49664
  buffer_load_dwordx2 v[98:99], v5, s[12:15], s84 offen offset:2560 sc1
  v_mfma_f32_16x16x32_bf16 v[48:51], a[116:119], v[120:123], v[48:51]
  s_waitcnt lgkmcnt(4)
  v_mfma_f32_16x16x32_bf16 v[40:43], a[120:123], v[124:127], v[40:43]
  ds_read_b64_tr_b16 v[120:121], v0 offset:50176
  v_mfma_f32_16x16x32_bf16 v[44:47], a[124:127], v[124:127], v[44:47]
  ds_read_b64_tr_b16 v[122:123], v0 offset:50688
  v_mfma_f32_16x16x32_bf16 v[48:51], a[128:131], v[124:127], v[48:51]
  s_waitcnt lgkmcnt(4)
  v_mfma_f32_16x16x32_bf16 v[40:43], a[132:135], v[128:131], v[40:43]
  ds_read_b64_tr_b16 v[124:125], v0 offset:51200
  v_mfma_f32_16x16x32_bf16 v[44:47], a[136:139], v[128:131], v[44:47]
  ds_read_b64_tr_b16 v[126:127], v0 offset:51712
  v_mfma_f32_16x16x32_bf16 v[48:51], a[140:143], v[128:131], v[48:51]
  s_waitcnt lgkmcnt(4)
  v_mfma_f32_16x16x32_bf16 v[40:43], a[144:147], v[116:119], v[40:43]
  ds_read_b64_tr_b16 v[128:129], v0 offset:52224
  v_mfma_f32_16x16x32_bf16 v[44:47], a[148:151], v[116:119], v[44:47]
  ds_read_b64_tr_b16 v[130:131], v0 offset:52736
  s_waitcnt vmcnt(15)
  v_bitop3_b32 v22, v56, v57, v58 bitop3:0xf7
  v_xor_b32 v0, 12288, v0
  v_mfma_f32_16x16x32_bf16 v[48:51], a[152:155], v[116:119], v[48:51]
  s_waitcnt vmcnt(14)
  v_bitop3_b32 v22, v22, v59, v60 bitop3:0xfe
  s_waitcnt lgkmcnt(3)
  v_mfma_f32_16x16x32_bf16 v[40:43], a[156:159], v[120:123], v[40:43]
  s_add_u32 s84, s26, 45056
  buffer_load_dwordx4 v[100:103], v4, s[12:15], s84 offen offset:0 sc1
  v_bitop3_b32 v22, v22, v61, v62 bitop3:0xf7
  v_mfma_f32_16x16x32_bf16 v[44:47], a[160:163], v[120:123], v[44:47]
  s_waitcnt vmcnt(14)
  v_bitop3_b32 v22, v22, v63, v64 bitop3:0xfe
  v_bitop3_b32 v22, v22, v65, v66 bitop3:0xf7
  v_mfma_f32_16x16x32_bf16 v[48:51], a[164:167], v[120:123], v[48:51]
  s_waitcnt vmcnt(13)
  v_bitop3_b32 v22, v22, v67, v68 bitop3:0xfe
  s_waitcnt lgkmcnt(0)
  v_mfma_f32_16x16x32_bf16 v[40:43], a[168:171], v[124:127], v[40:43]
  v_bitop3_b32 v22, v22, v69, v70 bitop3:0xf7
  s_waitcnt vmcnt(12)
  v_bitop3_b32 v22, v22, v71, v72 bitop3:0xfe
  v_mfma_f32_16x16x32_bf16 v[44:47], a[172:175], v[124:127], v[44:47]
  buffer_load_dwordx4 v[104:107], v4, s[12:15], s84 offen offset:1024 sc1
  v_bitop3_b32 v22, v22, v73, v74 bitop3:0xf7
  v_mfma_f32_16x16x32_bf16 v[48:51], a[176:179], v[124:127], v[48:51]
  s_waitcnt vmcnt(12)
  v_bitop3_b32 v22, v22, v75, v76 bitop3:0xfe
  v_bitop3_b32 v22, v22, v77, v78 bitop3:0xf7
  v_mfma_f32_16x16x32_bf16 v[40:43], a[180:183], v[128:131], v[40:43]
  buffer_load_dwordx4 v[108:111], v4, s[12:15], s84 offen offset:2048 sc1
  v_bitop3_b32 v22, v22, v79, s75 bitop3:0xa8
  v_mfma_f32_16x16x32_bf16 v[44:47], a[184:187], v[128:131], v[44:47]
  v_cmp_ne_u32 vcc, 0, v22
  s_nop 0
  s_cbranch_vccnz Lretry26
Lback27:
  v_mfma_f32_16x16x32_bf16 v[48:51], a[188:191], v[128:131], v[48:51]
  buffer_load_dwordx4 v[112:115], v4, s[12:15], s84 offen offset:3072 sc1
  s_add_u32 s84, s26, 49152
  buffer_load_dwordx4 v[116:119], v4, s[12:15], s84 offen offset:0 sc1
  s_nop 4
  v_mul_f32 v12, 0xbb000000, v48
  v_mul_f32 v13, 0xbb000000, v48
  v_cndmask_b32 v20, v52, v53, s[60:61]
  v_mfma_f32_16x16x32_bf16 v[24:27], v[56:59], a[192:195], 0
  v_permlane32_swap_b32 v12, v13
  v_mfma_f32_16x16x32_bf16 v[28:31], v[56:59], a[196:199], 0
  v_cndmask_b32 v20, v20, v54, s[62:63]
  v_mov_b32 v12, v13
  v_mfma_f32_16x16x32_bf16 v[32:35], v[56:59], a[200:203], 0
  v_cndmask_b32 v20, v20, v55, s[64:65]
  s_add_u32 s76, s24, 135168
  v_permlane16_swap_b32 v12, v13
  v_mfma_f32_16x16x32_bf16 v[36:39], v[56:59], a[204:207], 0
  buffer_load_dwordx4 v[120:123], v4, s[12:15], s84 offen offset:1024 sc1
  v_fmac_f32_e64 v40, v13, v132
  v_mfma_f32_16x16x32_bf16 v[24:27], v[60:63], a[208:211], v[24:27]
  v_fmac_f32_e64 v41, v13, v133
  v_cvt_pk_bf16_f32 v14, v40, v41
  v_pk_max_i16 v14, v14, 0
  v_mfma_f32_16x16x32_bf16 v[28:31], v[60:63], a[212:215], v[28:31]
  v_fma_f32 v42, -v13, v134, -v42
  v_fma_f32 v43, -v13, v135, -v43
  v_mfma_f32_16x16x32_bf16 v[32:35], v[60:63], a[216:219], v[32:35]
  buffer_load_dwordx4 v[124:127], v4, s[12:15], s84 offen offset:2048 sc1
  v_cvt_pk_bf16_f32 v15, v42, v43
  v_pk_max_u16 v15, v15, s75
  v_mfma_f32_16x16x32_bf16 v[36:39], v[60:63], a[220:223], v[36:39]
  v_fma_f32 v44, -v13, v136, -v44
  v_fma_f32 v45, -v13, v137, -v45
  v_cvt_pk_bf16_f32 v16, v44, v45
  v_mfma_f32_16x16x32_bf16 v[24:27], v[64:67], a[224:227], v[24:27]
  v_pk_max_u16 v16, v16, s75
  v_fmac_f32_e64 v46, v13, v138
  v_mfma_f32_16x16x32_bf16 v[28:31], v[64:67], a[228:231], v[28:31]
  buffer_load_dwordx4 v[128:131], v4, s[12:15], s84 offen offset:3072 sc1
  v_fmac_f32_e64 v47, v13, v139
  v_cvt_pk_bf16_f32 v17, v46, v47
  v_mfma_f32_16x16x32_bf16 v[32:35], v[64:67], a[232:235], v[32:35]
  v_pk_max_i16 v17, v17, 0
  v_mfma_f32_16x16x32_bf16 v[36:39], v[64:67], a[236:239], v[36:39]
  buffer_store_dwordx4 v[14:17], v4, s[12:15], s76 offen sc1
  s_add_u32 s76, s25, 135168
  v_fmac_f32_e64 v48, v13, v140
  v_mfma_f32_16x16x32_bf16 v[24:27], v[68:71], a[240:243], v[24:27]
  v_fmac_f32_e64 v49, v13, v141
  v_cvt_pk_bf16_f32 v18, v48, v49
  v_mfma_f32_16x16x32_bf16 v[28:31], v[68:71], a[244:247], v[28:31]
  v_pk_max_i16 v18, v18, 0
  v_fma_f32 v50, -v13, v142, -v50
  v_fma_f32 v51, -v13, v143, -v51
  s_waitcnt vmcnt(16)
  v_bitop3_b32 v22, v80, v81, v82 bitop3:0xf7
  v_mfma_f32_16x16x32_bf16 v[32:35], v[68:71], a[248:251], v[32:35]
  v_cvt_pk_bf16_f32 v19, v50, v51
  v_pk_max_u16 v19, v19, s75
  s_waitcnt vmcnt(15)
  v_bitop3_b32 v22, v22, v83, v84 bitop3:0xfe
  v_mfma_f32_16x16x32_bf16 v[36:39], v[68:71], a[252:255], v[36:39]
  buffer_store_dwordx2 v[18:19], v1, s[12:15], s76 offen sc1
  s_add_u32 s84, s26, 53248
  buffer_load_dwordx2 v[132:133], v5, s[12:15], s84 offen offset:0 sc1
  v_bitop3_b32 v22, v22, v85, v86 bitop3:0xf7
  v_mfma_f32_16x16x32_bf16 v[24:27], v[72:75], v[144:147], v[24:27]
  ds_write_b32 v9, v20 offset:768
  ds_write_b32 v9, v13 offset:1792
  s_waitcnt vmcnt(16)
  v_bitop3_b32 v22, v22, v87, v88 bitop3:0xfe
  v_mfma_f32_16x16x32_bf16 v[28:31], v[72:75], v[148:151], v[28:31]
  s_waitcnt vmcnt(15)
  v_bitop3_b32 v22, v22, v89, v90 bitop3:0xfb
  v_mfma_f32_16x16x32_bf16 v[32:35], v[72:75], v[152:155], v[32:35]
  buffer_load_dwordx2 v[134:135], v5, s[12:15], s84 offen offset:512 sc1
  s_waitcnt vmcnt(15)
  v_bitop3_b32 v22, v22, v91, v92 bitop3:0xfb
  s_waitcnt vmcnt(14)
  v_bitop3_b32 v22, v22, v93, v94 bitop3:0xfb
  v_mfma_f32_16x16x32_bf16 v[36:39], v[72:75], v[156:159], v[36:39]
  s_waitcnt vmcnt(13)
  v_bitop3_b32 v22, v22, v95, v96 bitop3:0xfb
  v_mfma_f32_16x16x32_bf16 v[24:27], v[76:79], v[160:163], v[24:27]
  s_waitcnt vmcnt(12)
  v_bitop3_b32 v22, v22, v97, v98 bitop3:0xfb
  v_mfma_f32_16x16x32_bf16 v[28:31], v[76:79], v[164:167], v[28:31]
  buffer_load_dwordx2 v[136:137], v5, s[12:15], s84 offen offset:1024 sc1
  v_bitop3_b32 v22, v22, v99, s75 bitop3:0xa2
  v_mfma_f32_16x16x32_bf16 v[32:35], v[76:79], v[168:171], v[32:35]
  v_cmp_ne_u32_e64 vcc, 0, v22
  s_nop 0
  s_cbranch_vccnz Lretry28
Lback29:
  v_mfma_f32_16x16x32_bf16 v[36:39], v[76:79], v[172:175], v[36:39]
  buffer_load_dwordx2 v[138:139], v5, s[12:15], s84 offen offset:1536 sc1
  v_mfma_f32_16x16x32_bf16 v[24:27], v[80:83], v[176:179], v[24:27]
  v_mfma_f32_16x16x32_bf16 v[28:31], v[80:83], v[180:183], v[28:31]
  buffer_load_dwordx2 v[140:141], v5, s[12:15], s84 offen offset:2048 sc1
  v_mfma_f32_16x16x32_bf16 v[32:35], v[80:83], v[184:187], v[32:35]
  v_mfma_f32_16x16x32_bf16 v[36:39], v[80:83], v[188:191], v[36:39]
  buffer_load_dwordx2 v[142:143], v5, s[12:15], s84 offen offset:2560 sc1
  v_mfma_f32_16x16x32_bf16 v[24:27], v[84:87], v[192:195], v[24:27]
  v_mfma_f32_16x16x32_bf16 v[28:31], v[84:87], v[196:199], v[28:31]
  v_mfma_f32_16x16x32_bf16 v[32:35], v[84:87], v[200:203], v[32:35]
  v_mfma_f32_16x16x32_bf16 v[36:39], v[84:87], v[204:207], v[36:39]
  s_lshl_b32 s76, s3, 6
  v_mfma_f32_16x16x32_bf16 v[24:27], v[88:91], v[208:211], v[24:27]
  s_add_u32 s76, s76, 157696
  v_bfe_u32 v12, v4, 6, 2
  v_mfma_f32_16x16x32_bf16 v[28:31], v[88:91], v[212:215], v[28:31]
  v_and_b32 v13, 48, v4
  s_waitcnt vmcnt(15)
  v_bitop3_b32 v22, v100, v101, v102 bitop3:0xf7
  v_mfma_f32_16x16x32_bf16 v[32:35], v[88:91], v[216:219], v[32:35]
  s_waitcnt vmcnt(14)
  v_bitop3_b32 v22, v22, v103, v104 bitop3:0xfe
  v_lshlrev_b32_e64 v12, 8, v12
  v_mfma_f32_16x16x32_bf16 v[36:39], v[88:91], v[220:223], v[36:39]
  v_bitop3_b32 v22, v22, v105, v106 bitop3:0xf7
  v_add3_u32 v12, v12, v13, s76
  v_mfma_f32_16x16x32_bf16 v[24:27], v[92:95], v[224:227], v[24:27]
  s_waitcnt vmcnt(13)
  v_bitop3_b32 v22, v22, v107, v108 bitop3:0xfe
  s_waitcnt lgkmcnt(0)
  s_barrier
  v_bitop3_b32 v22, v22, v109, v110 bitop3:0xf7
  v_mfma_f32_16x16x32_bf16 v[28:31], v[92:95], v[228:231], v[28:31]
  ds_read_b128 v[14:17], v12
  s_waitcnt vmcnt(12)
  v_bitop3_b32 v22, v22, v111, v112 bitop3:0xfe
  v_mfma_f32_16x16x32_bf16 v[32:35], v[92:95], v[232:235], v[32:35]
  ds_read_b32 v13, v12 offset:1024
  v_bitop3_b32 v22, v22, v113, v114 bitop3:0xf7
  s_waitcnt vmcnt(11)
  v_bitop3_b32 v22, v22, v115, v116 bitop3:0xfe
  v_mfma_f32_16x16x32_bf16 v[36:39], v[92:95], v[236:239], v[36:39]
  s_add_u32 s84, s26, 90112
  buffer_load_dwordx4 v[56:59], v4, s[12:15], s84 offen offset:0 sc1
  v_bitop3_b32 v22, v22, v117, v118 bitop3:0xf7
  v_mfma_f32_16x16x32_bf16 v[24:27], v[96:99], v[240:243], v[24:27]
  s_waitcnt vmcnt(11)
  v_bitop3_b32 v22, v22, v119, v120 bitop3:0xfe
  v_bitop3_b32 v22, v22, v121, v122 bitop3:0xf7
  v_mfma_f32_16x16x32_bf16 v[28:31], v[96:99], v[244:247], v[28:31]
  v_bitop3_b32 v22, v22, v123, s75 bitop3:0xa8
  v_mfma_f32_16x16x32_bf16 v[32:35], v[96:99], v[248:251], v[32:35]
  buffer_load_dwordx4 v[60:63], v4, s[12:15], s84 offen offset:1024 sc1
  v_cmp_ne_u32 vcc, 0, v22
  s_nop 0
  s_cbranch_vccnz Lretry30
Lback31:
  v_mfma_f32_16x16x32_bf16 v[36:39], v[96:99], v[252:255], v[36:39]
  s_waitcnt lgkmcnt(0)
  v_add_f32 v14, v14, v15
  v_mfma_f32_16x16x32_bf16 v[40:43], v[100:103], a[192:195], 0
  buffer_load_dwordx4 v[64:67], v4, s[12:15], s84 offen offset:2048 sc1
  v_add_f32 v16, v16, v17
  v_mfma_f32_16x16x32_bf16 v[44:47], v[100:103], a[196:199], 0
  buffer_load_dwordx4 v[68:71], v4, s[12:15], s84 offen offset:3072 sc1
  v_mul_f32 v13, v13, v13
  v_mfma_f32_16x16x32_bf16 v[48:51], v[100:103], a[200:203], 0
  v_add_f32 v14, v14, v16
  v_mfma_f32_16x16x32_bf16 v[52:55], v[100:103], a[204:207], 0
  s_add_u32 s84, s26, 94208
  buffer_load_dwordx4 v[72:75], v4, s[12:15], s84 offen offset:0 sc1
  v_fmamk_f32 v13, v14, 0xbb000000, v13
  v_mfma_f32_16x16x32_bf16 v[40:43], v[104:107], a[208:211], v[40:43]
  v_min_f32 v13, 0, v13
  v_mfma_f32_16x16x32_bf16 v[44:47], v[104:107], a[212:215], v[44:47]
  buffer_load_dwordx4 v[76:79], v4, s[12:15], s84 offen offset:1024 sc1
  v_sub_f32 v13, s73, v13
  v_rsq_f32_e64 v10, v13
  ds_write_b128 v2, v[24:27] offset:0
  ds_write_b128 v2, v[28:31] offset:1024
  ds_write_b128 v2, v[32:35] offset:2048
  ds_write_b128 v2, v[36:39] offset:3072
  v_mfma_f32_16x16x32_bf16 v[48:51], v[104:107], a[216:219], v[48:51]
  ds_read_b64 v[12:13], v7 offset:0
  v_readlane_b32 s78, v10, 0
  v_readlane_b32 s79, v10, 1
  v_readlane_b32 s80, v10, 2
  v_readlane_b32 s81, v10, 3
  v_mfma_f32_16x16x32_bf16 v[52:55], v[104:107], a[220:223], v[52:55]
  s_waitcnt lgkmcnt(1)
  s_barrier
  v_mfma_f32_16x16x32_bf16 v[40:43], v[108:111], a[224:227], v[40:43]
  ds_read_b128 v[24:27], v6 offset:0
  ds_read_b128 v[28:31], v6 offset:4096
  ds_read_b128 v[32:35], v6 offset:8192
  v_mfma_f32_16x16x32_bf16 v[44:47], v[108:111], a[228:231], v[44:47]
  ds_read_b128 v[36:39], v6 offset:12288
  s_waitcnt lgkmcnt(4)
  v_lshlrev_b32 v14, 16, v12
  v_and_b32_e64 v15, s70, v12
  v_mfma_f32_16x16x32_bf16 v[48:51], v[108:111], a[232:235], v[48:51]
  v_lshlrev_b32 v16, 16, v13
  v_and_b32 v17, s70, v13
  v_mfma_f32_16x16x32_bf16 v[52:55], v[108:111], a[236:239], v[52:55]
  s_add_u32 s84, s26, 94208
  buffer_load_dwordx4 v[80:83], v4, s[12:15], s84 offen offset:2048 sc1
  v_mfma_f32_16x16x32_bf16 v[40:43], v[112:115], a[240:243], v[40:43]
  s_waitcnt lgkmcnt(2)
  v_add_f32 v24, v24, v28
  v_add_f32 v25, v25, v29
  v_add_f32 v26, v26, v30
  v_mfma_f32_16x16x32_bf16 v[44:47], v[112:115], a[244:247], v[44:47]
  v_add_f32 v27, v27, v31
  s_waitcnt lgkmcnt(0)
  v_add_f32 v32, v32, v36
  v_add_f32_e64 v33, v33, v37
  s_waitcnt vmcnt(16)
  v_bitop3_b32 v22, v124, v125, v126 bitop3:0xf7
  v_mfma_f32_16x16x32_bf16 v[48:51], v[112:115], a[248:251], v[48:51]
  buffer_load_dwordx4 v[84:87], v4, s[12:15], s84 offen offset:3072 sc1
  v_add_f32 v34, v34, v38
  v_add_f32 v35, v35, v39
  s_waitcnt vmcnt(16)
  v_bitop3_b32 v22, v22, v127, v128 bitop3:0xfe
  s_barrier
  v_mfma_f32_16x16x32_bf16 v[52:55], v[112:115], a[252:255], v[52:55]
  v_add_f32 v24, v24, v32
  v_add_f32 v25, v25, v33
  v_bitop3_b32 v22, v22, v129, v130 bitop3:0xf7
  v_add_f32 v26, v26, v34
  v_mfma_f32_16x16x32_bf16 v[40:43], v[116:119], v[144:147], v[40:43]
  v_add_f32_e64 v27, v27, v35
  s_waitcnt vmcnt(13)
  v_bitop3_b32 v22, v22, v131, v132 bitop3:0xfe
  v_fmac_f32_e64 v14, s78, v24
  v_fmac_f32_e64 v15, s79, v25
  v_mfma_f32_16x16x32_bf16 v[44:47], v[116:119], v[148:151], v[44:47]
  s_add_u32 s84, s26, 98304
  buffer_load_dwordx2 v[88:89], v5, s[12:15], s84 offen offset:0 sc1
  v_fmac_f32 v16, s80, v26
  s_waitcnt vmcnt(13)
  v_bitop3_b32 v22, v22, v133, v134 bitop3:0xfb
  v_fmac_f32 v17, s81, v27
  v_cvt_pk_bf16_f32 v18, v14, v15
  v_mfma_f32_16x16x32_bf16 v[48:51], v[116:119], v[152:155], v[48:51]
  s_waitcnt vmcnt(12)
  v_bitop3_b32 v22, v22, v135, v136 bitop3:0xfb
  v_cvt_pk_bf16_f32 v19, v16, v17
  v_min_u32_e64 v18, -2, v18
  s_waitcnt vmcnt(11)
  v_bitop3_b32 v22, v22, v137, v138 bitop3:0xfb
  s_add_u32 s76, s27, 0
  v_mfma_f32_16x16x32_bf16 v[52:55], v[116:119], v[156:159], v[52:55]
  buffer_store_dwordx2 v[18:19], v5, s[12:15], s76 offen sc1
  s_waitcnt vmcnt(11)
  v_bitop3_b32 v22, v22, v139, v140 bitop3:0xfb
  v_mul_f32 v24, v14, v14
  v_mfma_f32_16x16x32_bf16 v[40:43], v[120:123], v[160:163], v[40:43]
  buffer_load_dwordx2 v[90:91], v5, s[12:15], s84 offen offset:512 sc1
  v_mul_f32 v25, v15, v15
  s_waitcnt vmcnt(11)
  v_bitop3_b32 v22, v22, v141, v142 bitop3:0xfb
  v_mul_f32 v26, v16, v16
  v_mul_f32 v27, v17, v17
  v_mfma_f32_16x16x32_bf16 v[44:47], v[120:123], v[164:167], v[44:47]
  v_permlane32_swap_b32 v14, v16
  v_bitop3_b32 v22, v22, v143, s75 bitop3:0xa2
  v_permlane32_swap_b32 v15, v17
  v_mfma_f32_16x16x32_bf16 v[48:51], v[120:123], v[168:171], v[48:51]
  buffer_load_dwordx2 v[92:93], v5, s[12:15], s84 offen offset:1024 sc1
  v_cmp_ne_u32_e64 vcc, 0, v22
  v_permlane32_swap_b32 v24, v26
  s_cbranch_vccnz Lretry32
Lback33:
  v_mfma_f32_16x16x32_bf16 v[52:55], v[120:123], v[172:175], v[52:55]
  v_permlane32_swap_b32 v25, v27
  v_mfma_f32_16x16x32_bf16 v[40:43], v[124:127], v[176:179], v[40:43]
  v_add_f32 v14, v14, v16
  v_add_f32_e64 v15, v15, v17
  v_add_f32 v24, v24, v26
  v_mfma_f32_16x16x32_bf16 v[44:47], v[124:127], v[180:183], v[44:47]
  buffer_load_dwordx2 v[94:95], v5, s[12:15], s84 offen offset:1536 sc1
  v_add_f32_e64 v25, v25, v27
  v_permlane16_swap_b32 v14, v15
  v_mfma_f32_16x16x32_bf16 v[48:51], v[124:127], v[184:187], v[48:51]
  v_permlane16_swap_b32 v24, v25
  v_add_f32 v14, v14, v15
  v_mfma_f32_16x16x32_bf16 v[52:55], v[124:127], v[188:191], v[52:55]
  buffer_load_dwordx2 v[96:97], v5, s[12:15], s84 offen offset:2048 sc1
  v_add_f32_e64 v24, v24, v25
  s_add_u32 s76, s46, 0
  v_add_f32_dpp v14, v14, v14 row_ror:8 row_mask:0xf bank_mask:0xf
  v_mfma_f32_16x16x32_bf16 v[40:43], v[128:131], v[192:195], v[40:43]
  s_nop 0
  v_add_f32_dpp v14, v24, v24 row_ror:8 row_mask:0xf bank_mask:0xc
Lpad3:
  s_cbranch_execz Lpadret
  s_nop 0
  s_nop 1
  v_add_f32_dpp v14, v14, v14 row_half_mirror row_mask:0xf bank_mask:0xf
  s_nop 1
  v_add_f32_dpp v14, v14, v14 quad_perm:[2,3,0,1] row_mask:0xf bank_mask:0xf
  v_mfma_f32_16x16x32_bf16 v[44:47], v[128:131], v[196:199], v[44:47]
  buffer_load_dwordx2 v[98:99], v5, s[12:15], s84 offen offset:2560 sc1
  v_add_f32_dpp v14, v14, v14 quad_perm:[1,0,3,2] row_mask:0xf bank_mask:0xf
  v_cndmask_b32 v14, v14, 1.0, s[38:39]
  v_mfma_f32_16x16x32_bf16 v[48:51], v[128:131], v[200:203], v[48:51]
  buffer_atomic_add_f32 v14, v8, s[12:15], s76 offen sc1
  v_mfma_f32_16x16x32_bf16 v[52:55], v[128:131], v[204:207], v[52:55]
  v_mfma_f32_16x16x32_bf16 v[40:43], v[132:135], v[208:211], v[40:43]
  v_mfma_f32_16x16x32_bf16 v[44:47], v[132:135], v[212:215], v[44:47]
  s_waitcnt vmcnt(15)
  v_bitop3_b32 v22, v56, v57, v58 bitop3:0xf7
  v_mfma_f32_16x16x32_bf16 v[48:51], v[132:135], v[216:219], v[48:51]
  s_waitcnt vmcnt(14)
  v_bitop3_b32 v22, v22, v59, v60 bitop3:0xfe
  v_mfma_f32_16x16x32_bf16 v[52:55], v[132:135], v[220:223], v[52:55]
  s_add_u32 s84, s26, 135168
  buffer_load_dwordx4 v[100:103], v4, s[12:15], s84 offen offset:0 sc1
  v_bitop3_b32 v22, v22, v61, v62 bitop3:0xf7
  v_mfma_f32_16x16x32_bf16 v[40:43], v[136:139], v[224:227], v[40:43]
  s_waitcnt vmcnt(14)
  v_bitop3_b32 v22, v22, v63, v64 bitop3:0xfe
  v_bitop3_b32 v22, v22, v65, v66 bitop3:0xf7
  v_mfma_f32_16x16x32_bf16 v[44:47], v[136:139], v[228:231], v[44:47]
  s_waitcnt vmcnt(13)
  v_bitop3_b32 v22, v22, v67, v68 bitop3:0xfe
  v_mfma_f32_16x16x32_bf16 v[48:51], v[136:139], v[232:235], v[48:51]
  v_bitop3_b32 v22, v22, v69, v70 bitop3:0xf7
  s_waitcnt vmcnt(12)
  v_bitop3_b32 v22, v22, v71, v72 bitop3:0xfe
  v_mfma_f32_16x16x32_bf16 v[52:55], v[136:139], v[236:239], v[52:55]
  buffer_load_dwordx4 v[104:107], v4, s[12:15], s84 offen offset:1024 sc1
  v_bitop3_b32 v22, v22, v73, v74 bitop3:0xf7
  v_mfma_f32_16x16x32_bf16 v[40:43], v[140:143], v[240:243], v[40:43]
  s_waitcnt vmcnt(12)
  v_bitop3_b32 v22, v22, v75, v76 bitop3:0xfe
  v_bitop3_b32 v22, v22, v77, v78 bitop3:0xf7
  v_mfma_f32_16x16x32_bf16 v[44:47], v[140:143], v[244:247], v[44:47]
  buffer_load_dwordx4 v[108:111], v4, s[12:15], s84 offen offset:2048 sc1
  v_bitop3_b32 v22, v22, v79, s75 bitop3:0xa8
  v_mfma_f32_16x16x32_bf16 v[48:51], v[140:143], v[248:251], v[48:51]
  v_cmp_ne_u32_e64 vcc, 0, v22
  s_nop 0
  s_cbranch_vccnz Lretry34
Lback35:
  v_mfma_f32_16x16x32_bf16 v[52:55], v[140:143], v[252:255], v[52:55]
  v_mfma_f32_16x16x32_bf16 v[24:27], v[56:59], a[192:195], 0
  buffer_load_dwordx4 v[112:115], v4, s[12:15], s84 offen offset:3072 sc1
  v_mfma_f32_16x16x32_bf16 v[28:31], v[56:59], a[196:199], 0
  v_mfma_f32_16x16x32_bf16 v[32:35], v[56:59], a[200:203], 0
  s_add_u32 s84, s26, 139264
  buffer_load_dwordx4 v[116:119], v4, s[12:15], s84 offen offset:0 sc1
  v_mfma_f32_16x16x32_bf16 v[36:39], v[56:59], a[204:207], 0
  ds_write_b128 v2, v[40:43] offset:0
  v_mfma_f32_16x16x32_bf16 v[24:27], v[60:63], a[208:211], v[24:27]
  v_mfma_f32_16x16x32_bf16 v[28:31], v[60:63], a[212:215], v[28:31]
  ds_write_b128 v2, v[44:47] offset:1024
  buffer_load_dwordx4 v[120:123], v4, s[12:15], s84 offen offset:1024 sc1
  v_mfma_f32_16x16x32_bf16 v[32:35], v[60:63], a[216:219], v[32:35]
  ds_write_b128 v2, v[48:51] offset:2048
  v_mfma_f32_16x16x32_bf16 v[36:39], v[60:63], a[220:223], v[36:39]
  ds_write_b128 v2, v[52:55] offset:3072
  v_mfma_f32_16x16x32_bf16 v[24:27], v[64:67], a[224:227], v[24:27]
  ds_read_b64 v[12:13], v7 offset:16384
  v_mfma_f32_16x16x32_bf16 v[28:31], v[64:67], a[228:231], v[28:31]
  v_readlane_b32 s78, v10, 4
  v_readlane_b32 s79, v10, 5
  v_mfma_f32_16x16x32_bf16 v[32:35], v[64:67], a[232:235], v[32:35]
  v_readlane_b32 s80, v10, 6
  v_readlane_b32 s81, v10, 7
  v_mfma_f32_16x16x32_bf16 v[36:39], v[64:67], a[236:239], v[36:39]
  s_waitcnt lgkmcnt(1)
  s_barrier
  v_mfma_f32_16x16x32_bf16 v[24:27], v[68:71], a[240:243], v[24:27]
  ds_read_b128 v[40:43], v6 offset:0
  ds_read_b128 v[44:47], v6 offset:4096
  ds_read_b128 v[48:51], v6 offset:8192
  v_mfma_f32_16x16x32_bf16 v[28:31], v[68:71], a[244:247], v[28:31]
  ds_read_b128 v[52:55], v6 offset:12288
  s_waitcnt lgkmcnt(4)
  v_lshlrev_b32 v14, 16, v12
  s_waitcnt vmcnt(15)
  v_bitop3_b32 v22, v80, v81, v82 bitop3:0xf7
  v_mfma_f32_16x16x32_bf16 v[32:35], v[68:71], a[248:251], v[32:35]
  v_and_b32 v15, s70, v12
  v_lshlrev_b32 v16, 16, v13
  s_waitcnt vmcnt(14)
  v_bitop3_b32 v22, v22, v83, v84 bitop3:0xfe
  v_and_b32_e64 v17, s70, v13
  v_mfma_f32_16x16x32_bf16 v[36:39], v[68:71], a[252:255], v[36:39]
  s_add_u32 s84, s26, 139264
  buffer_load_dwordx4 v[124:127], v4, s[12:15], s84 offen offset:2048 sc1
  v_bitop3_b32 v22, v22, v85, v86 bitop3:0xf7
  v_mfma_f32_16x16x32_bf16 v[24:27], v[72:75], v[144:147], v[24:27]
  s_waitcnt vmcnt(14)
  v_bitop3_b32 v22, v22, v87, v88 bitop3:0xfe
  s_waitcnt lgkmcnt(0)
  v_add_f32 v40, v40, v44
  v_add_f32 v41, v41, v45
  v_mfma_f32_16x16x32_bf16 v[28:31], v[72:75], v[148:151], v[28:31]
  s_waitcnt vmcnt(12)
  v_bitop3_b32 v22, v22, v89, v90 bitop3:0xfb
  v_add_f32 v42, v42, v46
  v_add_f32_e64 v43, v43, v47
  v_mfma_f32_16x16x32_bf16 v[32:35], v[72:75], v[152:155], v[32:35]
  buffer_load_dwordx4 v[128:131], v4, s[12:15], s84 offen offset:3072 sc1
  s_waitcnt vmcnt(12)
  v_bitop3_b32 v22, v22, v91, v92 bitop3:0xfb
  v_add_f32_e64 v48, v48, v52
  v_add_f32 v49, v49, v53
  s_waitcnt vmcnt(11)
  v_bitop3_b32 v22, v22, v93, v94 bitop3:0xfb
  v_add_f32 v50, v50, v54
  v_mfma_f32_16x16x32_bf16 v[36:39], v[72:75], v[156:159], v[36:39]
  v_add_f32 v51, v51, v55
  s_waitcnt vmcnt(10)
  v_bitop3_b32 v22, v22, v95, v96 bitop3:0xfb
  s_barrier
  v_add_f32 v40, v40, v48
  v_mfma_f32_16x16x32_bf16 v[24:27], v[76:79], v[160:163], v[24:27]
  s_add_u32 s84, s26, 143360
  buffer_load_dwordx2 v[132:133], v5, s[12:15], s84 offen offset:0 sc1
  v_add_f32 v41, v41, v49
  s_waitcnt vmcnt(10)
  v_bitop3_b32 v22, v22, v97, v98 bitop3:0xfb
  v_add_f32_e64 v42, v42, v50
  v_mfma_f32_16x16x32_bf16 v[28:31], v[76:79], v[164:167], v[28:31]
  v_add_f32 v43, v43, v51
  v_bitop3_b32 v22, v22, v99, s75 bitop3:0xa2
  v_fmac_f32 v14, s78, v40
  v_mfma_f32_16x16x32_bf16 v[32:35], v[76:79], v[168:171], v[32:35]
  buffer_load_dwordx2 v[134:135], v5, s[12:15], s84 offen offset:512 sc1
  v_fmac_f32 v15, s79, v41
  v_cmp_ne_u32 vcc, 0, v22
  v_fmac_f32 v16, s80, v42
  v_fmac_f32_e64 v17, s81, v43
  s_cbranch_vccnz Lretry36
Lback37:
  v_mfma_f32_16x16x32_bf16 v[36:39], v[76:79], v[172:175], v[36:39]
  v_cvt_pk_bf16_f32 v18, v14, v15
  v_cvt_pk_bf16_f32 v19, v16, v17
  v_mfma_f32_16x16x32_bf16 v[24:27], v[80:83], v[176:179], v[24:27]
  buffer_load_dwordx2 v[136:137], v5, s[12:15], s84 offen offset:1024 sc1
  v_min_u32_e64 v18, -2, v18
  s_add_u32 s76, s27, 65536
  v_mfma_f32_16x16x32_bf16 v[28:31], v[80:83], v[180:183], v[28:31]
  buffer_store_dwordx2 v[18:19], v5, s[12:15], s76 offen sc1
  v_mul_f32 v40, v14, v14
  v_mul_f32 v41, v15, v15
  v_mfma_f32_16x16x32_bf16 v[32:35], v[80:83], v[184:187], v[32:35]
  buffer_load_dwordx2 v[138:139], v5, s[12:15], s84 offen offset:1536 sc1
  v_mul_f32 v42, v16, v16
  v_mul_f32 v43, v17, v17
  v_mfma_f32_16x16x32_bf16 v[36:39], v[80:83], v[188:191], v[36:39]
  v_permlane32_swap_b32 v14, v16
  v_permlane32_swap_b32 v15, v17
  v_mfma_f32_16x16x32_bf16 v[24:27], v[84:87], v[192:195], v[24:27]
  buffer_load_dwordx2 v[140:141], v5, s[12:15], s84 offen offset:2048 sc1
  v_permlane32_swap_b32 v40, v42
  v_mfma_f32_16x16x32_bf16 v[28:31], v[84:87], v[196:199], v[28:31]
  buffer_load_dwordx2 v[142:143], v5, s[12:15], s84 offen offset:2560 sc1
  v_permlane32_swap_b32 v41, v43
  v_mfma_f32_16x16x32_bf16 v[32:35], v[84:87], v[200:203], v[32:35]
  v_add_f32 v14, v14, v16
  v_add_f32 v15, v15, v17
  v_mfma_f32_16x16x32_bf16 v[36:39], v[84:87], v[204:207], v[36:39]
  v_add_f32 v40, v40, v42
  v_add_f32 v41, v41, v43
  v_permlane16_swap_b32 v14, v15
  v_mfma_f32_16x16x32_bf16 v[24:27], v[88:91], v[208:211], v[24:27]
  v_permlane16_swap_b32 v40, v41
  v_mfma_f32_16x16x32_bf16 v[28:31], v[88:91], v[212:215], v[28:31]
  v_add_f32 v14, v14, v15
  v_add_f32 v40, v40, v41
  s_waitcnt vmcnt(14)
  v_bitop3_b32 v22, v100, v101, v102 bitop3:0xf7
  v_mfma_f32_16x16x32_bf16 v[32:35], v[88:91], v[216:219], v[32:35]
  s_add_u32 s76, s46, 8192
  v_add_f32_dpp v14, v14, v14 row_ror:8 row_mask:0xf bank_mask:0xf
  s_waitcnt vmcnt(13)
  v_bitop3_b32 v22, v22, v103, v104 bitop3:0xfe
  v_add_f32_dpp v14, v40, v40 row_ror:8 row_mask:0xf bank_mask:0xc
  v_mfma_f32_16x16x32_bf16 v[36:39], v[88:91], v[220:223], v[36:39]
  s_nop 0
  v_add_f32_dpp v14, v14, v14 row_half_mirror row_mask:0xf bank_mask:0xf
  v_bitop3_b32 v22, v22, v105, v106 bitop3:0xf7
  s_nop 0
  v_add_f32_dpp v14, v14, v14 quad_perm:[2,3,0,1] row_mask:0xf bank_mask:0xf
  v_mfma_f32_16x16x32_bf16 v[24:27], v[92:95], v[224:227], v[24:27]
  s_waitcnt vmcnt(12)
  v_bitop3_b32 v22, v22, v107, v108 bitop3:0xfe
  v_add_f32_dpp v14, v14, v14 quad_perm:[1,0,3,2] row_mask:0xf bank_mask:0xf
  v_cndmask_b32 v14, v14, 1.0, s[38:39]
  v_bitop3_b32 v22, v22, v109, v110 bitop3:0xf7
  v_mfma_f32_16x16x32_bf16 v[28:31], v[92:95], v[228:231], v[28:31]
  buffer_atomic_add_f32 v14, v8, s[12:15], s76 offen sc1
  s_waitcnt vmcnt(12)
  v_bitop3_b32 v22, v22, v111, v112 bitop3:0xfe
  v_mfma_f32_16x16x32_bf16 v[32:35], v[92:95], v[232:235], v[32:35]
  v_bitop3_b32 v22, v22, v113, v114 bitop3:0xf7
  s_waitcnt vmcnt(11)
  v_bitop3_b32 v22, v22, v115, v116 bitop3:0xfe
  v_mfma_f32_16x16x32_bf16 v[36:39], v[92:95], v[236:239], v[36:39]
  v_bitop3_b32 v22, v22, v117, v118 bitop3:0xf7
  v_mfma_f32_16x16x32_bf16 v[24:27], v[96:99], v[240:243], v[24:27]
  s_waitcnt vmcnt(10)
  v_bitop3_b32 v22, v22, v119, v120 bitop3:0xfe
  v_bitop3_b32 v22, v22, v121, v122 bitop3:0xf7
  v_mfma_f32_16x16x32_bf16 v[28:31], v[96:99], v[244:247], v[28:31]
  v_bitop3_b32 v22, v22, v123, s75 bitop3:0xa8
  v_mfma_f32_16x16x32_bf16 v[32:35], v[96:99], v[248:251], v[32:35]
  v_cmp_ne_u32_e64 vcc, 0, v22
  s_nop 0
  s_cbranch_vccnz Lretry38
Lback39:
  v_mfma_f32_16x16x32_bf16 v[36:39], v[96:99], v[252:255], v[36:39]
  s_lshr_b32 s90, s3, 1
  s_and_b32 s91, s3, 1
  s_lshl_b32 s91, s91, 8
  s_mul_i32 s92, s90, 33280
  s_add_u32 s92, s92, s91
  s_add_u32 s92, s92, 65584
  s_mul_i32 s90, s90, 4608
  s_sub_u32 s90, s90, s91
  s_add_u32 s90, s90, 132384
  v_bfe_u32 v92, v3, 4, 1
  v_lshrrev_b32 v93, 5, v3
  v_lshlrev_b32_e64 v61, 9, v93
  v_lshl_add_u32 v61, v92, 3, v61
  v_mul_u32_u24_e64 v63, 64, v93
  v_lshl_add_u32 v63, v92, 5, v63
  v_mul_u32_u24 v58, 4608, v92
  v_mfma_f32_16x16x32_bf16 v[40:43], v[100:103], a[192:195], 0
  ds_write_b128 v2, v[24:27] offset:0
  v_lshl_add_u32 v58, v93, 3, v58
  v_mfma_f32_16x16x32_bf16 v[44:47], v[100:103], a[196:199], 0
  v_add_u32 v58, 132608, v58
  v_lshlrev_b32_e64 v94, 4, v92
  v_mfma_f32_16x16x32_bf16 v[48:51], v[100:103], a[200:203], 0
  ds_write_b128 v2, v[28:31] offset:1024
  v_sub_u32_e64 v94, 16, v94
  v_mfma_f32_16x16x32_bf16 v[52:55], v[100:103], a[204:207], 0
  ds_write_b128 v2, v[32:35] offset:2048
  v_lshlrev_b32_e64 v62, v94, s66
  v_and_b32_e64 v62, s70, v62
  v_mfma_f32_16x16x32_bf16 v[40:43], v[104:107], a[208:211], v[40:43]
  ds_write_b128 v2, v[36:39] offset:3072
  v_and_b32_e64 v93, 3, v93
  v_mfma_f32_16x16x32_bf16 v[44:47], v[104:107], a[212:215], v[44:47]
  ds_read_b64 v[12:13], v7 offset:32768
  v_lshrrev_b32_e64 v94, 7, v3
  v_readlane_b32 s78, v10, 8
  v_readlane_b32 s79, v10, 9
  v_mfma_f32_16x16x32_bf16 v[48:51], v[104:107], a[216:219], v[48:51]
  v_lshlrev_b32_e64 v60, 14, v94
  v_readlane_b32 s80, v10, 10
  v_readlane_b32 s81, v10, 11
  v_lshl_add_u32 v60, v92, 5, v60
  v_mfma_f32_16x16x32_bf16 v[52:55], v[104:107], a[220:223], v[52:55]
  v_lshl_add_u32 v60, v93, 3, v60
  s_waitcnt lgkmcnt(1)
  s_barrier
  v_mfma_f32_16x16x32_bf16 v[40:43], v[108:111], a[224:227], v[40:43]
  ds_read_b128 v[24:27], v6 offset:0
  ds_read_b128 v[28:31], v6 offset:4096
  ds_read_b128 v[32:35], v6 offset:8192
  v_lshlrev_b32_e64 v59, 13, v92
  v_lshl_add_u32 v59, v93, 8, v59
  v_mfma_f32_16x16x32_bf16 v[44:47], v[108:111], a[228:231], v[44:47]
  ds_read_b128 v[36:39], v6 offset:12288
  s_add_u32 s84, s7, 8388608
  buffer_load_dwordx2 v[68:69], v61, s[12:15], s84 offen sc1
  s_waitcnt lgkmcnt(4)
  v_lshlrev_b32 v14, 16, v12
  v_lshlrev_b32_e64 v93, 2, v93
  v_and_b32_e64 v15, s70, v12
  v_mfma_f32_16x16x32_bf16 v[48:51], v[108:111], a[232:235], v[48:51]
  v_lshlrev_b32_e64 v16, 16, v13
  v_and_b32 v92, 15, v94
  v_and_b32 v17, s70, v13
  v_mfma_f32_16x16x32_bf16 v[52:55], v[108:111], a[236:239], v[52:55]
  s_mov_b32 s84, 3080192
  buffer_load_dwordx4 v[72:75], v63, s[12:15], s84 offen sc1
  v_xor_b32 v92, v92, v93
  v_lshl_add_u32 v59, v92, 4, v59
  v_mfma_f32_16x16x32_bf16 v[40:43], v[112:115], a[240:243], v[40:43]
  s_waitcnt lgkmcnt(0)
  v_add_f32 v24, v24, v28
  v_add_f32 v25, v25, v29
  v_lshrrev_b32 v94, 4, v94
  v_add_f32 v26, v26, v30
  v_mfma_f32_16x16x32_bf16 v[44:47], v[112:115], a[244:247], v[44:47]
  buffer_load_dwordx4 v[76:79], v63, s[12:15], s84 offen offset:16 sc1
  v_add_f32 v27, v27, v31
  v_lshl_add_u32 v59, v94, 10, v59
  v_add_f32 v32, v32, v36
  v_add_f32 v33, v33, v37
  s_waitcnt vmcnt(12)
  v_bitop3_b32 v22, v124, v125, v126 bitop3:0xf7
  v_mfma_f32_16x16x32_bf16 v[48:51], v[112:115], a[248:251], v[48:51]
  v_add_u32 v59, 141312, v59
  v_add_f32 v34, v34, v38
  v_add_f32 v35, v35, v39
  v_bfe_u32 v92, v5, 3, 3
  s_waitcnt vmcnt(11)
  v_bitop3_b32 v22, v22, v127, v128 bitop3:0xfe
  s_barrier
  v_mfma_f32_16x16x32_bf16 v[52:55], v[112:115], a[252:255], v[52:55]
  v_add_f32 v24, v24, v32
  v_add_f32 v25, v25, v33
  v_mul_u32_u24 v56, 4160, v92
  v_bitop3_b32 v22, v22, v129, v130 bitop3:0xf7
  v_add_f32 v26, v26, v34
  v_mfma_f32_16x16x32_bf16 v[40:43], v[116:119], v[144:147], v[40:43]
  v_add_f32 v27, v27, v35
  v_bfe_u32 v92, v5, 6, 1
  s_waitcnt vmcnt(10)
  v_bitop3_b32 v22, v22, v131, v132 bitop3:0xfe
  v_fmac_f32 v14, s78, v24
  v_fmac_f32 v15, s79, v25
  v_lshrrev_b32 v93, 7, v5
  v_mfma_f32_16x16x32_bf16 v[44:47], v[116:119], v[148:151], v[44:47]
  v_fmac_f32 v16, s80, v26
  s_waitcnt vmcnt(9)
  v_bitop3_b32 v22, v22, v133, v134 bitop3:0xfb
  v_fmac_f32_e64 v17, s81, v27
  v_sub_u32 v92, v92, v93
  v_cvt_pk_bf16_f32 v18, v14, v15
  v_mfma_f32_16x16x32_bf16 v[48:51], v[116:119], v[152:155], v[48:51]
  s_waitcnt vmcnt(8)
  v_bitop3_b32 v22, v22, v135, v136 bitop3:0xfb
  v_cvt_pk_bf16_f32 v19, v16, v17
  v_lshlrev_b32 v92, 4, v92
  v_min_u32_e64 v18, -2, v18
  s_waitcnt vmcnt(6)
  v_bitop3_b32 v22, v22, v137, v138 bitop3:0xfb
  s_add_u32 s76, s27, 131072
  v_mfma_f32_16x16x32_bf16 v[52:55], v[116:119], v[156:159], v[52:55]
  buffer_store_dwordx2 v[18:19], v5, s[12:15], s76 offen sc1
  v_add3_u32 v56, v56, v92, s92
  s_waitcnt vmcnt(6)
  v_bitop3_b32 v22, v22, v139, v140 bitop3:0xfb
  v_bfe_u32 v92, v5, 3, 4
  v_mul_f32 v24, v14, v14
  v_mfma_f32_16x16x32_bf16 v[40:43], v[120:123], v[160:163], v[40:43]
  v_mul_f32 v25, v15, v15
  s_waitcnt vmcnt(5)
  v_bitop3_b32 v22, v22, v141, v142 bitop3:0xfb
  v_lshlrev_b32 v92, 5, v92
  v_mul_f32 v26, v16, v16
  v_mul_f32_e64 v27, v17, v17
  v_mfma_f32_16x16x32_bf16 v[44:47], v[120:123], v[164:167], v[44:47]
  v_lshlrev_b32_e64 v93, 4, v93
  v_permlane32_swap_b32 v14, v16
  v_bitop3_b32 v22, v22, v143, s75 bitop3:0xa2
  v_permlane32_swap_b32 v15, v17
  v_add3_u32 v57, v92, v93, s90
  v_mfma_f32_16x16x32_bf16 v[48:51], v[120:123], v[168:171], v[48:51]
  v_cmp_ne_u32_e64 vcc, 0, v22
  v_permlane32_swap_b32 v24, v26
  s_cbranch_vccnz Lretry40
Lback41:
  v_mfma_f32_16x16x32_bf16 v[52:55], v[120:123], v[172:175], v[52:55]
  v_permlane32_swap_b32 v25, v27
  v_mfma_f32_16x16x32_bf16 v[40:43], v[124:127], v[176:179], v[40:43]
  v_add_f32 v14, v14, v16
  v_add_f32_e64 v15, v15, v17
  v_add_f32 v24, v24, v26
  v_mfma_f32_16x16x32_bf16 v[44:47], v[124:127], v[180:183], v[44:47]
  v_add_f32_e64 v25, v25, v27
  v_permlane16_swap_b32 v14, v15
  v_mfma_f32_16x16x32_bf16 v[48:51], v[124:127], v[184:187], v[48:51]
  v_permlane16_swap_b32 v24, v25
  v_add_f32_e64 v14, v14, v15
  v_mfma_f32_16x16x32_bf16 v[52:55], v[124:127], v[188:191], v[52:55]
  v_add_f32 v24, v24, v25
  s_add_u32 s76, s46, 16384
  v_add_f32_dpp v14, v14, v14 row_ror:8 row_mask:0xf bank_mask:0xf
  v_mfma_f32_16x16x32_bf16 v[40:43], v[128:131], v[192:195], v[40:43]
  s_nop 0
  v_add_f32_dpp v14, v24, v24 row_ror:8 row_mask:0xf bank_mask:0xc
  s_nop 1
  v_add_f32_dpp v14, v14, v14 row_half_mirror row_mask:0xf bank_mask:0xf
  s_nop 1
  v_add_f32_dpp v14, v14, v14 quad_perm:[2,3,0,1] row_mask:0xf bank_mask:0xf
  v_mfma_f32_16x16x32_bf16 v[44:47], v[128:131], v[196:199], v[44:47]
  s_nop 0
  v_add_f32_dpp v14, v14, v14 quad_perm:[1,0,3,2] row_mask:0xf bank_mask:0xf
  v_cndmask_b32 v14, v14, 1.0, s[38:39]
  v_mfma_f32_16x16x32_bf16 v[48:51], v[128:131], v[200:203], v[48:51]
  buffer_atomic_add_f32 v14, v8, s[12:15], s76 offen sc1
  v_mfma_f32_16x16x32_bf16 v[52:55], v[128:131], v[204:207], v[52:55]
  v_mfma_f32_16x16x32_bf16 v[40:43], v[132:135], v[208:211], v[40:43]
  v_mfma_f32_16x16x32_bf16 v[44:47], v[132:135], v[212:215], v[44:47]
  v_mfma_f32_16x16x32_bf16 v[48:51], v[132:135], v[216:219], v[48:51]
  v_mfma_f32_16x16x32_bf16 v[52:55], v[132:135], v[220:223], v[52:55]
  v_mfma_f32_16x16x32_bf16 v[40:43], v[136:139], v[224:227], v[40:43]
  v_mfma_f32_16x16x32_bf16 v[44:47], v[136:139], v[228:231], v[44:47]
  v_mfma_f32_16x16x32_bf16 v[48:51], v[136:139], v[232:235], v[48:51]
  v_mfma_f32_16x16x32_bf16 v[52:55], v[136:139], v[236:239], v[52:55]
  v_mfma_f32_16x16x32_bf16 v[40:43], v[140:143], v[240:243], v[40:43]
  v_mfma_f32_16x16x32_bf16 v[44:47], v[140:143], v[244:247], v[44:47]
  v_mfma_f32_16x16x32_bf16 v[48:51], v[140:143], v[248:251], v[48:51]
  v_mfma_f32_16x16x32_bf16 v[52:55], v[140:143], v[252:255], v[52:55]
  s_nop 4
  ds_write_b128 v2, v[40:43] offset:0
  ds_write_b128 v2, v[44:47] offset:1024
  ds_write_b128 v2, v[48:51] offset:2048
  ds_write_b128 v2, v[52:55] offset:3072
  ds_read_b64 v[12:13], v7 offset:49152
  v_readlane_b32 s78, v10, 12
  v_readlane_b32 s79, v10, 13
  v_readlane_b32 s80, v10, 14
  v_readlane_b32 s81, v10, 15
  s_waitcnt lgkmcnt(1)
  s_barrier
  s_waitcnt vmcnt(2)
  v_min_f32 v75, v74, v78
  v_cmp_eq_u32 s[100:101], -1, v68
  v_cmp_neq_f32 s[98:99], s67, v75
  s_nop 0
  s_or_b64 s[98:99], s[98:99], s[100:101]
  s_cbranch_scc1 Lretry10
Lback11:
  v_mul_f32 v72, 0x3b000000, v72
  v_mul_f32 v76, 0x3b000000, v76
  v_fma_f32 v74, v72, v72, -s73
  v_fma_f32 v75, v76, v76, -s73
  v_fmamk_f32 v73, v73, 0xbb000000, v74
  v_fmamk_f32 v77, v77, 0xbb000000, v75
  v_max_f32_e64 v73, -v73, s73
  v_max_f32_e64 v77, -v77, s73
  v_rsq_f32 v73, v73
  v_rsq_f32 v77, v77
  v_lshlrev_b32 v88, 16, v68
  v_and_b32 v89, s70, v68
  v_lshlrev_b32 v90, 16, v69
  v_and_b32 v91, s70, v69
  v_subrev_f32_dpp v74, v72, v88 quad_perm:[0,0,2,2] row_mask:0xf bank_mask:0xf
  v_subrev_f32_dpp v75, v76, v89 quad_perm:[0,0,2,2] row_mask:0xf bank_mask:0xf
  v_subrev_f32_dpp v78, v72, v90 quad_perm:[1,1,3,3] row_mask:0xf bank_mask:0xf
  v_subrev_f32_dpp v79, v76, v91 quad_perm:[1,1,3,3] row_mask:0xf bank_mask:0xf
  v_mul_f32_dpp v74, v73, v74 quad_perm:[0,0,2,2] row_mask:0xf bank_mask:0xf
  v_mul_f32_dpp v75, v77, v75 quad_perm:[0,0,2,2] row_mask:0xf bank_mask:0xf
  v_mul_f32_dpp v78, v73, v78 quad_perm:[1,1,3,3] row_mask:0xf bank_mask:0xf
  v_mul_f32_dpp v79, v77, v79 quad_perm:[1,1,3,3] row_mask:0xf bank_mask:0xf
  v_cvt_pk_bf16_f32 v68, v74, v75
  v_cvt_pk_bf16_f32 v69, v78, v79
  ds_read_b128 v[40:43], v6 offset:0
  ds_read_b128 v[44:47], v6 offset:4096
  ds_read_b128 v[48:51], v6 offset:8192
  ds_read_b128 v[52:55], v6 offset:12288
  s_waitcnt lgkmcnt(4)
  v_lshlrev_b32 v14, 16, v12
  v_and_b32 v15, s70, v12
  v_lshlrev_b32 v16, 16, v13
  v_and_b32 v17, s70, v13
  s_waitcnt lgkmcnt(2)
  v_add_f32 v40, v40, v44
  v_add_f32 v41, v41, v45
  v_add_f32 v42, v42, v46
  v_add_f32 v43, v43, v47
  s_waitcnt lgkmcnt(0)
  v_add_f32 v48, v48, v52
  v_add_f32 v49, v49, v53
  v_add_f32 v50, v50, v54
  v_add_f32 v51, v51, v55
  s_barrier
  v_add_f32 v40, v40, v48
  v_add_f32 v41, v41, v49
  v_add_f32 v42, v42, v50
  v_add_f32 v43, v43, v51
  v_fmac_f32 v14, s78, v40
  v_fmac_f32 v15, s79, v41
  v_fmac_f32 v16, s80, v42
  v_fmac_f32 v17, s81, v43
  v_cvt_pk_bf16_f32 v18, v14, v15
  v_cvt_pk_bf16_f32 v19, v16, v17
  v_min_u32_e64 v18, -2, v18
  s_add_u32 s76, s27, 196608
  buffer_store_dwordx2 v[18:19], v5, s[12:15], s76 offen sc1
  v_mul_f32 v40, v14, v14
  v_mul_f32 v41, v15, v15
  v_mul_f32 v42, v16, v16
  v_mul_f32 v43, v17, v17
  v_permlane32_swap_b32 v14, v16
  v_permlane32_swap_b32 v15, v17
  v_permlane32_swap_b32 v40, v42
  v_permlane32_swap_b32 v41, v43
  v_add_f32 v14, v14, v16
  v_add_f32 v15, v15, v17
  v_add_f32 v40, v40, v42
  v_add_f32 v41, v41, v43
  v_permlane16_swap_b32 v14, v15
  s_nop 0
  v_permlane16_swap_b32 v40, v41
  v_add_f32 v14, v14, v15
  v_add_f32_e64 v40, v40, v41
  s_add_u32 s76, s46, 24576
  v_add_f32_dpp v14, v14, v14 row_ror:8 row_mask:0xf bank_mask:0xf
  s_nop 1
  v_add_f32_dpp v14, v40, v40 row_ror:8 row_mask:0xf bank_mask:0xc
  s_nop 1
  v_add_f32_dpp v14, v14, v14 row_half_mirror row_mask:0xf bank_mask:0xf
  s_nop 1
  v_add_f32_dpp v14, v14, v14 quad_perm:[2,3,0,1] row_mask:0xf bank_mask:0xf
  s_nop 1
  v_add_f32_dpp v14, v14, v14 quad_perm:[1,0,3,2] row_mask:0xf bank_mask:0xf
  v_cndmask_b32 v14, v14, 1.0, s[38:39]
  buffer_atomic_add_f32 v14, v8, s[12:15], s76 offen sc1
  ds_write_b64 v58, v[68:69] offset:0
  v_fmac_f32 v88, v62, v74
  v_fmac_f32 v89, v62, v75
  v_fmac_f32_e64 v90, v62, v78
  v_fmac_f32 v91, v62, v79
  s_waitcnt lgkmcnt(0)
  s_barrier
  ds_read_b128 v[92:95], v56 offset:0
  ds_read_b128 v[96:99], v57 offset:192
  ds_read_b128 v[116:119], v57 offset:704
  ds_read_b128 v[120:123], v56 offset:512
  ds_read_b128 v[124:127], v56 offset:64
  ds_read_b128 v[128:131], v57 offset:128
  s_waitcnt lgkmcnt(4)
  v_mfma_f32_16x16x32_bf16 v[24:27], v[92:95], v[96:99], 0
  ds_read_b128 v[132:135], v57 offset:640
  s_waitcnt lgkmcnt(4)
  v_mfma_f32_16x16x32_bf16 v[28:31], v[92:95], v[116:119], 0
  ds_read_b128 v[136:139], v56 offset:576
  s_waitcnt lgkmcnt(4)
  v_mfma_f32_16x16x32_bf16 v[28:31], v[120:123], v[96:99], v[28:31]
  ds_read_b128 v[140:143], v56 offset:128
  s_add_u32 s84, s7, 8454144
  buffer_load_dwordx2 v[70:71], v61, s[12:15], s84 offen sc1
  s_waitcnt lgkmcnt(3)
  v_mfma_f32_16x16x32_bf16 v[24:27], v[124:127], v[128:131], v[24:27]
  ds_read_b128 v[40:43], v57 offset:64
  s_waitcnt lgkmcnt(3)
  v_mfma_f32_16x16x32_bf16 v[28:31], v[124:127], v[132:135], v[28:31]
  ds_read_b128 v[44:47], v57 offset:576
  s_mov_b32 s84, 3088384
  buffer_load_dwordx4 v[80:83], v63, s[12:15], s84 offen sc1
  s_waitcnt lgkmcnt(3)
  v_mfma_f32_16x16x32_bf16 v[28:31], v[136:139], v[128:131], v[28:31]
  ds_read_b128 v[48:51], v56 offset:640
  s_waitcnt lgkmcnt(2)
  v_mfma_f32_16x16x32_bf16 v[24:27], v[140:143], v[40:43], v[24:27]
  ds_read_b128 v[52:55], v56 offset:192
  buffer_load_dwordx4 v[84:87], v63, s[12:15], s84 offen offset:16 sc1
  s_waitcnt lgkmcnt(2)
  v_mfma_f32_16x16x32_bf16 v[28:31], v[140:143], v[44:47], v[28:31]
  ds_read_b128 v[140:143], v57 offset:0
  s_waitcnt lgkmcnt(2)
  v_mfma_f32_16x16x32_bf16 v[28:31], v[48:51], v[40:43], v[28:31]
  ds_read_b128 v[124:127], v57 offset:512
  s_waitcnt lgkmcnt(1)
  v_mfma_f32_16x16x32_bf16 v[24:27], v[52:55], v[140:143], v[24:27]
  ds_read_b128 v[92:95], v56 offset:704
  s_waitcnt lgkmcnt(1)
  v_mfma_f32_16x16x32_bf16 v[28:31], v[52:55], v[124:127], v[28:31]
  ds_read_b128 v[52:55], v56 offset:1216
  s_waitcnt lgkmcnt(1)
  v_mfma_f32_16x16x32_bf16 v[28:31], v[92:95], v[140:143], v[28:31]
  ds_read_b128 v[96:99], v56 offset:1728
  s_nop 0
  ds_write_b128 v2, v[24:27] offset:0
  v_mfma_f32_16x16x32_bf16 v[32:35], v[92:95], v[124:127], 0
  ds_read_b128 v[92:95], v56 offset:2240
  s_nop 2
  ds_write_b128 v2, v[28:31] offset:1024
  s_waitcnt lgkmcnt(4)
  v_mfma_f32_16x16x32_bf16 v[32:35], v[52:55], v[140:143], v[32:35]
  ds_read_b128 v[116:119], v56 offset:2752
  v_mfma_f32_16x16x32_bf16 v[36:39], v[52:55], v[124:127], 0
  ds_read_b128 v[52:55], v56 offset:3264
  s_waitcnt lgkmcnt(5)
  v_mfma_f32_16x16x32_bf16 v[36:39], v[96:99], v[140:143], v[36:39]
  ds_read_b128 v[120:123], v56 offset:3776
  v_mfma_f32_16x16x32_bf16 v[100:103], v[96:99], v[124:127], 0
  ds_read_b128 v[96:99], v56 offset:1152
  s_waitcnt lgkmcnt(4)
  s_barrier
  v_mfma_f32_16x16x32_bf16 v[100:103], v[92:95], v[140:143], v[100:103]
  ds_read_b128 v[12:15], v59 offset:0
  ds_read_b128 v[16:19], v59 offset:4096
  v_mfma_f32_16x16x32_bf16 v[104:107], v[92:95], v[124:127], 0
  ds_read_b128 v[92:95], v56 offset:1664
  s_waitcnt lgkmcnt(6)
  v_mfma_f32_16x16x32_bf16 v[104:107], v[116:119], v[140:143], v[104:107]
  s_add_u32 s84, s7, 8519680
  buffer_load_dwordx2 v[68:69], v61, s[12:15], s84 offen sc1
  v_mfma_f32_16x16x32_bf16 v[108:111], v[116:119], v[124:127], 0
  ds_read_b128 v[116:119], v56 offset:2176
  s_waitcnt lgkmcnt(3)
  v_add_f32 v88, v88, v12
  v_mfma_f32_16x16x32_bf16 v[108:111], v[52:55], v[140:143], v[108:111]
  s_mov_b32 s84, 3096576
  buffer_load_dwordx4 v[72:75], v63, s[12:15], s84 offen sc1
  v_add_f32 v89, v89, v13
  v_mfma_f32_16x16x32_bf16 v[112:115], v[52:55], v[124:127], 0
  ds_read_b128 v[52:55], v56 offset:2688
  v_add_f32 v90, v90, v14
  v_add_f32_e64 v91, v91, v15
  v_mfma_f32_16x16x32_bf16 v[112:115], v[120:123], v[140:143], v[112:115]
  buffer_load_dwordx4 v[76:79], v63, s[12:15], s84 offen offset:16 sc1
  s_waitcnt lgkmcnt(2)
  v_add_f32 v88, v88, v16
  v_add_f32_e64 v89, v89, v17
  v_mfma_f32_16x16x32_bf16 v[32:35], v[48:51], v[44:47], v[32:35]
  ds_read_b128 v[124:127], v56 offset:3200
  v_add_f32_e64 v90, v90, v18
  v_add_f32_e64 v91, v91, v19
  v_mfma_f32_16x16x32_bf16 v[32:35], v[96:99], v[40:43], v[32:35]
  v_cvt_pk_bf16_f32 v20, v88, v89
  v_cvt_pk_bf16_f32 v21, v90, v91
  v_mfma_f32_16x16x32_bf16 v[36:39], v[96:99], v[44:47], v[36:39]
  ds_read_b128 v[120:123], v56 offset:3712
  v_min_u32 v20, -2, v20
  v_mfma_f32_16x16x32_bf16 v[36:39], v[92:95], v[40:43], v[36:39]
  s_add_u32 s76, s32, 6291456
  buffer_store_dwordx2 v[20:21], v60, s[12:15], s76 offen sc1
Lpad4:
  s_cbranch_execz Lpadret
  s_nop 0
  v_mfma_f32_16x16x32_bf16 v[100:103], v[92:95], v[44:47], v[100:103]
  ds_read_b128 v[140:143], v56 offset:1088
  s_waitcnt lgkmcnt(3)
  v_mfma_f32_16x16x32_bf16 v[100:103], v[116:119], v[40:43], v[100:103]
  v_mfma_f32_16x16x32_bf16 v[104:107], v[116:119], v[44:47], v[104:107]
  ds_read_b128 v[116:119], v56 offset:1600
  v_mfma_f32_16x16x32_bf16 v[104:107], v[52:55], v[40:43], v[104:107]
  v_mfma_f32_16x16x32_bf16 v[108:111], v[52:55], v[44:47], v[108:111]
  ds_read_b128 v[52:55], v56 offset:2112
  s_waitcnt lgkmcnt(4)
  v_mfma_f32_16x16x32_bf16 v[108:111], v[124:127], v[40:43], v[108:111]
  v_mfma_f32_16x16x32_bf16 v[112:115], v[124:127], v[44:47], v[112:115]
  ds_read_b128 v[124:127], v56 offset:2624
  s_waitcnt lgkmcnt(4)
  v_mfma_f32_16x16x32_bf16 v[112:115], v[120:123], v[40:43], v[112:115]
  v_mfma_f32_16x16x32_bf16 v[32:35], v[136:139], v[132:135], v[32:35]
  ds_read_b128 v[44:47], v56 offset:3136
  s_waitcnt lgkmcnt(4)
  v_mfma_f32_16x16x32_bf16 v[32:35], v[140:143], v[128:131], v[32:35]
  v_mfma_f32_16x16x32_bf16 v[36:39], v[140:143], v[132:135], v[36:39]
  ds_read_b128 v[120:123], v56 offset:3648
  s_waitcnt lgkmcnt(4)
  v_mfma_f32_16x16x32_bf16 v[36:39], v[116:119], v[128:131], v[36:39]
  ds_read_b128 v[40:43], v56 offset:512
  v_mfma_f32_16x16x32_bf16 v[100:103], v[116:119], v[132:135], v[100:103]
  ds_read_b128 v[116:119], v57 offset:704
  s_waitcnt lgkmcnt(5)
  v_mfma_f32_16x16x32_bf16 v[100:103], v[52:55], v[128:131], v[100:103]
  ds_read_b128 v[140:143], v56 offset:1024
  v_mfma_f32_16x16x32_bf16 v[104:107], v[52:55], v[132:135], v[104:107]
  ds_read_b128 v[52:55], v57 offset:192
  s_waitcnt lgkmcnt(5)
  v_mfma_f32_16x16x32_bf16 v[104:107], v[124:127], v[128:131], v[104:107]
  ds_read_b128 v[92:95], v56 offset:1536
  v_mfma_f32_16x16x32_bf16 v[108:111], v[124:127], v[132:135], v[108:111]
  ds_read_b128 v[124:127], v56 offset:2048
  s_waitcnt vmcnt(4)
  v_min_f32 v83, v82, v86
  v_mfma_f32_16x16x32_bf16 v[108:111], v[44:47], v[128:131], v[108:111]
  v_cmp_eq_u32 s[100:101], -1, v70
  v_mfma_f32_16x16x32_bf16 v[112:115], v[44:47], v[132:135], v[112:115]
  ds_read_b128 v[44:47], v56 offset:2560
  v_cmp_neq_f32 s[98:99], s67, v83
  s_nop 0
  s_or_b64 s[98:99], s[98:99], s[100:101]
  s_cbranch_scc1 Lretry12
Lback13:
  s_waitcnt lgkmcnt(3)
  v_mfma_f32_16x16x32_bf16 v[112:115], v[120:123], v[128:131], v[112:115]
  v_mul_f32 v80, 0x3b000000, v80
  v_mfma_f32_16x16x32_bf16 v[32:35], v[40:43], v[116:119], v[32:35]
  ds_read_b128 v[132:135], v56 offset:3072
  v_mul_f32 v84, 0x3b000000, v84
  v_fma_f32 v82, v80, v80, -s73
  v_mfma_f32_16x16x32_bf16 v[32:35], v[140:143], v[52:55], v[32:35]
  v_fma_f32 v83, v84, v84, -s73
  v_mfma_f32_16x16x32_bf16 v[36:39], v[140:143], v[116:119], v[36:39]
  ds_read_b128 v[120:123], v56 offset:3584
  v_fmamk_f32 v81, v81, 0xbb000000, v82
  v_fmamk_f32 v85, v85, 0xbb000000, v83
  s_waitcnt lgkmcnt(2)
  v_mfma_f32_16x16x32_bf16 v[36:39], v[92:95], v[52:55], v[36:39]
  ds_read_b128 v[128:131], v56 offset:0
  v_max_f32_e64 v81, -v81, s73
  v_max_f32_e64 v85, -v85, s73
  v_mfma_f32_16x16x32_bf16 v[100:103], v[92:95], v[116:119], v[100:103]
  v_rsq_f32_e64 v81, v81
  v_rsq_f32 v85, v85
  v_lshlrev_b32 v64, 16, v70
  v_and_b32 v65, s70, v70
  v_lshlrev_b32 v66, 16, v71
  v_and_b32 v67, s70, v71
  v_subrev_f32_dpp v82, v80, v64 quad_perm:[0,0,2,2] row_mask:0xf bank_mask:0xf
  v_subrev_f32_dpp v83, v84, v65 quad_perm:[0,0,2,2] row_mask:0xf bank_mask:0xf
  v_subrev_f32_dpp v86, v80, v66 quad_perm:[1,1,3,3] row_mask:0xf bank_mask:0xf
  v_subrev_f32_dpp v87, v84, v67 quad_perm:[1,1,3,3] row_mask:0xf bank_mask:0xf
  v_mul_f32_dpp v82, v81, v82 quad_perm:[0,0,2,2] row_mask:0xf bank_mask:0xf
  v_mul_f32_dpp v83, v85, v83 quad_perm:[0,0,2,2] row_mask:0xf bank_mask:0xf
  v_mul_f32_dpp v86, v81, v86 quad_perm:[1,1,3,3] row_mask:0xf bank_mask:0xf
  v_mul_f32_dpp v87, v85, v87 quad_perm:[1,1,3,3] row_mask:0xf bank_mask:0xf
  v_cvt_pk_bf16_f32 v70, v82, v83
  v_cvt_pk_bf16_f32 v71, v86, v87
  ds_write_b64 v58, v[70:71] offset:1024
  v_fmac_f32_e64 v64, v62, v82
  v_fmac_f32_e64 v65, v62, v83
  v_fmac_f32_e64 v66, v62, v86
  v_fmac_f32_e64 v67, v62, v87
  s_waitcnt lgkmcnt(0)
  s_barrier
  ds_read_b128 v[92:95], v57 offset:1216
  v_mfma_f32_16x16x32_bf16 v[100:103], v[124:127], v[52:55], v[100:103]
  ds_read_b128 v[140:143], v57 offset:1728
  v_mfma_f32_16x16x32_bf16 v[104:107], v[124:127], v[116:119], v[104:107]
  ds_read_b128 v[124:127], v56 offset:64
  v_mfma_f32_16x16x32_bf16 v[104:107], v[44:47], v[52:55], v[104:107]
  ds_read_b128 v[96:99], v57 offset:1152
  v_mfma_f32_16x16x32_bf16 v[108:111], v[44:47], v[116:119], v[108:111]
  ds_read_b128 v[44:47], v57 offset:1664
  v_mfma_f32_16x16x32_bf16 v[108:111], v[132:135], v[52:55], v[108:111]
  ds_read_b128 v[48:51], v56 offset:128
  v_mfma_f32_16x16x32_bf16 v[112:115], v[132:135], v[116:119], v[112:115]
  ds_read_b128 v[132:135], v57 offset:1088
  v_mfma_f32_16x16x32_bf16 v[112:115], v[120:123], v[52:55], v[112:115]
  ds_read_b128 v[116:119], v57 offset:1600
  s_waitcnt vmcnt(1)
  v_min_f32_e64 v75, v74, v78
  s_waitcnt lgkmcnt(6)
  v_mfma_f32_16x16x32_bf16 v[32:35], v[128:131], v[92:95], v[32:35]
  ds_read_b128 v[120:123], v56 offset:640
  v_mfma_f32_16x16x32_bf16 v[36:39], v[128:131], v[140:143], v[36:39]
  ds_read_b128 v[52:55], v56 offset:192
  v_cmp_eq_u32 s[100:101], -1, v68
  v_mfma_f32_16x16x32_bf16 v[36:39], v[40:43], v[92:95], v[36:39]
  ds_read_b128 v[128:131], v57 offset:1024
  v_cmp_neq_f32 s[98:99], s67, v75
  s_waitcnt lgkmcnt(5)
  v_mfma_f32_16x16x32_bf16 v[32:35], v[124:127], v[96:99], v[32:35]
  ds_read_b128 v[92:95], v57 offset:1536
  s_add_u32 s84, s7, 8585216
  buffer_load_dwordx2 v[70:71], v61, s[12:15], s84 offen sc1
  s_or_b64 s[98:99], s[98:99], s[100:101]
  s_cbranch_scc1 Lretry14
Lback15:
  v_mfma_f32_16x16x32_bf16 v[36:39], v[124:127], v[44:47], v[36:39]
  ds_read_b128 v[124:127], v56 offset:704
  v_mul_f32 v72, 0x3b000000, v72
  v_mfma_f32_16x16x32_bf16 v[36:39], v[136:139], v[96:99], v[36:39]
  ds_read_b128 v[40:43], v56 offset:1216
  s_waitcnt lgkmcnt(3)
  v_mfma_f32_16x16x32_bf16 v[32:35], v[48:51], v[132:135], v[32:35]
  ds_read_b128 v[140:143], v56 offset:1728
  s_mov_b32 s84, 3104768
  buffer_load_dwordx4 v[80:83], v63, s[12:15], s84 offen sc1
  v_mul_f32 v76, 0x3b000000, v76
  v_mfma_f32_16x16x32_bf16 v[36:39], v[48:51], v[116:119], v[36:39]
  v_fma_f32 v74, v72, v72, -s73
  v_mfma_f32_16x16x32_bf16 v[36:39], v[120:123], v[132:135], v[36:39]
  ds_read_b128 v[48:51], v56 offset:2240
  v_fma_f32 v75, v76, v76, -s73
  v_mfma_f32_16x16x32_bf16 v[32:35], v[52:55], v[128:131], v[32:35]
  buffer_load_dwordx4 v[84:87], v63, s[12:15], s84 offen offset:16 sc1
  v_fmamk_f32 v73, v73, 0xbb000000, v74
  s_waitcnt lgkmcnt(2)
  v_mfma_f32_16x16x32_bf16 v[36:39], v[52:55], v[92:95], v[36:39]
  ds_read_b128 v[52:55], v56 offset:2752
  v_fmamk_f32 v77, v77, 0xbb000000, v75
  v_mfma_f32_16x16x32_bf16 v[36:39], v[124:127], v[128:131], v[36:39]
  s_nop 0
  ds_write_b128 v2, v[32:35] offset:2048
  v_max_f32_e64 v73, -v73, s73
  v_mfma_f32_16x16x32_bf16 v[100:103], v[124:127], v[92:95], v[100:103]
  ds_read_b128 v[124:127], v56 offset:1152
  v_max_f32_e64 v77, -v77, s73
  v_mfma_f32_16x16x32_bf16 v[100:103], v[40:43], v[128:131], v[100:103]
  s_nop 0
  ds_write_b128 v2, v[36:39] offset:3072
  v_rsq_f32 v73, v73
  v_mfma_f32_16x16x32_bf16 v[104:107], v[40:43], v[92:95], v[104:107]
  ds_read_b128 v[40:43], v56 offset:1664
  s_waitcnt lgkmcnt(4)
  v_mfma_f32_16x16x32_bf16 v[104:107], v[140:143], v[128:131], v[104:107]
  v_rsq_f32 v77, v77
  v_mfma_f32_16x16x32_bf16 v[108:111], v[140:143], v[92:95], v[108:111]
  ds_read_b128 v[140:143], v56 offset:2176
  v_mfma_f32_16x16x32_bf16 v[108:111], v[48:51], v[128:131], v[108:111]
  s_waitcnt lgkmcnt(2)
  s_barrier
  v_mfma_f32_16x16x32_bf16 v[112:115], v[48:51], v[92:95], v[112:115]
  ds_read_b128 v[48:51], v56 offset:2688
  ds_read_b128 v[12:15], v59 offset:2048
  v_lshlrev_b32_e64 v88, 16, v68
  v_mfma_f32_16x16x32_bf16 v[112:115], v[52:55], v[128:131], v[112:115]
  ds_read_b128 v[16:19], v59 offset:6144
  v_and_b32_e64 v89, s70, v68
  v_mfma_f32_16x16x32_bf16 v[100:103], v[120:123], v[116:119], v[100:103]
  ds_read_b128 v[92:95], v56 offset:1088
  v_lshlrev_b32 v90, 16, v69
  v_mfma_f32_16x16x32_bf16 v[100:103], v[124:127], v[132:135], v[100:103]
  v_and_b32 v91, s70, v69
  v_mfma_f32_16x16x32_bf16 v[104:107], v[124:127], v[116:119], v[104:107]
  ds_read_b128 v[52:55], v56 offset:1600
  v_subrev_f32_dpp v74, v72, v88 quad_perm:[0,0,2,2] row_mask:0xf bank_mask:0xf
  s_waitcnt lgkmcnt(5)
  v_mfma_f32_16x16x32_bf16 v[104:107], v[40:43], v[132:135], v[104:107]
  s_waitcnt lgkmcnt(3)
  v_add_f32 v64, v64, v12
  v_subrev_f32_dpp v75, v76, v89 quad_perm:[0,0,2,2] row_mask:0xf bank_mask:0xf
  v_mfma_f32_16x16x32_bf16 v[108:111], v[40:43], v[116:119], v[108:111]
  ds_read_b128 v[128:131], v56 offset:2112
  v_add_f32 v65, v65, v13
  v_subrev_f32_dpp v78, v72, v90 quad_perm:[1,1,3,3] row_mask:0xf bank_mask:0xf
  v_add_f32 v66, v66, v14
  v_mfma_f32_16x16x32_bf16 v[108:111], v[140:143], v[132:135], v[108:111]
  v_add_f32 v67, v67, v15
  v_subrev_f32_dpp v79, v76, v91 quad_perm:[1,1,3,3] row_mask:0xf bank_mask:0xf
  v_mfma_f32_16x16x32_bf16 v[112:115], v[140:143], v[116:119], v[112:115]
  ds_read_b128 v[140:143], v56 offset:2624
  s_waitcnt lgkmcnt(2)
  v_add_f32 v64, v64, v16
  v_mul_f32_dpp v74, v73, v74 quad_perm:[0,0,2,2] row_mask:0xf bank_mask:0xf
  v_add_f32 v65, v65, v17
  v_mfma_f32_16x16x32_bf16 v[112:115], v[48:51], v[132:135], v[112:115]
  ds_read_b128 v[116:119], v56 offset:512
  v_add_f32 v66, v66, v18
  v_mul_f32_dpp v75, v77, v75 quad_perm:[0,0,2,2] row_mask:0xf bank_mask:0xf
  v_mfma_f32_16x16x32_bf16 v[100:103], v[136:139], v[44:47], v[100:103]
  ds_read_b128 v[48:51], v57 offset:1728
  v_add_f32_e64 v67, v67, v19
  v_cvt_pk_bf16_f32 v20, v64, v65
  v_mfma_f32_16x16x32_bf16 v[100:103], v[92:95], v[96:99], v[100:103]
  ds_read_b128 v[132:135], v56 offset:1024
  v_mul_f32_dpp v78, v73, v78 quad_perm:[1,1,3,3] row_mask:0xf bank_mask:0xf
  v_cvt_pk_bf16_f32 v21, v66, v67
  v_mfma_f32_16x16x32_bf16 v[104:107], v[92:95], v[44:47], v[104:107]
  ds_read_b128 v[92:95], v57 offset:1216
  v_mul_f32_dpp v79, v77, v79 quad_perm:[1,1,3,3] row_mask:0xf bank_mask:0xf
  v_min_u32 v20, -2, v20
  v_mfma_f32_16x16x32_bf16 v[104:107], v[52:55], v[96:99], v[104:107]
  ds_read_b128 v[40:43], v56 offset:1536
  s_add_u32 s76, s32, 6815744
  buffer_store_dwordx2 v[20:21], v60, s[12:15], s76 offen sc1
  v_cvt_pk_bf16_f32 v68, v74, v75
  v_mfma_f32_16x16x32_bf16 v[108:111], v[52:55], v[44:47], v[108:111]
  ds_read_b128 v[52:55], v56 offset:2048
  v_cvt_pk_bf16_f32 v69, v78, v79
  s_waitcnt lgkmcnt(3)
  v_mfma_f32_16x16x32_bf16 v[108:111], v[128:131], v[96:99], v[108:111]
  ds_write_b64 v58, v[68:69] offset:2048
  v_mfma_f32_16x16x32_bf16 v[112:115], v[128:131], v[44:47], v[112:115]
  ds_read_b128 v[128:131], v56 offset:2560
  v_mfma_f32_16x16x32_bf16 v[112:115], v[140:143], v[96:99], v[112:115]
  ds_read_b128 v[44:47], v56 offset:0
  v_fmac_f32 v88, v62, v74
  v_mfma_f32_16x16x32_bf16 v[100:103], v[116:119], v[48:51], v[100:103]
  v_fmac_f32 v89, v62, v75
  v_fmac_f32 v90, v62, v78
  v_fmac_f32 v91, v62, v79
  s_waitcnt lgkmcnt(2)
  s_barrier
  ds_read_b128 v[140:143], v57 offset:2240
  v_mfma_f32_16x16x32_bf16 v[100:103], v[132:135], v[92:95], v[100:103]
  ds_read_b128 v[96:99], v57 offset:2752
  s_add_u32 s84, s33, 6291456
  buffer_load_dwordx4 v[24:27], v3, s[12:15], s84 offen sc1
  v_mfma_f32_16x16x32_bf16 v[104:107], v[132:135], v[48:51], v[104:107]
  ds_read_b128 v[132:135], v56 offset:64
  v_mfma_f32_16x16x32_bf16 v[104:107], v[40:43], v[92:95], v[104:107]
  ds_read_b128 v[124:127], v57 offset:2176
  s_add_u32 s84, s33, 6295552
  buffer_load_dwordx4 v[28:31], v3, s[12:15], s84 offen sc1
  v_mfma_f32_16x16x32_bf16 v[108:111], v[40:43], v[48:51], v[108:111]
  ds_read_b128 v[40:43], v57 offset:2688
  v_mfma_f32_16x16x32_bf16 v[108:111], v[52:55], v[92:95], v[108:111]
  ds_read_b128 v[120:123], v56 offset:128
  s_add_u32 s84, s33, 6299648
  buffer_load_dwordx4 v[32:35], v3, s[12:15], s84 offen sc1
  v_mfma_f32_16x16x32_bf16 v[112:115], v[52:55], v[48:51], v[112:115]
  ds_read_b128 v[52:55], v57 offset:2112
  s_waitcnt lgkmcnt(5)
  v_mfma_f32_16x16x32_bf16 v[112:115], v[128:131], v[92:95], v[112:115]
  ds_read_b128 v[48:51], v57 offset:2624
  s_add_u32 s84, s33, 6303744
  buffer_load_dwordx4 v[36:39], v3, s[12:15], s84 offen sc1
  v_mfma_f32_16x16x32_bf16 v[100:103], v[44:47], v[140:143], v[100:103]
  ds_read_b128 v[128:131], v56 offset:640
  v_mfma_f32_16x16x32_bf16 v[104:107], v[44:47], v[96:99], v[104:107]
  ds_read_b128 v[92:95], v56 offset:192
  v_mfma_f32_16x16x32_bf16 v[104:107], v[116:119], v[140:143], v[104:107]
  ds_read_b128 v[44:47], v57 offset:2048
  s_waitcnt lgkmcnt(5)
  v_mfma_f32_16x16x32_bf16 v[100:103], v[132:135], v[124:127], v[100:103]
  ds_read_b128 v[140:143], v57 offset:2560
  v_mfma_f32_16x16x32_bf16 v[104:107], v[132:135], v[40:43], v[104:107]
  ds_read_b128 v[132:135], v56 offset:704
  v_mfma_f32_16x16x32_bf16 v[104:107], v[136:139], v[124:127], v[104:107]
  ds_read_b128 v[116:119], v56 offset:1216
  s_waitcnt lgkmcnt(6)
  v_mfma_f32_16x16x32_bf16 v[100:103], v[120:123], v[52:55], v[100:103]
  ds_read_b128 v[96:99], v56 offset:1728
  v_mfma_f32_16x16x32_bf16 v[104:107], v[120:123], v[48:51], v[104:107]
  s_waitcnt lgkmcnt(6)
  v_mfma_f32_16x16x32_bf16 v[104:107], v[128:131], v[52:55], v[104:107]
  ds_read_b128 v[120:123], v56 offset:1152
  s_waitcnt vmcnt(5)
  v_min_f32 v83, v82, v86
  s_waitcnt lgkmcnt(5)
  v_mfma_f32_16x16x32_bf16 v[100:103], v[92:95], v[44:47], v[100:103]
  v_cmp_eq_u32 s[100:101], -1, v70
  s_waitcnt lgkmcnt(3)
  v_mfma_f32_16x16x32_bf16 v[104:107], v[92:95], v[140:143], v[104:107]
  ds_read_b128 v[92:95], v56 offset:1664
  v_cmp_neq_f32 s[98:99], s67, v83
  s_nop 0
  s_or_b64 s[98:99], s[98:99], s[100:101]
  s_cbranch_scc1 Lretry16
Lback17:
  v_mfma_f32_16x16x32_bf16 v[104:107], v[132:135], v[44:47], v[104:107]
  v_mul_f32 v80, 0x3b000000, v80
  v_mfma_f32_16x16x32_bf16 v[108:111], v[132:135], v[140:143], v[108:111]
  ds_read_b128 v[132:135], v56 offset:1088
  v_mul_f32 v84, 0x3b000000, v84
  s_waitcnt lgkmcnt(2)
  v_mfma_f32_16x16x32_bf16 v[108:111], v[116:119], v[44:47], v[108:111]
  ds_write_b128 v2, v[100:103] offset:0
  v_fma_f32 v82, v80, v80, -s73
  v_fma_f32 v83, v84, v84, -s73
  v_mfma_f32_16x16x32_bf16 v[112:115], v[116:119], v[140:143], v[112:115]
  ds_read_b128 v[116:119], v56 offset:1600
  v_fmamk_f32 v81, v81, 0xbb000000, v82
  v_mfma_f32_16x16x32_bf16 v[112:115], v[96:99], v[44:47], v[112:115]
  ds_read_b128 v[140:143], v56 offset:512
  v_fmamk_f32 v85, v85, 0xbb000000, v83
  v_max_f32_e64 v81, -v81, s73
  v_mfma_f32_16x16x32_bf16 v[108:111], v[128:131], v[48:51], v[108:111]
  ds_read_b128 v[96:99], v57 offset:2752
  ds_write_b128 v2, v[104:107] offset:1024
  v_max_f32_e64 v85, -v85, s73
  v_mfma_f32_16x16x32_bf16 v[108:111], v[120:123], v[52:55], v[108:111]
  ds_read_b128 v[44:47], v56 offset:1024
  v_rsq_f32_e64 v81, v81
  v_mfma_f32_16x16x32_bf16 v[112:115], v[120:123], v[48:51], v[112:115]
  ds_read_b128 v[120:123], v57 offset:2240
  v_rsq_f32 v85, v85
  s_waitcnt lgkmcnt(5)
  v_mfma_f32_16x16x32_bf16 v[112:115], v[92:95], v[52:55], v[112:115]
  ds_read_b128 v[48:51], v56 offset:1536
  v_lshlrev_b32 v64, 16, v70
  v_mfma_f32_16x16x32_bf16 v[108:111], v[136:139], v[40:43], v[108:111]
  ds_read_b128 v[92:95], v56 offset:0
  v_and_b32 v65, s70, v70
  s_waitcnt lgkmcnt(4)
  s_barrier
  v_mfma_f32_16x16x32_bf16 v[108:111], v[132:135], v[124:127], v[108:111]
  ds_read_b128 v[12:15], v59 offset:0
  v_lshlrev_b32 v66, 16, v71
  v_and_b32 v67, s70, v71
  v_subrev_f32_dpp v82, v80, v64 quad_perm:[0,0,2,2] row_mask:0xf bank_mask:0xf
  v_subrev_f32_dpp v83, v84, v65 quad_perm:[0,0,2,2] row_mask:0xf bank_mask:0xf
  v_subrev_f32_dpp v86, v80, v66 quad_perm:[1,1,3,3] row_mask:0xf bank_mask:0xf
  v_subrev_f32_dpp v87, v84, v67 quad_perm:[1,1,3,3] row_mask:0xf bank_mask:0xf
  v_mul_f32_dpp v82, v81, v82 quad_perm:[0,0,2,2] row_mask:0xf bank_mask:0xf
  v_mul_f32_dpp v83, v85, v83 quad_perm:[0,0,2,2] row_mask:0xf bank_mask:0xf
  v_mul_f32_dpp v86, v81, v86 quad_perm:[1,1,3,3] row_mask:0xf bank_mask:0xf
  v_mul_f32_dpp v87, v85, v87 quad_perm:[1,1,3,3] row_mask:0xf bank_mask:0xf
  v_cvt_pk_bf16_f32 v70, v82, v83
  v_cvt_pk_bf16_f32 v71, v86, v87
  ds_write_b64 v58, v[70:71] offset:3072
  v_fmac_f32 v64, v62, v82
  v_fmac_f32 v65, v62, v83
  v_fmac_f32 v66, v62, v86
  v_fmac_f32 v67, v62, v87
  s_waitcnt lgkmcnt(0)
  s_barrier
  ds_read_b128 v[52:55], v57 offset:3264
  v_mfma_f32_16x16x32_bf16 v[112:115], v[132:135], v[40:43], v[112:115]
  ds_read_b128 v[132:135], v57 offset:3776
  ds_read_b128 v[16:19], v59 offset:4096
  v_mfma_f32_16x16x32_bf16 v[112:115], v[116:119], v[124:127], v[112:115]
  ds_read_b128 v[40:43], v56 offset:64
  v_mfma_f32_16x16x32_bf16 v[108:111], v[140:143], v[96:99], v[108:111]
  ds_read_b128 v[116:119], v57 offset:3200
  v_mfma_f32_16x16x32_bf16 v[108:111], v[44:47], v[120:123], v[108:111]
  ds_read_b128 v[124:127], v57 offset:3712
  v_mfma_f32_16x16x32_bf16 v[112:115], v[44:47], v[96:99], v[112:115]
  ds_read_b128 v[44:47], v56 offset:128
  v_add_f32_e64 v88, v88, v12
  v_mfma_f32_16x16x32_bf16 v[112:115], v[48:51], v[120:123], v[112:115]
  ds_read_b128 v[96:99], v57 offset:3136
  v_add_f32 v89, v89, v13
  v_add_f32_e64 v90, v90, v14
  s_waitcnt lgkmcnt(6)
  v_mfma_f32_16x16x32_bf16 v[108:111], v[92:95], v[52:55], v[108:111]
  ds_read_b128 v[48:51], v57 offset:3648
  v_add_f32 v91, v91, v15
  v_mfma_f32_16x16x32_bf16 v[112:115], v[92:95], v[132:135], v[112:115]
  ds_read_b128 v[120:123], v56 offset:192
  s_waitcnt lgkmcnt(5)
  v_add_f32 v88, v88, v16
  v_add_f32 v89, v89, v17
  v_mfma_f32_16x16x32_bf16 v[112:115], v[140:143], v[52:55], v[112:115]
  ds_read_b128 v[92:95], v57 offset:3072
  v_add_f32_e64 v90, v90, v18
  v_mfma_f32_16x16x32_bf16 v[108:111], v[40:43], v[116:119], v[108:111]
  ds_read_b128 v[132:135], v57 offset:3584
  v_add_f32 v91, v91, v19
  v_cvt_pk_bf16_f32 v20, v88, v89
  s_waitcnt lgkmcnt(4)
  v_mfma_f32_16x16x32_bf16 v[112:115], v[40:43], v[124:127], v[112:115]
  ds_read_b128 v[140:143], v56 offset:704
  v_cvt_pk_bf16_f32 v21, v90, v91
  v_mfma_f32_16x16x32_bf16 v[112:115], v[136:139], v[116:119], v[112:115]
  v_min_u32_e64 v20, -2, v20
  v_mfma_f32_16x16x32_bf16 v[108:111], v[44:47], v[96:99], v[108:111]
  s_add_u32 s76, s32, 7340032
  buffer_store_dwordx2 v[20:21], v60, s[12:15], s76 offen sc1
  s_waitcnt lgkmcnt(2)
  v_mfma_f32_16x16x32_bf16 v[112:115], v[44:47], v[48:51], v[112:115]
  v_mfma_f32_16x16x32_bf16 v[112:115], v[128:131], v[96:99], v[112:115]
  v_mfma_f32_16x16x32_bf16 v[108:111], v[120:123], v[92:95], v[108:111]
  s_waitcnt lgkmcnt(1)
  v_mfma_f32_16x16x32_bf16 v[112:115], v[120:123], v[132:135], v[112:115]
  s_waitcnt lgkmcnt(0)
  v_mfma_f32_16x16x32_bf16 v[112:115], v[140:143], v[92:95], v[112:115]
  s_waitcnt vmcnt(3)
  v_max3_u32 v22, v24, v26, v28
  s_waitcnt vmcnt(2)
  v_max3_u32 v22, v22, v30, v32
  s_waitcnt vmcnt(1)
  v_max3_u32 v22, v22, v34, v36
  v_max_u32 v22, v22, v38
  v_cmp_eq_u32 vcc, -1, v22
  s_nop 0
  s_cbranch_vccnz Lretry42
Lback43:
  ds_write_b128 v3, v[24:27] offset:0
  ds_write_b128 v3, v[28:31] offset:4096
  ds_write_b128 v3, v[32:35] offset:8192
  ds_write_b128 v3, v[36:39] offset:12288
  s_waitcnt lgkmcnt(0)
  s_barrier
  ds_read_b64_tr_b16 v[116:117], v0 offset:0
  ds_read_b64_tr_b16 v[118:119], v0 offset:512
  ds_read_b64_tr_b16 v[120:121], v0 offset:1024
  ds_read_b64_tr_b16 v[122:123], v0 offset:1536
  ds_read_b64_tr_b16 v[124:125], v0 offset:2048
  ds_read_b64_tr_b16 v[126:127], v0 offset:2560
  s_waitcnt lgkmcnt(4)
  v_mfma_f32_16x16x32_bf16 v[24:27], a[0:3], v[116:119], 0
  ds_read_b64_tr_b16 v[128:129], v0 offset:3072
  v_mfma_f32_16x16x32_bf16 v[28:31], a[4:7], v[116:119], 0
  ds_read_b64_tr_b16 v[130:131], v0 offset:3584
  s_add_u32 s84, s33, 6815744
  buffer_load_dwordx4 v[68:71], v3, s[12:15], s84 offen sc1
  v_xor_b32 v0, 4096, v0
  v_mfma_f32_16x16x32_bf16 v[32:35], a[8:11], v[116:119], 0
  ds_write_b128 v2, v[108:111] offset:2048
  v_mfma_f32_16x16x32_bf16 v[36:39], v[116:119], v[116:119], 0
  s_add_u32 s84, s33, 6819840
  buffer_load_dwordx4 v[72:75], v3, s[12:15], s84 offen sc1
  s_waitcnt lgkmcnt(4)
  v_mfma_f32_16x16x32_bf16 v[24:27], a[12:15], v[120:123], v[24:27]
  ds_read_b64_tr_b16 v[116:117], v0 offset:0
  ds_write_b128 v2, v[112:115] offset:3072
  v_mfma_f32_16x16x32_bf16 v[28:31], a[16:19], v[120:123], v[28:31]
  ds_read_b64_tr_b16 v[118:119], v0 offset:512
  s_add_u32 s84, s33, 6823936
  buffer_load_dwordx4 v[76:79], v3, s[12:15], s84 offen sc1
  v_mfma_f32_16x16x32_bf16 v[32:35], a[20:23], v[120:123], v[32:35]
  v_mfma_f32_16x16x32_bf16 v[36:39], v[120:123], v[120:123], v[36:39]
  s_add_u32 s84, s33, 6828032
  buffer_load_dwordx4 v[80:83], v3, s[12:15], s84 offen sc1
  s_waitcnt lgkmcnt(1)
  s_barrier
  v_mfma_f32_16x16x32_bf16 v[24:27], a[24:27], v[124:127], v[24:27]
  ds_read_b64_tr_b16 v[120:121], v0 offset:1024
  ds_read_b128 v[12:15], v59 offset:2048
  ds_read_b128 v[16:19], v59 offset:6144
  v_mfma_f32_16x16x32_bf16 v[28:31], a[28:31], v[124:127], v[28:31]
  ds_read_b64_tr_b16 v[122:123], v0 offset:1536
  v_mfma_f32_16x16x32_bf16 v[32:35], a[32:35], v[124:127], v[32:35]
  v_mfma_f32_16x16x32_bf16 v[36:39], v[124:127], v[124:127], v[36:39]
  s_waitcnt lgkmcnt(2)
  v_add_f32 v64, v64, v12
  v_mfma_f32_16x16x32_bf16 v[24:27], a[36:39], v[128:131], v[24:27]
  ds_read_b64_tr_b16 v[124:125], v0 offset:2048
  v_add_f32 v65, v65, v13
  v_add_f32 v66, v66, v14
  v_mfma_f32_16x16x32_bf16 v[28:31], a[40:43], v[128:131], v[28:31]
  ds_read_b64_tr_b16 v[126:127], v0 offset:2560
  v_add_f32 v67, v67, v15
  s_waitcnt lgkmcnt(3)
  v_add_f32 v64, v64, v16
  v_mfma_f32_16x16x32_bf16 v[32:35], a[44:47], v[128:131], v[32:35]
  v_add_f32 v65, v65, v17
  v_add_f32 v66, v66, v18
  v_mfma_f32_16x16x32_bf16 v[36:39], v[128:131], v[128:131], v[36:39]
  v_add_f32 v67, v67, v19
  v_cvt_pk_bf16_f32 v20, v64, v65
  v_mfma_f32_16x16x32_bf16 v[24:27], a[48:51], v[116:119], v[24:27]
  ds_read_b64_tr_b16 v[128:129], v0 offset:3072
  v_cvt_pk_bf16_f32 v21, v66, v67
  v_min_u32 v20, -2, v20
  v_mfma_f32_16x16x32_bf16 v[28:31], a[52:55], v[116:119], v[28:31]
  ds_read_b64_tr_b16 v[130:131], v0 offset:3584
  s_add_u32 s76, s32, 7864320
  buffer_store_dwordx2 v[20:21], v60, s[12:15], s76 offen sc1
  v_xor_b32 v0, 12288, v0
  v_mfma_f32_16x16x32_bf16 v[32:35], a[56:59], v[116:119], v[32:35]
  s_waitcnt lgkmcnt(2)
  v_mfma_f32_16x16x32_bf16 v[24:27], a[60:63], v[120:123], v[24:27]
  ds_read_b64_tr_b16 v[116:117], v0 offset:0
  v_mfma_f32_16x16x32_bf16 v[28:31], a[64:67], v[120:123], v[28:31]
  ds_read_b64_tr_b16 v[118:119], v0 offset:512
  s_mul_i32 s76, s3, 192
  v_mfma_f32_16x16x32_bf16 v[32:35], a[68:71], v[120:123], v[32:35]
  s_add_u32 s76, s76, 159744
  v_lshrrev_b32_e64 v12, 8, v4
  v_mfma_f32_16x16x32_bf16 v[24:27], a[72:75], v[124:127], v[24:27]
  ds_read_b64_tr_b16 v[120:121], v0 offset:1024
  v_lshl_add_u32 v12, v12, 4, s76
  v_mfma_f32_16x16x32_bf16 v[28:31], a[76:79], v[124:127], v[28:31]
  ds_read_b64_tr_b16 v[122:123], v0 offset:1536
  ds_read_b128 v[132:135], v12 offset:0
  s_lshl_b32 s90, s5, 11
  v_mfma_f32_16x16x32_bf16 v[32:35], a[80:83], v[124:127], v[32:35]
  ds_read_b128 v[136:139], v12 offset:64
  s_lshl_b32 s91, s3, 3
  s_waitcnt lgkmcnt(4)
  v_mfma_f32_16x16x32_bf16 v[24:27], a[84:87], v[128:131], v[24:27]
  ds_read_b64_tr_b16 v[124:125], v0 offset:2048
  ds_read_b128 v[140:143], v12 offset:128
  s_add_u32 s90, s90, s91
  s_lshl_b32 s91, s3, 6
  v_mfma_f32_16x16x32_bf16 v[28:31], a[88:91], v[128:131], v[28:31]
  ds_read_b64_tr_b16 v[126:127], v0 offset:2560
  v_and_b32 v56, 0xf0, v4
  v_mfma_f32_16x16x32_bf16 v[32:35], a[92:95], v[128:131], v[32:35]
  v_xor_b32 v56, s91, v56
  v_mfma_f32_16x16x32_bf16 v[24:27], a[96:99], v[116:119], v[24:27]
  ds_read_b64_tr_b16 v[128:129], v0 offset:3072
  v_lshrrev_b32_e64 v57, 6, v4
  v_mfma_f32_16x16x32_bf16 v[28:31], a[100:103], v[116:119], v[28:31]
  ds_read_b64_tr_b16 v[130:131], v0 offset:3584
  v_lshl_add_u32 v6, v57, 8, v56
  v_xor_b32 v0, 4096, v0
  v_mfma_f32_16x16x32_bf16 v[32:35], a[104:107], v[116:119], v[32:35]
  v_add_u32 v6, 141312, v6
  s_waitcnt lgkmcnt(3)
  v_mfma_f32_16x16x32_bf16 v[24:27], a[108:111], v[120:123], v[24:27]
  ds_read_b64_tr_b16 v[116:117], v0 offset:0
  v_lshlrev_b32_e64 v8, 3, v57
  v_mfma_f32_16x16x32_bf16 v[28:31], a[112:115], v[120:123], v[28:31]
  ds_read_b64_tr_b16 v[118:119], v0 offset:512
  v_mfma_f32_16x16x32_bf16 v[32:35], a[116:119], v[120:123], v[32:35]
  v_bfe_u32 v56, v4, 4, 2
  s_waitcnt lgkmcnt(3)
  v_mfma_f32_16x16x32_bf16 v[24:27], a[120:123], v[124:127], v[24:27]
  ds_read_b64_tr_b16 v[120:121], v0 offset:1024
  v_lshl_add_u32 v8, v56, 10, v8
  v_mfma_f32_16x16x32_bf16 v[28:31], a[124:127], v[124:127], v[28:31]
  ds_read_b64_tr_b16 v[122:123], v0 offset:1536
  v_and_b32 v57, 3, v57
  v_mfma_f32_16x16x32_bf16 v[32:35], a[128:131], v[124:127], v[32:35]
  v_lshl_add_u32 v56, v56, 2, v57
  s_waitcnt lgkmcnt(3)
  v_mfma_f32_16x16x32_bf16 v[24:27], a[132:135], v[128:131], v[24:27]
  ds_read_b64_tr_b16 v[124:125], v0 offset:2048
  v_lshrrev_b32_e64 v57, 8, v4
  v_mfma_f32_16x16x32_bf16 v[28:31], a[136:139], v[128:131], v[28:31]
  ds_read_b64_tr_b16 v[126:127], v0 offset:2560
  v_lshl_add_u32 v56, v57, 4, v56
  v_mfma_f32_16x16x32_bf16 v[32:35], a[140:143], v[128:131], v[32:35]
  s_waitcnt vmcnt(3)
  v_max3_u32 v22, v68, v70, v72
  v_lshl_add_u32 v7, v56, 5, s90
  s_waitcnt lgkmcnt(2)
  v_mfma_f32_16x16x32_bf16 v[24:27], a[144:147], v[116:119], v[24:27]
  ds_read_b64_tr_b16 v[128:129], v0 offset:3072
  s_waitcnt vmcnt(2)
  v_max3_u32 v22, v22, v74, v76
  s_waitcnt vmcnt(1)
  v_max3_u32 v22, v22, v78, v80
  v_max_u32_e64 v22, v22, v82
  v_cmp_eq_u32_e64 vcc, -1, v22
  s_nop 0
  s_cbranch_vccnz Lretry44
Lback45:
  v_mfma_f32_16x16x32_bf16 v[28:31], a[148:151], v[116:119], v[28:31]
  ds_read_b64_tr_b16 v[130:131], v0 offset:3584
  ds_write_b128 v3, v[68:71] offset:16384
  ds_write_b128 v3, v[72:75] offset:20480
  ds_write_b128 v3, v[76:79] offset:24576
  v_xor_b32 v0, 12288, v0
  v_mfma_f32_16x16x32_bf16 v[32:35], a[152:155], v[116:119], v[32:35]
  s_add_u32 s84, s33, 7340032
  buffer_load_dwordx4 v[100:103], v3, s[12:15], s84 offen sc1
  ds_write_b128 v3, v[80:83] offset:28672
  s_waitcnt lgkmcnt(0)
  s_barrier
  v_mfma_f32_16x16x32_bf16 v[24:27], a[156:159], v[120:123], v[24:27]
  s_add_u32 s84, s33, 7344128
  buffer_load_dwordx4 v[104:107], v3, s[12:15], s84 offen sc1
  ds_read_b64_tr_b16 v[116:117], v0 offset:16384
Lpad5:
  s_cbranch_execz Lpadret
  s_nop 0
  v_mfma_f32_16x16x32_bf16 v[28:31], a[160:163], v[120:123], v[28:31]
  ds_read_b64_tr_b16 v[118:119], v0 offset:16896
  s_add_u32 s84, s33, 7348224
  buffer_load_dwordx4 v[108:111], v3, s[12:15], s84 offen sc1
  s_add_u32 s84, s33, 7352320
  buffer_load_dwordx4 v[112:115], v3, s[12:15], s84 offen sc1
  v_mfma_f32_16x16x32_bf16 v[32:35], a[164:167], v[120:123], v[32:35]
  v_mfma_f32_16x16x32_bf16 v[24:27], a[168:171], v[124:127], v[24:27]
  ds_read_b64_tr_b16 v[120:121], v0 offset:17408
  v_mfma_f32_16x16x32_bf16 v[28:31], a[172:175], v[124:127], v[28:31]
  ds_read_b64_tr_b16 v[122:123], v0 offset:17920
  v_mfma_f32_16x16x32_bf16 v[32:35], a[176:179], v[124:127], v[32:35]
  v_mfma_f32_16x16x32_bf16 v[24:27], a[180:183], v[128:131], v[24:27]
  ds_read_b64_tr_b16 v[124:125], v0 offset:18432
  v_mfma_f32_16x16x32_bf16 v[28:31], a[184:187], v[128:131], v[28:31]
  ds_read_b64_tr_b16 v[126:127], v0 offset:18944
  v_mfma_f32_16x16x32_bf16 v[32:35], a[188:191], v[128:131], v[32:35]
  s_waitcnt lgkmcnt(4)
  v_mfma_f32_16x16x32_bf16 v[40:43], a[0:3], v[116:119], 0
  ds_read_b64_tr_b16 v[128:129], v0 offset:19456
  v_mfma_f32_16x16x32_bf16 v[44:47], a[4:7], v[116:119], 0
  ds_read_b64_tr_b16 v[130:131], v0 offset:19968
  v_xor_b32 v0, 4096, v0
  v_mfma_f32_16x16x32_bf16 v[48:51], a[8:11], v[116:119], 0
  v_mfma_f32_16x16x32_bf16 v[52:55], v[116:119], v[116:119], 0
  s_waitcnt lgkmcnt(4)
  v_mfma_f32_16x16x32_bf16 v[40:43], a[12:15], v[120:123], v[40:43]
  ds_read_b64_tr_b16 v[116:117], v0 offset:16384
  v_mul_f32 v12, 0xbb000000, v32
  v_mfma_f32_16x16x32_bf16 v[44:47], a[16:19], v[120:123], v[44:47]
  ds_read_b64_tr_b16 v[118:119], v0 offset:16896
  v_mul_f32 v13, 0xbb000000, v32
  v_cndmask_b32 v20, v36, v37, s[60:61]
  v_mfma_f32_16x16x32_bf16 v[48:51], a[20:23], v[120:123], v[48:51]
  v_permlane32_swap_b32 v12, v13
  v_mfma_f32_16x16x32_bf16 v[52:55], v[120:123], v[120:123], v[52:55]
  v_cndmask_b32 v20, v20, v38, s[62:63]
  v_mov_b32_e64 v12, v13
  s_waitcnt lgkmcnt(2)
  v_mfma_f32_16x16x32_bf16 v[40:43], a[24:27], v[124:127], v[40:43]
  ds_read_b64_tr_b16 v[120:121], v0 offset:17408
  v_cndmask_b32 v20, v20, v39, s[64:65]
  s_add_u32 s76, s24, 0
  v_permlane16_swap_b32 v12, v13
  v_mfma_f32_16x16x32_bf16 v[44:47], a[28:31], v[124:127], v[44:47]
  ds_read_b64_tr_b16 v[122:123], v0 offset:17920
  v_fma_f32 v24, -v13, v132, -v24
  v_mfma_f32_16x16x32_bf16 v[48:51], a[32:35], v[124:127], v[48:51]
  v_fma_f32 v25, -v13, v133, -v25
  v_cvt_pk_bf16_f32 v14, v24, v25
  v_pk_max_u16 v14, v14, s75
  v_mfma_f32_16x16x32_bf16 v[52:55], v[124:127], v[124:127], v[52:55]
  v_fmac_f32_e64 v26, v13, v134
  v_fmac_f32_e64 v27, v13, v135
  v_mfma_f32_16x16x32_bf16 v[40:43], a[36:39], v[128:131], v[40:43]
  ds_read_b64_tr_b16 v[124:125], v0 offset:18432
  v_cvt_pk_bf16_f32 v15, v26, v27
  v_pk_max_i16 v15, v15, 0
  v_mfma_f32_16x16x32_bf16 v[44:47], a[40:43], v[128:131], v[44:47]
  ds_read_b64_tr_b16 v[126:127], v0 offset:18944
  v_fmac_f32_e64 v28, v13, v136
  v_fmac_f32_e64 v29, v13, v137
  v_cvt_pk_bf16_f32 v16, v28, v29
  v_mfma_f32_16x16x32_bf16 v[48:51], a[44:47], v[128:131], v[48:51]
  v_pk_max_i16 v16, v16, 0
  v_fma_f32 v30, -v13, v138, -v30
  v_mfma_f32_16x16x32_bf16 v[52:55], v[128:131], v[128:131], v[52:55]
  v_fma_f32 v31, -v13, v139, -v31
  v_cvt_pk_bf16_f32 v17, v30, v31
  s_waitcnt lgkmcnt(2)
  v_mfma_f32_16x16x32_bf16 v[40:43], a[48:51], v[116:119], v[40:43]
  ds_read_b64_tr_b16 v[128:129], v0 offset:19456
  v_pk_max_u16 v17, v17, s75
  v_mfma_f32_16x16x32_bf16 v[44:47], a[52:55], v[116:119], v[44:47]
  ds_read_b64_tr_b16 v[130:131], v0 offset:19968
  buffer_store_dwordx4 v[14:17], v4, s[12:15], s76 offen sc1
  s_add_u32 s76, s25, 0
  v_fma_f32 v32, -v13, v140, -v32
  v_xor_b32 v0, 12288, v0
  v_mfma_f32_16x16x32_bf16 v[48:51], a[56:59], v[116:119], v[48:51]
  v_fma_f32 v33, -v13, v141, -v33
  v_cvt_pk_bf16_f32 v18, v32, v33
  v_mfma_f32_16x16x32_bf16 v[40:43], a[60:63], v[120:123], v[40:43]
  ds_read_b64_tr_b16 v[116:117], v0 offset:16384
  v_pk_max_u16 v18, v18, s75
  v_fmac_f32 v34, v13, v142
  v_fmac_f32 v35, v13, v143
  v_mfma_f32_16x16x32_bf16 v[44:47], a[64:67], v[120:123], v[44:47]
  ds_read_b64_tr_b16 v[118:119], v0 offset:16896
  v_cvt_pk_bf16_f32 v19, v34, v35
  v_pk_max_i16 v19, v19, 0
  v_mfma_f32_16x16x32_bf16 v[48:51], a[68:71], v[120:123], v[48:51]
  buffer_store_dwordx2 v[18:19], v1, s[12:15], s76 offen sc1
  s_waitcnt lgkmcnt(2)
  v_mfma_f32_16x16x32_bf16 v[40:43], a[72:75], v[124:127], v[40:43]
  ds_read_b64_tr_b16 v[120:121], v0 offset:17408
  ds_write_b32 v9, v20 offset:0
  ds_write_b32 v9, v13 offset:1024
  v_mfma_f32_16x16x32_bf16 v[44:47], a[76:79], v[124:127], v[44:47]
  ds_read_b64_tr_b16 v[122:123], v0 offset:17920
  v_mfma_f32_16x16x32_bf16 v[48:51], a[80:83], v[124:127], v[48:51]
  v_mfma_f32_16x16x32_bf16 v[40:43], a[84:87], v[128:131], v[40:43]
  ds_read_b64_tr_b16 v[124:125], v0 offset:18432
  v_mfma_f32_16x16x32_bf16 v[44:47], a[88:91], v[128:131], v[44:47]
  ds_read_b64_tr_b16 v[126:127], v0 offset:18944
  v_mfma_f32_16x16x32_bf16 v[48:51], a[92:95], v[128:131], v[48:51]
  s_waitcnt lgkmcnt(6)
  v_mfma_f32_16x16x32_bf16 v[40:43], a[96:99], v[116:119], v[40:43]
  ds_read_b64_tr_b16 v[128:129], v0 offset:19456
  v_mfma_f32_16x16x32_bf16 v[44:47], a[100:103], v[116:119], v[44:47]
  ds_read_b64_tr_b16 v[130:131], v0 offset:19968
  s_add_u32 s84, s33, 7864320
  buffer_load_dwordx4 v[84:87], v3, s[12:15], s84 offen sc1
  v_xor_b32 v0, 4096, v0
  v_mfma_f32_16x16x32_bf16 v[48:51], a[104:107], v[116:119], v[48:51]
  s_waitcnt lgkmcnt(4)
  v_mfma_f32_16x16x32_bf16 v[40:43], a[108:111], v[120:123], v[40:43]
  ds_read_b64_tr_b16 v[116:117], v0 offset:16384
  v_mfma_f32_16x16x32_bf16 v[44:47], a[112:115], v[120:123], v[44:47]
  ds_read_b64_tr_b16 v[118:119], v0 offset:16896
  v_mfma_f32_16x16x32_bf16 v[48:51], a[116:119], v[120:123], v[48:51]
  s_add_u32 s84, s33, 7868416
  buffer_load_dwordx4 v[88:91], v3, s[12:15], s84 offen sc1
  s_waitcnt lgkmcnt(3)
  v_mfma_f32_16x16x32_bf16 v[40:43], a[120:123], v[124:127], v[40:43]
  ds_read_b64_tr_b16 v[120:121], v0 offset:17408
  v_mfma_f32_16x16x32_bf16 v[44:47], a[124:127], v[124:127], v[44:47]
  ds_read_b64_tr_b16 v[122:123], v0 offset:17920
  v_mfma_f32_16x16x32_bf16 v[48:51], a[128:131], v[124:127], v[48:51]
  s_add_u32 s84, s33, 7872512
  buffer_load_dwordx4 v[92:95], v3, s[12:15], s84 offen sc1
  s_waitcnt lgkmcnt(4)
  v_mfma_f32_16x16x32_bf16 v[40:43], a[132:135], v[128:131], v[40:43]
  ds_read_b64_tr_b16 v[124:125], v0 offset:18432
  v_mfma_f32_16x16x32_bf16 v[44:47], a[136:139], v[128:131], v[44:47]
  ds_read_b64_tr_b16 v[126:127], v0 offset:18944
  v_mfma_f32_16x16x32_bf16 v[48:51], a[140:143], v[128:131], v[48:51]
  s_add_u32 s84, s33, 7876608
  buffer_load_dwordx4 v[96:99], v3, s[12:15], s84 offen sc1
  s_waitcnt lgkmcnt(4)
  v_mfma_f32_16x16x32_bf16 v[40:43], a[144:147], v[116:119], v[40:43]
  ds_read_b64_tr_b16 v[128:129], v0 offset:19456
  v_mfma_f32_16x16x32_bf16 v[44:47], a[148:151], v[116:119], v[44:47]
  ds_read_b64_tr_b16 v[130:131], v0 offset:19968
  v_xor_b32 v0, 12288, v0
  v_mfma_f32_16x16x32_bf16 v[48:51], a[152:155], v[116:119], v[48:51]
  s_waitcnt lgkmcnt(4)
  v_mfma_f32_16x16x32_bf16 v[40:43], a[156:159], v[120:123], v[40:43]
  s_waitcnt vmcnt(8)
  v_max3_u32 v22, v100, v102, v104
  s_waitcnt vmcnt(7)
  v_max3_u32 v22, v22, v106, v108
  s_waitcnt vmcnt(6)
  v_max3_u32 v22, v22, v110, v112
  v_max_u32 v22, v22, v114
  v_cmp_eq_u32 vcc, -1, v22
  s_nop 0
  s_cbranch_vccnz Lretry46
Lback47:
  ds_write_b128 v3, v[100:103] offset:32768
  ds_write_b128 v3, v[104:107] offset:36864
  ds_write_b128 v3, v[108:111] offset:40960
  ds_write_b128 v3, v[112:115] offset:45056
  s_waitcnt lgkmcnt(0)
  s_barrier
  ds_read_b64_tr_b16 v[116:117], v0 offset:32768
  v_mfma_f32_16x16x32_bf16 v[44:47], a[160:163], v[120:123], v[44:47]
  ds_read_b64_tr_b16 v[118:119], v0 offset:33280
  v_mfma_f32_16x16x32_bf16 v[48:51], a[164:167], v[120:123], v[48:51]
  v_mfma_f32_16x16x32_bf16 v[40:43], a[168:171], v[124:127], v[40:43]
  ds_read_b64_tr_b16 v[120:121], v0 offset:33792
  v_mfma_f32_16x16x32_bf16 v[44:47], a[172:175], v[124:127], v[44:47]
  ds_read_b64_tr_b16 v[122:123], v0 offset:34304
  v_mfma_f32_16x16x32_bf16 v[48:51], a[176:179], v[124:127], v[48:51]
  v_mfma_f32_16x16x32_bf16 v[40:43], a[180:183], v[128:131], v[40:43]
  ds_read_b64_tr_b16 v[124:125], v0 offset:34816
  v_mfma_f32_16x16x32_bf16 v[44:47], a[184:187], v[128:131], v[44:47]
  ds_read_b64_tr_b16 v[126:127], v0 offset:35328
  v_mfma_f32_16x16x32_bf16 v[48:51], a[188:191], v[128:131], v[48:51]
  s_waitcnt lgkmcnt(4)
  v_mfma_f32_16x16x32_bf16 v[24:27], a[0:3], v[116:119], 0
  ds_read_b64_tr_b16 v[128:129], v0 offset:35840
  s_nop 4
  v_mul_f32 v12, 0xbb000000, v48
  v_mfma_f32_16x16x32_bf16 v[28:31], a[4:7], v[116:119], 0
  ds_read_b64_tr_b16 v[130:131], v0 offset:36352
  v_mul_f32 v13, 0xbb000000, v48
  v_xor_b32 v0, 4096, v0
  v_mfma_f32_16x16x32_bf16 v[32:35], a[8:11], v[116:119], 0
  v_cndmask_b32 v20, v52, v53, s[60:61]
  v_permlane32_swap_b32 v12, v13
  v_mfma_f32_16x16x32_bf16 v[36:39], v[116:119], v[116:119], 0
  v_cndmask_b32 v20, v20, v54, s[62:63]
  s_waitcnt lgkmcnt(2)
  v_mfma_f32_16x16x32_bf16 v[24:27], a[12:15], v[120:123], v[24:27]
  ds_read_b64_tr_b16 v[116:117], v0 offset:32768
  v_mov_b32 v12, v13
  v_cndmask_b32 v20, v20, v55, s[64:65]
  v_mfma_f32_16x16x32_bf16 v[28:31], a[16:19], v[120:123], v[28:31]
  ds_read_b64_tr_b16 v[118:119], v0 offset:33280
  s_add_u32 s76, s24, 45056
  v_permlane16_swap_b32 v12, v13
  v_mfma_f32_16x16x32_bf16 v[32:35], a[20:23], v[120:123], v[32:35]
  v_fma_f32 v40, -v13, v132, -v40
  v_mfma_f32_16x16x32_bf16 v[36:39], v[120:123], v[120:123], v[36:39]
  v_fma_f32 v41, -v13, v133, -v41
  v_cvt_pk_bf16_f32 v14, v40, v41
  v_mfma_f32_16x16x32_bf16 v[24:27], a[24:27], v[124:127], v[24:27]
  ds_read_b64_tr_b16 v[120:121], v0 offset:33792
  v_pk_max_u16 v14, v14, s75
  v_fmac_f32 v42, v13, v134
  v_mfma_f32_16x16x32_bf16 v[28:31], a[28:31], v[124:127], v[28:31]
  ds_read_b64_tr_b16 v[122:123], v0 offset:34304
  v_fmac_f32 v43, v13, v135
  v_cvt_pk_bf16_f32 v15, v42, v43
  v_mfma_f32_16x16x32_bf16 v[32:35], a[32:35], v[124:127], v[32:35]
  v_pk_max_i16 v15, v15, 0
  v_fmac_f32_e64 v44, v13, v136
  v_mfma_f32_16x16x32_bf16 v[36:39], v[124:127], v[124:127], v[36:39]
  v_fmac_f32 v45, v13, v137
  v_cvt_pk_bf16_f32 v16, v44, v45
  s_waitcnt lgkmcnt(2)
  v_mfma_f32_16x16x32_bf16 v[24:27], a[36:39], v[128:131], v[24:27]
  ds_read_b64_tr_b16 v[124:125], v0 offset:34816
  v_pk_max_i16 v16, v16, 0
  v_mfma_f32_16x16x32_bf16 v[28:31], a[40:43], v[128:131], v[28:31]
  ds_read_b64_tr_b16 v[126:127], v0 offset:35328
  v_fma_f32 v46, -v13, v138, -v46
  v_fma_f32 v47, -v13, v139, -v47
  v_mfma_f32_16x16x32_bf16 v[32:35], a[44:47], v[128:131], v[32:35]
  v_cvt_pk_bf16_f32 v17, v46, v47
  v_pk_max_u16 v17, v17, s75
  v_mfma_f32_16x16x32_bf16 v[36:39], v[128:131], v[128:131], v[36:39]
  buffer_store_dwordx4 v[14:17], v4, s[12:15], s76 offen sc1
  v_mfma_f32_16x16x32_bf16 v[24:27], a[48:51], v[116:119], v[24:27]
  ds_read_b64_tr_b16 v[128:129], v0 offset:35840
  s_add_u32 s76, s25, 45056
  v_fma_f32 v48, -v13, v140, -v48
  v_mfma_f32_16x16x32_bf16 v[28:31], a[52:55], v[116:119], v[28:31]
  ds_read_b64_tr_b16 v[130:131], v0 offset:36352
  v_fma_f32 v49, -v13, v141, -v49
  v_cvt_pk_bf16_f32 v18, v48, v49
  v_xor_b32 v0, 12288, v0
  v_mfma_f32_16x16x32_bf16 v[32:35], a[56:59], v[116:119], v[32:35]
  v_pk_max_u16 v18, v18, s75
  v_fmac_f32 v50, v13, v142
  s_waitcnt lgkmcnt(2)
  v_mfma_f32_16x16x32_bf16 v[24:27], a[60:63], v[120:123], v[24:27]
  ds_read_b64_tr_b16 v[116:117], v0 offset:32768
  v_fmac_f32_e64 v51, v13, v143
  v_cvt_pk_bf16_f32 v19, v50, v51
  v_mfma_f32_16x16x32_bf16 v[28:31], a[64:67], v[120:123], v[28:31]
  ds_read_b64_tr_b16 v[118:119], v0 offset:33280
  v_pk_max_i16 v19, v19, 0
  v_mfma_f32_16x16x32_bf16 v[32:35], a[68:71], v[120:123], v[32:35]
  buffer_store_dwordx2 v[18:19], v1, s[12:15], s76 offen sc1
  ds_write_b32 v9, v20 offset:256
  s_waitcnt vmcnt(4)
  v_max3_u32 v22, v84, v86, v88
  v_mfma_f32_16x16x32_bf16 v[24:27], a[72:75], v[124:127], v[24:27]
  ds_read_b64_tr_b16 v[120:121], v0 offset:33792
  ds_write_b32 v9, v13 offset:1280
  s_waitcnt vmcnt(3)
  v_max3_u32 v22, v22, v90, v92
  v_mfma_f32_16x16x32_bf16 v[28:31], a[76:79], v[124:127], v[28:31]
  ds_read_b64_tr_b16 v[122:123], v0 offset:34304
  s_waitcnt vmcnt(2)
  v_max3_u32 v22, v22, v94, v96
  v_mfma_f32_16x16x32_bf16 v[32:35], a[80:83], v[124:127], v[32:35]
  v_max_u32_e64 v22, v22, v98
  s_waitcnt lgkmcnt(4)
  v_mfma_f32_16x16x32_bf16 v[24:27], a[84:87], v[128:131], v[24:27]
  ds_read_b64_tr_b16 v[124:125], v0 offset:34816
  v_cmp_eq_u32_e64 vcc, -1, v22
  v_mfma_f32_16x16x32_bf16 v[28:31], a[88:91], v[128:131], v[28:31]
  ds_read_b64_tr_b16 v[126:127], v0 offset:35328
  s_cbranch_vccnz Lretry48
Lback49:
  v_mfma_f32_16x16x32_bf16 v[32:35], a[92:95], v[128:131], v[32:35]
  ds_write_b128 v3, v[84:87] offset:49152
  v_mfma_f32_16x16x32_bf16 v[24:27], a[96:99], v[116:119], v[24:27]
  ds_read_b64_tr_b16 v[128:129], v0 offset:35840
  v_mfma_f32_16x16x32_bf16 v[28:31], a[100:103], v[116:119], v[28:31]
  ds_read_b64_tr_b16 v[130:131], v0 offset:36352
  v_xor_b32 v0, 4096, v0
  v_mfma_f32_16x16x32_bf16 v[32:35], a[104:107], v[116:119], v[32:35]
  ds_write_b128 v3, v[88:91] offset:53248
  s_waitcnt lgkmcnt(5)
  v_mfma_f32_16x16x32_bf16 v[24:27], a[108:111], v[120:123], v[24:27]
  ds_read_b64_tr_b16 v[116:117], v0 offset:32768
  v_mfma_f32_16x16x32_bf16 v[28:31], a[112:115], v[120:123], v[28:31]
  ds_read_b64_tr_b16 v[118:119], v0 offset:33280
  ds_write_b128 v3, v[92:95] offset:57344
  v_mfma_f32_16x16x32_bf16 v[32:35], a[116:119], v[120:123], v[32:35]
  s_add_u32 s84, s26, 0
  buffer_load_dwordx4 v[56:59], v4, s[12:15], s84 offen offset:0 sc1
  s_waitcnt lgkmcnt(5)
  v_mfma_f32_16x16x32_bf16 v[24:27], a[120:123], v[124:127], v[24:27]
  ds_read_b64_tr_b16 v[120:121], v0 offset:33792
  v_mfma_f32_16x16x32_bf16 v[28:31], a[124:127], v[124:127], v[28:31]
  ds_read_b64_tr_b16 v[122:123], v0 offset:34304
  ds_write_b128 v3, v[96:99] offset:61440
  v_mfma_f32_16x16x32_bf16 v[32:35], a[128:131], v[124:127], v[32:35]
  s_waitcnt lgkmcnt(6)
  v_mfma_f32_16x16x32_bf16 v[24:27], a[132:135], v[128:131], v[24:27]
  ds_read_b64_tr_b16 v[124:125], v0 offset:34816
  buffer_load_dwordx4 v[60:63], v4, s[12:15], s84 offen offset:1024 sc1
  v_mfma_f32_16x16x32_bf16 v[28:31], a[136:139], v[128:131], v[28:31]
  ds_read_b64_tr_b16 v[126:127], v0 offset:35328
  v_mfma_f32_16x16x32_bf16 v[32:35], a[140:143], v[128:131], v[32:35]
  buffer_load_dwordx4 v[64:67], v4, s[12:15], s84 offen offset:2048 sc1
  s_waitcnt lgkmcnt(5)
  v_mfma_f32_16x16x32_bf16 v[24:27], a[144:147], v[116:119], v[24:27]
  ds_read_b64_tr_b16 v[128:129], v0 offset:35840
  v_mfma_f32_16x16x32_bf16 v[28:31], a[148:151], v[116:119], v[28:31]
  ds_read_b64_tr_b16 v[130:131], v0 offset:36352
  s_waitcnt lgkmcnt(4)
  s_barrier
  v_xor_b32 v0, 12288, v0
  v_mfma_f32_16x16x32_bf16 v[32:35], a[152:155], v[116:119], v[32:35]
  buffer_load_dwordx4 v[68:71], v4, s[12:15], s84 offen offset:3072 sc1
  v_mfma_f32_16x16x32_bf16 v[24:27], a[156:159], v[120:123], v[24:27]
  ds_read_b64_tr_b16 v[116:117], v0 offset:49152
  v_mfma_f32_16x16x32_bf16 v[28:31], a[160:163], v[120:123], v[28:31]
  ds_read_b64_tr_b16 v[118:119], v0 offset:49664
  s_add_u32 s84, s26, 4096
  buffer_load_dwordx4 v[72:75], v4, s[12:15], s84 offen offset:0 sc1
  v_mfma_f32_16x16x32_bf16 v[32:35], a[164:167], v[120:123], v[32:35]
  s_waitcnt lgkmcnt(3)
  v_mfma_f32_16x16x32_bf16 v[24:27], a[168:171], v[124:127], v[24:27]
  ds_read_b64_tr_b16 v[120:121], v0 offset:50176
  v_mfma_f32_16x16x32_bf16 v[28:31], a[172:175], v[124:127], v[28:31]
  ds_read_b64_tr_b16 v[122:123], v0 offset:50688
  buffer_load_dwordx4 v[76:79], v4, s[12:15], s84 offen offset:1024 sc1
  v_mfma_f32_16x16x32_bf16 v[32:35], a[176:179], v[124:127], v[32:35]
  s_waitcnt lgkmcnt(4)
  v_mfma_f32_16x16x32_bf16 v[24:27], a[180:183], v[128:131], v[24:27]
  ds_read_b64_tr_b16 v[124:125], v0 offset:51200
  v_mfma_f32_16x16x32_bf16 v[28:31], a[184:187], v[128:131], v[28:31]
  ds_read_b64_tr_b16 v[126:127], v0 offset:51712
  v_mfma_f32_16x16x32_bf16 v[32:35], a[188:191], v[128:131], v[32:35]
  s_nop 7
  v_mul_f32 v12, 0xbb000000, v32
  v_mul_f32 v13, 0xbb000000, v32
  v_cndmask_b32 v20, v36, v37, s[60:61]
  s_nop 0
  v_permlane32_swap_b32 v12, v13
  v_cndmask_b32 v20, v20, v38, s[62:63]
  v_mov_b32 v12, v13
  v_cndmask_b32 v20, v20, v39, s[64:65]
  s_add_u32 s76, s24, 90112
  v_permlane16_swap_b32 v12, v13
  v_fma_f32 v24, -v13, v132, -v24
  v_fma_f32 v25, -v13, v133, -v25
  v_cvt_pk_bf16_f32 v14, v24, v25
  v_pk_max_u16 v14, v14, s75
  s_waitcnt lgkmcnt(0)
  v_mfma_f32_16x16x32_bf16 v[40:43], a[0:3], v[116:119], 0
  ds_read_b64_tr_b16 v[128:129], v0 offset:52224
  v_fmac_f32 v26, v13, v134
  v_fmac_f32 v27, v13, v135
  v_mfma_f32_16x16x32_bf16 v[44:47], a[4:7], v[116:119], 0
  ds_read_b64_tr_b16 v[130:131], v0 offset:52736
  v_cvt_pk_bf16_f32 v15, v26, v27
  v_pk_max_i16 v15, v15, 0
  v_xor_b32 v0, 4096, v0
  v_mfma_f32_16x16x32_bf16 v[48:51], a[8:11], v[116:119], 0
  v_fmac_f32 v28, v13, v136
  v_fmac_f32 v29, v13, v137
  v_cvt_pk_bf16_f32 v16, v28, v29
  v_mfma_f32_16x16x32_bf16 v[52:55], v[116:119], v[116:119], 0
  v_pk_max_i16 v16, v16, 0
  v_fma_f32 v30, -v13, v138, -v30
  v_mfma_f32_16x16x32_bf16 v[40:43], a[12:15], v[120:123], v[40:43]
  ds_read_b64_tr_b16 v[116:117], v0 offset:49152
  v_fma_f32 v31, -v13, v139, -v31
  v_cvt_pk_bf16_f32 v17, v30, v31
  v_mfma_f32_16x16x32_bf16 v[44:47], a[16:19], v[120:123], v[44:47]
  ds_read_b64_tr_b16 v[118:119], v0 offset:49664
  v_pk_max_u16 v17, v17, s75
  v_mfma_f32_16x16x32_bf16 v[48:51], a[20:23], v[120:123], v[48:51]
  buffer_store_dwordx4 v[14:17], v4, s[12:15], s76 offen sc1
  s_add_u32 s76, s25, 90112
  v_fma_f32 v32, -v13, v140, -v32
  v_mfma_f32_16x16x32_bf16 v[52:55], v[120:123], v[120:123], v[52:55]
  v_fma_f32 v33, -v13, v141, -v33
  v_cvt_pk_bf16_f32 v18, v32, v33
  v_mfma_f32_16x16x32_bf16 v[40:43], a[24:27], v[124:127], v[40:43]
  ds_read_b64_tr_b16 v[120:121], v0 offset:50176
  v_pk_max_u16 v18, v18, s75
  v_fmac_f32 v34, v13, v142
  v_fmac_f32_e64 v35, v13, v143
  v_mfma_f32_16x16x32_bf16 v[44:47], a[28:31], v[124:127], v[44:47]
  ds_read_b64_tr_b16 v[122:123], v0 offset:50688
  v_cvt_pk_bf16_f32 v19, v34, v35
  v_pk_max_i16 v19, v19, 0
  v_mfma_f32_16x16x32_bf16 v[48:51], a[32:35], v[124:127], v[48:51]
  buffer_store_dwordx2 v[18:19], v1, s[12:15], s76 offen sc1
  s_add_u32 s84, s26, 4096
  buffer_load_dwordx4 v[80:83], v4, s[12:15], s84 offen offset:2048 sc1
  v_mfma_f32_16x16x32_bf16 v[52:55], v[124:127], v[124:127], v[52:55]
  ds_write_b32 v9, v20 offset:512
  ds_write_b32 v9, v13 offset:1536
  s_waitcnt lgkmcnt(3)
  v_mfma_f32_16x16x32_bf16 v[40:43], a[36:39], v[128:131], v[40:43]
  ds_read_b64_tr_b16 v[124:125], v0 offset:51200
  v_mfma_f32_16x16x32_bf16 v[44:47], a[40:43], v[128:131], v[44:47]
  ds_read_b64_tr_b16 v[126:127], v0 offset:51712
  buffer_load_dwordx4 v[84:87], v4, s[12:15], s84 offen offset:3072 sc1
  v_mfma_f32_16x16x32_bf16 v[48:51], a[44:47], v[128:131], v[48:51]
  v_mfma_f32_16x16x32_bf16 v[52:55], v[128:131], v[128:131], v[52:55]
  s_add_u32 s84, s26, 8192
  buffer_load_dwordx2 v[88:89], v5, s[12:15], s84 offen offset:0 sc1
  v_mfma_f32_16x16x32_bf16 v[40:43], a[48:51], v[116:119], v[40:43]
  ds_read_b64_tr_b16 v[128:129], v0 offset:52224
  v_mfma_f32_16x16x32_bf16 v[44:47], a[52:55], v[116:119], v[44:47]
  ds_read_b64_tr_b16 v[130:131], v0 offset:52736
  v_xor_b32 v0, 12288, v0
  v_mfma_f32_16x16x32_bf16 v[48:51], a[56:59], v[116:119], v[48:51]
  buffer_load_dwordx2 v[90:91], v5, s[12:15], s84 offen offset:512 sc1
  s_waitcnt lgkmcnt(3)
  v_mfma_f32_16x16x32_bf16 v[40:43], a[60:63], v[120:123], v[40:43]
  ds_read_b64_tr_b16 v[116:117], v0 offset:49152
  v_mfma_f32_16x16x32_bf16 v[44:47], a[64:67], v[120:123], v[44:47]
  ds_read_b64_tr_b16 v[118:119], v0 offset:49664
  buffer_load_dwordx2 v[92:93], v5, s[12:15], s84 offen offset:1024 sc1
  v_mfma_f32_16x16x32_bf16 v[48:51], a[68:71], v[120:123], v[48:51]
  s_waitcnt lgkmcnt(4)
  v_mfma_f32_16x16x32_bf16 v[40:43], a[72:75], v[124:127], v[40:43]
  ds_read_b64_tr_b16 v[120:121], v0 offset:50176
  buffer_load_dwordx2 v[94:95], v5, s[12:15], s84 offen offset:1536 sc1
  v_mfma_f32_16x16x32_bf16 v[44:47], a[76:79], v[124:127], v[44:47]
  ds_read_b64_tr_b16 v[122:123], v0 offset:50688
  v_mfma_f32_16x16x32_bf16 v[48:51], a[80:83], v[124:127], v[48:51]
  buffer_load_dwordx2 v[96:97], v5, s[12:15], s84 offen offset:2048 sc1
  s_waitcnt lgkmcnt(4)
  v_mfma_f32_16x16x32_bf16 v[40:43], a[84:87], v[128:131], v[40:43]
  ds_read_b64_tr_b16 v[124:125], v0 offset:51200
  v_mfma_f32_16x16x32_bf16 v[44:47], a[88:91], v[128:131], v[44:47]
  ds_read_b64_tr_b16 v[126:127], v0 offset:51712
  buffer_load_dwordx2 v[98:99], v5, s[12:15], s84 offen offset:2560 sc1
  v_mfma_f32_16x16x32_bf16 v[48:51], a[92:95], v[128:131], v[48:51]
  s_waitcnt lgkmcnt(4)
  v_mfma_f32_16x16x32_bf16 v[40:43], a[96:99], v[116:119], v[40:43]
  ds_read_b64_tr_b16 v[128:129], v0 offset:52224
  v_mfma_f32_16x16x32_bf16 v[44:47], a[100:103], v[116:119], v[44:47]
  ds_read_b64_tr_b16 v[130:131], v0 offset:52736
  v_xor_b32 v0, 4096, v0
  v_mfma_f32_16x16x32_bf16 v[48:51], a[104:107], v[116:119], v[48:51]
  s_waitcnt lgkmcnt(4)
  v_mfma_f32_16x16x32_bf16 v[40:43], a[108:111], v[120:123], v[40:43]
  ds_read_b64_tr_b16 v[116:117], v0 offset:49152
  v_mfma_f32_16x16x32_bf16 v[44:47], a[112:115], v[120:123], v[44:47]
  ds_read_b64_tr_b16 v[118:119], v0 offset:49664
  v_mfma_f32_16x16x32_bf16 v[48:51], a[116:119], v[120:123], v[48:51]
  s_waitcnt lgkmcnt(4)
  v_mfma_f32_16x16x32_bf16 v[40:43], a[120:123], v[124:127], v[40:43]
  ds_read_b64_tr_b16 v[120:121], v0 offset:50176
  v_mfma_f32_16x16x32_bf16 v[44:47], a[124:127], v[124:127], v[44:47]
  ds_read_b64_tr_b16 v[122:123], v0 offset:50688
  s_add_u32 s84, s26, 45056
  buffer_load_dwordx4 v[100:103], v4, s[12:15], s84 offen offset:0 sc1
  v_mfma_f32_16x16x32_bf16 v[48:51], a[128:131], v[124:127], v[48:51]
  s_waitcnt lgkmcnt(4)
  v_mfma_f32_16x16x32_bf16 v[40:43], a[132:135], v[128:131], v[40:43]
  ds_read_b64_tr_b16 v[124:125], v0 offset:51200
  v_mfma_f32_16x16x32_bf16 v[44:47], a[136:139], v[128:131], v[44:47]
  ds_read_b64_tr_b16 v[126:127], v0 offset:51712
  v_mfma_f32_16x16x32_bf16 v[48:51], a[140:143], v[128:131], v[48:51]
  s_waitcnt lgkmcnt(4)
  v_mfma_f32_16x16x32_bf16 v[40:43], a[144:147], v[116:119], v[40:43]
  ds_read_b64_tr_b16 v[128:129], v0 offset:52224
  buffer_load_dwordx4 v[104:107], v4, s[12:15], s84 offen offset:1024 sc1
  v_mfma_f32_16x16x32_bf16 v[44:47], a[148:151], v[116:119], v[44:47]
  ds_read_b64_tr_b16 v[130:131], v0 offset:52736
  v_xor_b32 v0, 12288, v0
  v_mfma_f32_16x16x32_bf16 v[48:51], a[152:155], v[116:119], v[48:51]
  s_waitcnt lgkmcnt(4)
  v_mfma_f32_16x16x32_bf16 v[40:43], a[156:159], v[120:123], v[40:43]
  v_mfma_f32_16x16x32_bf16 v[44:47], a[160:163], v[120:123], v[44:47]
  buffer_load_dwordx4 v[108:111], v4, s[12:15], s84 offen offset:2048 sc1
  v_mfma_f32_16x16x32_bf16 v[48:51], a[164:167], v[120:123], v[48:51]
  s_waitcnt vmcnt(16)
  v_bitop3_b32 v22, v56, v60, v64 bitop3:0x80
  s_waitcnt lgkmcnt(2)
  v_mfma_f32_16x16x32_bf16 v[40:43], a[168:171], v[124:127], v[40:43]
  v_mfma_f32_16x16x32_bf16 v[44:47], a[172:175], v[124:127], v[44:47]
  buffer_load_dwordx4 v[112:115], v4, s[12:15], s84 offen offset:3072 sc1
  s_waitcnt vmcnt(15)
  v_bitop3_b32 v22, v22, v68, v72 bitop3:0x80
  v_mfma_f32_16x16x32_bf16 v[48:51], a[176:179], v[124:127], v[48:51]
  s_waitcnt vmcnt(14)
  v_and_b32_e64 v22, v22, v76
  s_waitcnt lgkmcnt(0)
  v_mfma_f32_16x16x32_bf16 v[40:43], a[180:183], v[128:131], v[40:43]
  v_cmp_le_i32 vcc, 0, v22
  v_mfma_f32_16x16x32_bf16 v[44:47], a[184:187], v[128:131], v[44:47]
  s_cbranch_vccnz Lretry50
Lback51:
  v_mfma_f32_16x16x32_bf16 v[48:51], a[188:191], v[128:131], v[48:51]
  s_add_u32 s84, s26, 49152
  buffer_load_dwordx4 v[116:119], v4, s[12:15], s84 offen offset:0 sc1
  v_mfma_f32_16x16x32_bf16 v[24:27], a[192:195], v[56:59], 0
  v_mfma_f32_16x16x32_bf16 v[28:31], a[196:199], v[56:59], 0
  v_mfma_f32_16x16x32_bf16 v[32:35], a[200:203], v[56:59], 0
  v_mfma_f32_16x16x32_bf16 v[36:39], a[204:207], v[56:59], 0
  buffer_load_dwordx4 v[120:123], v4, s[12:15], s84 offen offset:1024 sc1
  v_mfma_f32_16x16x32_bf16 v[24:27], a[208:211], v[60:63], v[24:27]
  v_mul_f32 v12, 0xbb000000, v48
  v_mfma_f32_16x16x32_bf16 v[28:31], a[212:215], v[60:63], v[28:31]
  v_mul_f32 v13, 0xbb000000, v48
  v_cndmask_b32 v20, v52, v53, s[60:61]
  s_nop 0
  v_permlane32_swap_b32 v12, v13
  v_mfma_f32_16x16x32_bf16 v[32:35], a[216:219], v[60:63], v[32:35]
  buffer_load_dwordx4 v[124:127], v4, s[12:15], s84 offen offset:2048 sc1
  v_cndmask_b32 v20, v20, v54, s[62:63]
  v_mov_b32 v12, v13
  v_cndmask_b32 v20, v20, v55, s[64:65]
  s_add_u32 s76, s24, 135168
  v_mfma_f32_16x16x32_bf16 v[36:39], a[220:223], v[60:63], v[36:39]
  v_permlane16_swap_b32 v12, v13
  v_fma_f32 v40, -v13, v132, -v40
  v_fma_f32 v41, -v13, v133, -v41
  v_mfma_f32_16x16x32_bf16 v[24:27], a[224:227], v[64:67], v[24:27]
  v_cvt_pk_bf16_f32 v14, v40, v41
  v_pk_max_u16 v14, v14, s75
  v_fmac_f32_e64 v42, v13, v134
  v_fmac_f32_e64 v43, v13, v135
  v_mfma_f32_16x16x32_bf16 v[28:31], a[228:231], v[64:67], v[28:31]
  buffer_load_dwordx4 v[128:131], v4, s[12:15], s84 offen offset:3072 sc1
  v_cvt_pk_bf16_f32 v15, v42, v43
  v_pk_max_i16 v15, v15, 0
  v_fmac_f32 v44, v13, v136
  v_fmac_f32 v45, v13, v137
  v_cvt_pk_bf16_f32 v16, v44, v45
  v_mfma_f32_16x16x32_bf16 v[32:35], a[232:235], v[64:67], v[32:35]
  v_pk_max_i16 v16, v16, 0
  v_fma_f32 v46, -v13, v138, -v46
  v_fma_f32 v47, -v13, v139, -v47
  v_cvt_pk_bf16_f32 v17, v46, v47
  v_mfma_f32_16x16x32_bf16 v[36:39], a[236:239], v[64:67], v[36:39]
  v_pk_max_u16 v17, v17, s75
  v_mfma_f32_16x16x32_bf16 v[24:27], a[240:243], v[68:71], v[24:27]
  buffer_store_dwordx4 v[14:17], v4, s[12:15], s76 offen sc1
  s_add_u32 s76, s25, 135168
  v_fma_f32 v48, -v13, v140, -v48
  v_fma_f32 v49, -v13, v141, -v49
  v_cvt_pk_bf16_f32 v18, v48, v49
  v_pk_max_u16 v18, v18, s75
  v_mfma_f32_16x16x32_bf16 v[28:31], a[244:247], v[68:71], v[28:31]
  v_fmac_f32 v50, v13, v142
  v_fmac_f32 v51, v13, v143
  v_cvt_pk_bf16_f32 v19, v50, v51
  v_pk_max_i16 v19, v19, 0
  v_mfma_f32_16x16x32_bf16 v[32:35], a[248:251], v[68:71], v[32:35]
  buffer_store_dwordx2 v[18:19], v1, s[12:15], s76 offen sc1
  ds_write_b32 v9, v20 offset:768
Lpad6:
  s_cbranch_execz Lpadret
  s_nop 0
  ds_write_b32 v9, v13 offset:1792
  v_mfma_f32_16x16x32_bf16 v[36:39], a[252:255], v[68:71], v[36:39]
  s_add_u32 s84, s26, 53248
  buffer_load_dwordx2 v[132:133], v5, s[12:15], s84 offen offset:0 sc1
  v_mfma_f32_16x16x32_bf16 v[24:27], v[144:147], v[72:75], v[24:27]
  v_mfma_f32_16x16x32_bf16 v[28:31], v[148:151], v[72:75], v[28:31]
  s_waitcnt vmcnt(16)
  v_bitop3_b32 v22, v80, v84, v88 bitop3:0x80
  v_mfma_f32_16x16x32_bf16 v[32:35], v[152:155], v[72:75], v[32:35]
  buffer_load_dwordx2 v[134:135], v5, s[12:15], s84 offen offset:512 sc1
  s_lshl_b32 s76, s3, 6
  s_waitcnt vmcnt(15)
  v_bitop3_b32 v22, v22, v90, v92 bitop3:0x80
  v_mfma_f32_16x16x32_bf16 v[36:39], v[156:159], v[72:75], v[36:39]
  s_add_u32 s76, s76, 157696
  v_bfe_u32 v12, v4, 6, 2
  s_waitcnt vmcnt(13)
  v_bitop3_b32 v22, v22, v94, v96 bitop3:0x80
  v_mfma_f32_16x16x32_bf16 v[24:27], v[160:163], v[76:79], v[24:27]
  buffer_load_dwordx2 v[136:137], v5, s[12:15], s84 offen offset:1024 sc1
  v_and_b32 v13, 48, v4
  s_waitcnt vmcnt(13)
  v_and_b32_e64 v22, v22, v98
  v_mfma_f32_16x16x32_bf16 v[28:31], v[164:167], v[76:79], v[28:31]
  v_lshlrev_b32_e64 v12, 8, v12
  v_cmp_le_i32 vcc, 0, v22
  v_mfma_f32_16x16x32_bf16 v[32:35], v[168:171], v[76:79], v[32:35]
  buffer_load_dwordx2 v[138:139], v5, s[12:15], s84 offen offset:1536 sc1
  v_add3_u32 v12, v12, v13, s76
  s_cbranch_vccnz Lretry52
Lback53:
  v_mfma_f32_16x16x32_bf16 v[36:39], v[172:175], v[76:79], v[36:39]
  s_waitcnt lgkmcnt(0)
  s_barrier
  v_mfma_f32_16x16x32_bf16 v[24:27], v[176:179], v[80:83], v[24:27]
  ds_read_b128 v[14:17], v12
  ds_read_b32 v13, v12 offset:1024
  buffer_load_dwordx2 v[140:141], v5, s[12:15], s84 offen offset:2048 sc1
  v_mfma_f32_16x16x32_bf16 v[28:31], v[180:183], v[80:83], v[28:31]
  buffer_load_dwordx2 v[142:143], v5, s[12:15], s84 offen offset:2560 sc1
  v_mfma_f32_16x16x32_bf16 v[32:35], v[184:187], v[80:83], v[32:35]
  v_mfma_f32_16x16x32_bf16 v[36:39], v[188:191], v[80:83], v[36:39]
  v_mfma_f32_16x16x32_bf16 v[24:27], v[192:195], v[84:87], v[24:27]
  v_mfma_f32_16x16x32_bf16 v[28:31], v[196:199], v[84:87], v[28:31]
  s_waitcnt lgkmcnt(1)
  v_add_f32 v14, v14, v15
  v_mfma_f32_16x16x32_bf16 v[32:35], v[200:203], v[84:87], v[32:35]
  v_add_f32 v16, v16, v17
  s_waitcnt lgkmcnt(0)
  v_mul_f32_e64 v13, v13, v13
  v_mfma_f32_16x16x32_bf16 v[36:39], v[204:207], v[84:87], v[36:39]
  v_add_f32_e64 v14, v14, v16
  v_mfma_f32_16x16x32_bf16 v[24:27], v[208:211], v[88:91], v[24:27]
  v_fmamk_f32 v13, v14, 0xbb000000, v13
  v_mfma_f32_16x16x32_bf16 v[28:31], v[212:215], v[88:91], v[28:31]
  v_min_f32_e64 v13, 0, v13
  v_mfma_f32_16x16x32_bf16 v[32:35], v[216:219], v[88:91], v[32:35]
  s_add_u32 s84, s26, 90112
  buffer_load_dwordx4 v[56:59], v4, s[12:15], s84 offen offset:0 sc1
  v_sub_f32_e64 v13, s73, v13
  v_mfma_f32_16x16x32_bf16 v[36:39], v[220:223], v[88:91], v[36:39]
  v_rsq_f32_e64 v10, v13
  v_mfma_f32_16x16x32_bf16 v[24:27], v[224:227], v[92:95], v[24:27]
  v_sub_f32 v10, 0, v10
  v_mfma_f32_16x16x32_bf16 v[28:31], v[228:231], v[92:95], v[28:31]
  buffer_load_dwordx4 v[60:63], v4, s[12:15], s84 offen offset:1024 sc1
  s_waitcnt vmcnt(15)
  v_bitop3_b32 v22, v100, v104, v108 bitop3:0x80
  v_mfma_f32_16x16x32_bf16 v[32:35], v[232:235], v[92:95], v[32:35]
  buffer_load_dwordx4 v[64:67], v4, s[12:15], s84 offen offset:2048 sc1
  v_mfma_f32_16x16x32_bf16 v[36:39], v[236:239], v[92:95], v[36:39]
  s_waitcnt vmcnt(14)
  v_bitop3_b32 v22, v22, v112, v116 bitop3:0x80
  v_mfma_f32_16x16x32_bf16 v[24:27], v[240:243], v[96:99], v[24:27]
  buffer_load_dwordx4 v[68:71], v4, s[12:15], s84 offen offset:3072 sc1
  s_waitcnt vmcnt(14)
  v_and_b32_e64 v22, v22, v120
  v_mfma_f32_16x16x32_bf16 v[28:31], v[244:247], v[96:99], v[28:31]
  s_add_u32 s84, s26, 94208
  buffer_load_dwordx4 v[72:75], v4, s[12:15], s84 offen offset:0 sc1
  v_cmp_le_i32 vcc, 0, v22
  v_mfma_f32_16x16x32_bf16 v[32:35], v[248:251], v[96:99], v[32:35]
  s_cbranch_vccnz Lretry54
Lback55:
  v_mfma_f32_16x16x32_bf16 v[36:39], v[252:255], v[96:99], v[36:39]
  buffer_load_dwordx4 v[76:79], v4, s[12:15], s84 offen offset:1024 sc1
  v_mfma_f32_16x16x32_bf16 v[40:43], a[192:195], v[100:103], 0
  v_mfma_f32_16x16x32_bf16 v[44:47], a[196:199], v[100:103], 0
  v_mfma_f32_16x16x32_bf16 v[48:51], a[200:203], v[100:103], 0
  s_add_u32 s84, s26, 94208
  buffer_load_dwordx4 v[80:83], v4, s[12:15], s84 offen offset:2048 sc1
  v_mfma_f32_16x16x32_bf16 v[52:55], a[204:207], v[100:103], 0
  v_mfma_f32_16x16x32_bf16 v[40:43], a[208:211], v[104:107], v[40:43]
  v_mfma_f32_16x16x32_bf16 v[44:47], a[212:215], v[104:107], v[44:47]
  buffer_load_dwordx4 v[84:87], v4, s[12:15], s84 offen offset:3072 sc1
  v_mfma_f32_16x16x32_bf16 v[48:51], a[216:219], v[104:107], v[48:51]
  ds_write_b128 v2, v[24:27] offset:0
  v_mfma_f32_16x16x32_bf16 v[52:55], a[220:223], v[104:107], v[52:55]
  v_mfma_f32_16x16x32_bf16 v[40:43], a[224:227], v[108:111], v[40:43]
  s_add_u32 s84, s26, 98304
  buffer_load_dwordx2 v[88:89], v5, s[12:15], s84 offen offset:0 sc1
  v_mfma_f32_16x16x32_bf16 v[44:47], a[228:231], v[108:111], v[44:47]
  ds_write_b128 v2, v[28:31] offset:1024
  v_mfma_f32_16x16x32_bf16 v[48:51], a[232:235], v[108:111], v[48:51]
  buffer_load_dwordx2 v[90:91], v5, s[12:15], s84 offen offset:512 sc1
  v_mfma_f32_16x16x32_bf16 v[52:55], a[236:239], v[108:111], v[52:55]
  ds_write_b128 v2, v[32:35] offset:2048
  v_mfma_f32_16x16x32_bf16 v[40:43], a[240:243], v[112:115], v[40:43]
  v_mfma_f32_16x16x32_bf16 v[44:47], a[244:247], v[112:115], v[44:47]
  ds_write_b128 v2, v[36:39] offset:3072
  buffer_load_dwordx2 v[92:93], v5, s[12:15], s84 offen offset:1024 sc1
  v_mfma_f32_16x16x32_bf16 v[48:51], a[248:251], v[112:115], v[48:51]
  v_mfma_f32_16x16x32_bf16 v[52:55], a[252:255], v[112:115], v[52:55]
  ds_read_b64_tr_b16 v[12:13], v7 offset:0
  buffer_load_dwordx2 v[94:95], v5, s[12:15], s84 offen offset:1536 sc1
  v_bfe_u32 v20, v4, 2, 4
  v_mfma_f32_16x16x32_bf16 v[40:43], v[144:147], v[116:119], v[40:43]
  ds_bpermute_b32 v20, v20, v10 offset:0
  v_mfma_f32_16x16x32_bf16 v[44:47], v[148:151], v[116:119], v[44:47]
  buffer_load_dwordx2 v[96:97], v5, s[12:15], s84 offen offset:2048 sc1
  s_waitcnt vmcnt(18)
  v_bitop3_b32 v22, v124, v128, v132 bitop3:0x80
  v_mfma_f32_16x16x32_bf16 v[48:51], v[152:155], v[116:119], v[48:51]
  s_waitcnt lgkmcnt(2)
  s_barrier
  s_waitcnt vmcnt(16)
  v_bitop3_b32 v22, v22, v134, v136 bitop3:0x80
  v_mfma_f32_16x16x32_bf16 v[52:55], v[156:159], v[116:119], v[52:55]
  ds_read_b128 v[24:27], v6 offset:0
  buffer_load_dwordx2 v[98:99], v5, s[12:15], s84 offen offset:2560 sc1
  s_waitcnt vmcnt(15)
  v_bitop3_b32 v22, v22, v138, v140 bitop3:0x80
  v_mfma_f32_16x16x32_bf16 v[40:43], v[160:163], v[120:123], v[40:43]
  ds_read_b128 v[28:31], v6 offset:4096
  ds_read_b128 v[32:35], v6 offset:8192
  s_waitcnt vmcnt(14)
  v_and_b32_e64 v22, v22, v142
  v_mfma_f32_16x16x32_bf16 v[44:47], v[164:167], v[120:123], v[44:47]
  ds_read_b128 v[36:39], v6 offset:12288
  v_cmp_le_i32 vcc, 0, v22
  v_mfma_f32_16x16x32_bf16 v[48:51], v[168:171], v[120:123], v[48:51]
  s_waitcnt lgkmcnt(4)
  v_lshlrev_b32 v14, 16, v12
  v_and_b32_e64 v15, s70, v12
  s_cbranch_vccnz Lretry56
Lback57:
  v_mfma_f32_16x16x32_bf16 v[52:55], v[172:175], v[120:123], v[52:55]
  s_add_u32 s84, s26, 135168
  buffer_load_dwordx4 v[100:103], v4, s[12:15], s84 offen offset:0 sc1
  v_lshlrev_b32 v16, 16, v13
  v_mfma_f32_16x16x32_bf16 v[40:43], v[176:179], v[124:127], v[40:43]
  v_and_b32 v17, s70, v13
  v_mfma_f32_16x16x32_bf16 v[44:47], v[180:183], v[124:127], v[44:47]
  v_mfma_f32_16x16x32_bf16 v[48:51], v[184:187], v[124:127], v[48:51]
  s_waitcnt lgkmcnt(0)
  v_add_f32 v24, v24, v28
  v_mfma_f32_16x16x32_bf16 v[52:55], v[188:191], v[124:127], v[52:55]
  buffer_load_dwordx4 v[104:107], v4, s[12:15], s84 offen offset:1024 sc1
  v_add_f32 v25, v25, v29
  v_mfma_f32_16x16x32_bf16 v[40:43], v[192:195], v[128:131], v[40:43]
  v_add_f32 v26, v26, v30
  v_add_f32 v27, v27, v31
  v_mfma_f32_16x16x32_bf16 v[44:47], v[196:199], v[128:131], v[44:47]
  v_add_f32 v32, v32, v36
  v_mfma_f32_16x16x32_bf16 v[48:51], v[200:203], v[128:131], v[48:51]
  buffer_load_dwordx4 v[108:111], v4, s[12:15], s84 offen offset:2048 sc1
  v_add_f32 v33, v33, v37
  v_mfma_f32_16x16x32_bf16 v[52:55], v[204:207], v[128:131], v[52:55]
  v_add_f32 v34, v34, v38
  v_add_f32 v35, v35, v39
  v_mfma_f32_16x16x32_bf16 v[40:43], v[208:211], v[132:135], v[40:43]
  s_barrier
  v_add_f32_e64 v24, v24, v32
  v_mfma_f32_16x16x32_bf16 v[44:47], v[212:215], v[132:135], v[44:47]
  buffer_load_dwordx4 v[112:115], v4, s[12:15], s84 offen offset:3072 sc1
  v_add_f32 v25, v25, v33
  v_mfma_f32_16x16x32_bf16 v[48:51], v[216:219], v[132:135], v[48:51]
  v_add_f32 v26, v26, v34
  v_add_f32_e64 v27, v27, v35
  v_mfma_f32_16x16x32_bf16 v[52:55], v[220:223], v[132:135], v[52:55]
  v_fmac_f32_e64 v14, v20, v24
  v_mfma_f32_16x16x32_bf16 v[40:43], v[224:227], v[136:139], v[40:43]
  s_add_u32 s84, s26, 139264
  buffer_load_dwordx4 v[116:119], v4, s[12:15], s84 offen offset:0 sc1
  v_fmac_f32 v15, v20, v25
  v_fmac_f32 v16, v20, v26
  v_mfma_f32_16x16x32_bf16 v[44:47], v[228:231], v[136:139], v[44:47]
  v_fmac_f32 v17, v20, v27
  s_waitcnt vmcnt(16)
  v_bitop3_b32 v22, v56, v60, v64 bitop3:0x80
  v_mfma_f32_16x16x32_bf16 v[48:51], v[232:235], v[136:139], v[48:51]
  v_cvt_pk_bf16_f32 v18, v14, v15
  v_cvt_pk_bf16_f32 v19, v16, v17
  v_mfma_f32_16x16x32_bf16 v[52:55], v[236:239], v[136:139], v[52:55]
  buffer_load_dwordx4 v[120:123], v4, s[12:15], s84 offen offset:1024 sc1
  s_waitcnt vmcnt(15)
  v_bitop3_b32 v22, v22, v68, v72 bitop3:0x80
  s_add_u32 s76, s47, 0
  v_mfma_f32_16x16x32_bf16 v[40:43], v[240:243], v[140:143], v[40:43]
  buffer_store_dwordx2 v[18:19], v8, s[16:19], s76 offen
  s_waitcnt vmcnt(15)
  v_and_b32 v22, v22, v76
  v_mfma_f32_16x16x32_bf16 v[44:47], v[244:247], v[140:143], v[44:47]
  v_cmp_le_i32 vcc, 0, v22
  v_mfma_f32_16x16x32_bf16 v[48:51], v[248:251], v[140:143], v[48:51]
  s_add_u32 s84, s26, 139264
  buffer_load_dwordx4 v[124:127], v4, s[12:15], s84 offen offset:2048 sc1
  s_cbranch_vccnz Lretry58
Lback59:
  v_mfma_f32_16x16x32_bf16 v[52:55], v[252:255], v[140:143], v[52:55]
  v_mfma_f32_16x16x32_bf16 v[24:27], a[192:195], v[56:59], 0
  v_mfma_f32_16x16x32_bf16 v[28:31], a[196:199], v[56:59], 0
  buffer_load_dwordx4 v[128:131], v4, s[12:15], s84 offen offset:3072 sc1
  v_mfma_f32_16x16x32_bf16 v[32:35], a[200:203], v[56:59], 0
  v_mfma_f32_16x16x32_bf16 v[36:39], a[204:207], v[56:59], 0
  ds_write_b128 v2, v[40:43] offset:0
  v_mfma_f32_16x16x32_bf16 v[24:27], a[208:211], v[60:63], v[24:27]
  s_add_u32 s84, s26, 143360
  buffer_load_dwordx2 v[132:133], v5, s[12:15], s84 offen offset:0 sc1
  v_mfma_f32_16x16x32_bf16 v[28:31], a[212:215], v[60:63], v[28:31]
  v_mfma_f32_16x16x32_bf16 v[32:35], a[216:219], v[60:63], v[32:35]
  ds_write_b128 v2, v[44:47] offset:1024
  buffer_load_dwordx2 v[134:135], v5, s[12:15], s84 offen offset:512 sc1
  v_mfma_f32_16x16x32_bf16 v[36:39], a[220:223], v[60:63], v[36:39]
  v_mfma_f32_16x16x32_bf16 v[24:27], a[224:227], v[64:67], v[24:27]
  ds_write_b128 v2, v[48:51] offset:2048
  v_mfma_f32_16x16x32_bf16 v[28:31], a[228:231], v[64:67], v[28:31]
  buffer_load_dwordx2 v[136:137], v5, s[12:15], s84 offen offset:1024 sc1
  v_mfma_f32_16x16x32_bf16 v[32:35], a[232:235], v[64:67], v[32:35]
  ds_write_b128 v2, v[52:55] offset:3072
  v_mfma_f32_16x16x32_bf16 v[36:39], a[236:239], v[64:67], v[36:39]
  buffer_load_dwordx2 v[138:139], v5, s[12:15], s84 offen offset:1536 sc1
  v_mfma_f32_16x16x32_bf16 v[24:27], a[240:243], v[68:71], v[24:27]
  ds_read_b64_tr_b16 v[12:13], v7 offset:16384
  v_bfe_u32 v20, v4, 2, 4
  v_mfma_f32_16x16x32_bf16 v[28:31], a[244:247], v[68:71], v[28:31]
  ds_bpermute_b32 v20, v20, v10 offset:16
  buffer_load_dwordx2 v[140:141], v5, s[12:15], s84 offen offset:2048 sc1
  v_mfma_f32_16x16x32_bf16 v[32:35], a[248:251], v[68:71], v[32:35]
  v_mfma_f32_16x16x32_bf16 v[36:39], a[252:255], v[68:71], v[36:39]
  buffer_load_dwordx2 v[142:143], v5, s[12:15], s84 offen offset:2560 sc1
  s_waitcnt lgkmcnt(2)
  s_barrier
  v_mfma_f32_16x16x32_bf16 v[24:27], v[144:147], v[72:75], v[24:27]
  ds_read_b128 v[40:43], v6 offset:0
  v_mfma_f32_16x16x32_bf16 v[28:31], v[148:151], v[72:75], v[28:31]
  ds_read_b128 v[44:47], v6 offset:4096
  ds_read_b128 v[48:51], v6 offset:8192
  s_waitcnt vmcnt(20)
  v_bitop3_b32 v22, v80, v84, v88 bitop3:0x80
  v_mfma_f32_16x16x32_bf16 v[32:35], v[152:155], v[72:75], v[32:35]
  ds_read_b128 v[52:55], v6 offset:12288
  s_waitcnt vmcnt(18)
  v_bitop3_b32 v22, v22, v90, v92 bitop3:0x80
  v_mfma_f32_16x16x32_bf16 v[36:39], v[156:159], v[72:75], v[36:39]
  s_waitcnt lgkmcnt(4)
  v_lshlrev_b32_e64 v14, 16, v12
  v_and_b32_e64 v15, s70, v12
  s_waitcnt vmcnt(16)
  v_bitop3_b32 v22, v22, v94, v96 bitop3:0x80
  v_mfma_f32_16x16x32_bf16 v[24:27], v[160:163], v[76:79], v[24:27]
  v_lshlrev_b32_e64 v16, 16, v13
  s_waitcnt vmcnt(15)
  v_and_b32 v22, v22, v98
  v_mfma_f32_16x16x32_bf16 v[28:31], v[164:167], v[76:79], v[28:31]
  v_and_b32 v17, s70, v13
  v_cmp_le_i32 vcc, 0, v22
  v_mfma_f32_16x16x32_bf16 v[32:35], v[168:171], v[76:79], v[32:35]
  s_cbranch_vccnz Lretry60
Lback61:
  v_mfma_f32_16x16x32_bf16 v[36:39], v[172:175], v[76:79], v[36:39]
  s_waitcnt lgkmcnt(0)
  v_add_f32 v40, v40, v44
  v_mfma_f32_16x16x32_bf16 v[24:27], v[176:179], v[80:83], v[24:27]
  v_add_f32 v41, v41, v45
  v_mfma_f32_16x16x32_bf16 v[28:31], v[180:183], v[80:83], v[28:31]
  v_add_f32 v42, v42, v46
  v_add_f32 v43, v43, v47
  v_mfma_f32_16x16x32_bf16 v[32:35], v[184:187], v[80:83], v[32:35]
  v_add_f32 v48, v48, v52
  v_mfma_f32_16x16x32_bf16 v[36:39], v[188:191], v[80:83], v[36:39]
  v_add_f32 v49, v49, v53
  v_mfma_f32_16x16x32_bf16 v[24:27], v[192:195], v[84:87], v[24:27]
  v_add_f32 v50, v50, v54
  v_add_f32 v51, v51, v55
  v_mfma_f32_16x16x32_bf16 v[28:31], v[196:199], v[84:87], v[28:31]
  s_barrier
  v_add_f32 v40, v40, v48
  v_mfma_f32_16x16x32_bf16 v[32:35], v[200:203], v[84:87], v[32:35]
  v_add_f32 v41, v41, v49
  v_mfma_f32_16x16x32_bf16 v[36:39], v[204:207], v[84:87], v[36:39]
  v_add_f32 v42, v42, v50
  v_add_f32 v43, v43, v51
  v_mfma_f32_16x16x32_bf16 v[24:27], v[208:211], v[88:91], v[24:27]
  v_fmac_f32 v14, v20, v40
  v_mfma_f32_16x16x32_bf16 v[28:31], v[212:215], v[88:91], v[28:31]
  v_fmac_f32_e64 v15, v20, v41
  v_fmac_f32_e64 v16, v20, v42
  v_mfma_f32_16x16x32_bf16 v[32:35], v[216:219], v[88:91], v[32:35]
  v_fmac_f32_e64 v17, v20, v43
  v_mfma_f32_16x16x32_bf16 v[36:39], v[220:223], v[88:91], v[36:39]
  v_cvt_pk_bf16_f32 v18, v14, v15
  v_cvt_pk_bf16_f32 v19, v16, v17
  v_mfma_f32_16x16x32_bf16 v[24:27], v[224:227], v[92:95], v[24:27]
  s_add_u32 s76, s47, 524288
  buffer_store_dwordx2 v[18:19], v8, s[16:19], s76 offen
  v_mfma_f32_16x16x32_bf16 v[28:31], v[228:231], v[92:95], v[28:31]
  s_waitcnt vmcnt(13)
  v_bitop3_b32 v22, v100, v104, v108 bitop3:0x80
  v_mfma_f32_16x16x32_bf16 v[32:35], v[232:235], v[92:95], v[32:35]
  v_mfma_f32_16x16x32_bf16 v[36:39], v[236:239], v[92:95], v[36:39]
  s_waitcnt vmcnt(11)
  v_bitop3_b32 v22, v22, v112, v116 bitop3:0x80
  v_mfma_f32_16x16x32_bf16 v[24:27], v[240:243], v[96:99], v[24:27]
  s_waitcnt vmcnt(10)
  v_and_b32 v22, v22, v120
  v_mfma_f32_16x16x32_bf16 v[28:31], v[244:247], v[96:99], v[28:31]
  v_cmp_le_i32 vcc, 0, v22
  v_mfma_f32_16x16x32_bf16 v[32:35], v[248:251], v[96:99], v[32:35]
  s_cbranch_vccnz Lretry62
Lback63:
  v_mfma_f32_16x16x32_bf16 v[36:39], v[252:255], v[96:99], v[36:39]
  v_mfma_f32_16x16x32_bf16 v[40:43], a[192:195], v[100:103], 0
  v_mfma_f32_16x16x32_bf16 v[44:47], a[196:199], v[100:103], 0
  v_mfma_f32_16x16x32_bf16 v[48:51], a[200:203], v[100:103], 0
  v_mfma_f32_16x16x32_bf16 v[52:55], a[204:207], v[100:103], 0
  v_mfma_f32_16x16x32_bf16 v[40:43], a[208:211], v[104:107], v[40:43]
  ds_write_b128 v2, v[24:27] offset:0
  v_mfma_f32_16x16x32_bf16 v[44:47], a[212:215], v[104:107], v[44:47]
  v_mfma_f32_16x16x32_bf16 v[48:51], a[216:219], v[104:107], v[48:51]
  ds_write_b128 v2, v[28:31] offset:1024
  v_mfma_f32_16x16x32_bf16 v[52:55], a[220:223], v[104:107], v[52:55]
  v_mfma_f32_16x16x32_bf16 v[40:43], a[224:227], v[108:111], v[40:43]
  ds_write_b128 v2, v[32:35] offset:2048
  v_mfma_f32_16x16x32_bf16 v[44:47], a[228:231], v[108:111], v[44:47]
  v_mfma_f32_16x16x32_bf16 v[48:51], a[232:235], v[108:111], v[48:51]
  ds_write_b128 v2, v[36:39] offset:3072
  v_mfma_f32_16x16x32_bf16 v[52:55], a[236:239], v[108:111], v[52:55]
  v_mfma_f32_16x16x32_bf16 v[40:43], a[240:243], v[112:115], v[40:43]
  ds_read_b64_tr_b16 v[12:13], v7 offset:32768
  v_bfe_u32 v20, v4, 2, 4
  v_mfma_f32_16x16x32_bf16 v[44:47], a[244:247], v[112:115], v[44:47]
  ds_bpermute_b32 v20, v20, v10 offset:32
  v_mfma_f32_16x16x32_bf16 v[48:51], a[248:251], v[112:115], v[48:51]
  v_mfma_f32_16x16x32_bf16 v[52:55], a[252:255], v[112:115], v[52:55]
  s_waitcnt lgkmcnt(2)
  s_barrier
  ds_read_b128 v[24:27], v6 offset:0
  v_mfma_f32_16x16x32_bf16 v[40:43], v[144:147], v[116:119], v[40:43]
  ds_read_b128 v[28:31], v6 offset:4096
  v_mfma_f32_16x16x32_bf16 v[44:47], v[148:151], v[116:119], v[44:47]
  ds_read_b128 v[32:35], v6 offset:8192
  ds_read_b128 v[36:39], v6 offset:12288
  s_waitcnt vmcnt(6)
  v_bitop3_b32 v22, v124, v128, v132 bitop3:0x80
  v_mfma_f32_16x16x32_bf16 v[48:51], v[152:155], v[116:119], v[48:51]
  s_waitcnt lgkmcnt(5)
  v_lshlrev_b32 v14, 16, v12
  v_and_b32 v15, s70, v12
  s_waitcnt vmcnt(4)
  v_bitop3_b32 v22, v22, v134, v136 bitop3:0x80
  v_mfma_f32_16x16x32_bf16 v[52:55], v[156:159], v[116:119], v[52:55]
  v_lshlrev_b32 v16, 16, v13
  s_waitcnt vmcnt(2)
  v_bitop3_b32 v22, v22, v138, v140 bitop3:0x80
  v_mfma_f32_16x16x32_bf16 v[40:43], v[160:163], v[120:123], v[40:43]
  v_and_b32 v17, s70, v13
  s_waitcnt vmcnt(1)
  v_and_b32 v22, v22, v142
  v_mfma_f32_16x16x32_bf16 v[44:47], v[164:167], v[120:123], v[44:47]
  v_cmp_le_i32 vcc, 0, v22
  v_mfma_f32_16x16x32_bf16 v[48:51], v[168:171], v[120:123], v[48:51]
  s_waitcnt lgkmcnt(0)
  v_add_f32 v24, v24, v28
  s_cbranch_vccnz Lretry64
Lback65:
  v_mfma_f32_16x16x32_bf16 v[52:55], v[172:175], v[120:123], v[52:55]
  v_add_f32 v25, v25, v29
  v_add_f32 v26, v26, v30
  v_mfma_f32_16x16x32_bf16 v[40:43], v[176:179], v[124:127], v[40:43]
  v_add_f32 v27, v27, v31
  v_add_f32 v32, v32, v36
  v_mfma_f32_16x16x32_bf16 v[44:47], v[180:183], v[124:127], v[44:47]
  v_add_f32 v33, v33, v37
  v_mfma_f32_16x16x32_bf16 v[48:51], v[184:187], v[124:127], v[48:51]
  v_add_f32 v34, v34, v38
  v_add_f32_e64 v35, v35, v39
  v_mfma_f32_16x16x32_bf16 v[52:55], v[188:191], v[124:127], v[52:55]
  s_barrier
  v_add_f32 v24, v24, v32
  v_mfma_f32_16x16x32_bf16 v[40:43], v[192:195], v[128:131], v[40:43]
  v_add_f32_e64 v25, v25, v33
  v_add_f32_e64 v26, v26, v34
  v_mfma_f32_16x16x32_bf16 v[44:47], v[196:199], v[128:131], v[44:47]
  v_add_f32_e64 v27, v27, v35
  v_mfma_f32_16x16x32_bf16 v[48:51], v[200:203], v[128:131], v[48:51]
  v_fmac_f32_e64 v14, v20, v24
  v_fmac_f32 v15, v20, v25
  v_mfma_f32_16x16x32_bf16 v[52:55], v[204:207], v[128:131], v[52:55]
  v_fmac_f32 v16, v20, v26
  v_fmac_f32_e64 v17, v20, v27
  v_mfma_f32_16x16x32_bf16 v[40:43], v[208:211], v[132:135], v[40:43]
  v_cvt_pk_bf16_f32 v18, v14, v15
  v_mfma_f32_16x16x32_bf16 v[44:47], v[212:215], v[132:135], v[44:47]
  v_cvt_pk_bf16_f32 v19, v16, v17
  s_add_u32 s76, s47, 1048576
  v_mfma_f32_16x16x32_bf16 v[48:51], v[216:219], v[132:135], v[48:51]
  buffer_store_dwordx2 v[18:19], v8, s[16:19], s76 offen
  v_mfma_f32_16x16x32_bf16 v[52:55], v[220:223], v[132:135], v[52:55]
  v_mfma_f32_16x16x32_bf16 v[40:43], v[224:227], v[136:139], v[40:43]
  v_mfma_f32_16x16x32_bf16 v[44:47], v[228:231], v[136:139], v[44:47]
  v_mfma_f32_16x16x32_bf16 v[48:51], v[232:235], v[136:139], v[48:51]
  v_mfma_f32_16x16x32_bf16 v[52:55], v[236:239], v[136:139], v[52:55]
  v_mfma_f32_16x16x32_bf16 v[40:43], v[240:243], v[140:143], v[40:43]
  v_mfma_f32_16x16x32_bf16 v[44:47], v[244:247], v[140:143], v[44:47]
  v_mfma_f32_16x16x32_bf16 v[48:51], v[248:251], v[140:143], v[48:51]
  v_mfma_f32_16x16x32_bf16 v[52:55], v[252:255], v[140:143], v[52:55]
  s_nop 4
  ds_write_b128 v2, v[40:43] offset:0
  ds_write_b128 v2, v[44:47] offset:1024
  ds_write_b128 v2, v[48:51] offset:2048
  ds_write_b128 v2, v[52:55] offset:3072
  ds_read_b64_tr_b16 v[12:13], v7 offset:49152
  v_bfe_u32 v20, v4, 2, 4
  ds_bpermute_b32 v20, v20, v10 offset:48
  s_waitcnt lgkmcnt(2)
  s_barrier
  ds_read_b128 v[40:43], v6 offset:0
  ds_read_b128 v[44:47], v6 offset:4096
  ds_read_b128 v[48:51], v6 offset:8192
  ds_read_b128 v[52:55], v6 offset:12288
  s_waitcnt lgkmcnt(5)
  v_lshlrev_b32 v14, 16, v12
  v_and_b32 v15, s70, v12
  v_lshlrev_b32 v16, 16, v13
  v_and_b32 v17, s70, v13
  s_waitcnt lgkmcnt(2)
  v_add_f32 v40, v40, v44
  v_add_f32 v41, v41, v45
  v_add_f32 v42, v42, v46
  v_add_f32 v43, v43, v47
  s_waitcnt lgkmcnt(0)
  v_add_f32 v48, v48, v52
  v_add_f32 v49, v49, v53
  v_add_f32 v50, v50, v54
  v_add_f32 v51, v51, v55
  v_add_f32 v40, v40, v48
  v_add_f32 v41, v41, v49
  v_add_f32 v42, v42, v50
  v_add_f32 v43, v43, v51
  v_fmac_f32 v14, v20, v40
  v_fmac_f32 v15, v20, v41
  v_fmac_f32_e64 v16, v20, v42
  v_fmac_f32 v17, v20, v43
  v_cvt_pk_bf16_f32 v18, v14, v15
  v_cvt_pk_bf16_f32 v19, v16, v17
  s_add_u32 s76, s47, 1572864
  buffer_store_dwordx2 v[18:19], v8, s[16:19], s76 offen
Lend:
  s_endpgm
Lbail:
  s_endpgm
Lretry4:
  s_nop 7
  s_sub_u32 s74, s74, 1
  s_cbranch_scc1 Lbail
  s_mov_b32 s96, 3014656
  buffer_load_dwordx4 v[124:127], v3, s[12:15], s96 offen sc1
  s_mov_b32 s96, 3018752
  buffer_load_dwordx4 v[128:131], v3, s[12:15], s96 offen sc1
  s_mov_b32 s96, 3022848
  buffer_load_dwordx4 v[132:135], v3, s[12:15], s96 offen sc1
  s_mov_b32 s96, 3026944
  buffer_load_dwordx4 v[136:139], v3, s[12:15], s96 offen sc1
  s_waitcnt vmcnt(0)
  v_xor_b32 v22, s40, v125
  v_bitop3_b32 v22, v22, v127, s40 bitop3:0xf6
  v_bitop3_b32 v22, v22, v129, s40 bitop3:0xf6
  v_bitop3_b32 v22, v22, v131, s40 bitop3:0xf6
  v_bitop3_b32 v22, v22, v133, s40 bitop3:0xf6
  v_bitop3_b32 v22, v22, v135, s40 bitop3:0xf6
  v_bitop3_b32 v22, v22, v137, s40 bitop3:0xf6
  v_bitop3_b32 v22, v22, v139, s40 bitop3:0xf6
  v_cmp_ne_u32 vcc, 0, v22
  s_nop 0
  s_cbranch_vccnz Lretry4
  s_nop 4
  s_branch Lback5
Lretry6:
  s_nop 7
  s_sub_u32 s74, s74, 1
  s_cbranch_scc1 Lbail
  buffer_load_dword v23, v10, s[12:15], s42 offen sc1
  s_waitcnt vmcnt(0)
  v_cmp_ne_u32 s[92:93], s40, v23
  s_nop 0
  s_cmp_lg_u64 s[92:93], 0
  s_cbranch_scc1 Lretry6
  s_nop 4
  s_branch Lback7
Lretry8:
  s_nop 7
  s_sub_u32 s74, s74, 1
  s_cbranch_scc1 Lbail
  buffer_load_dword v23, v10, s[12:15], s42 offen offset:256 sc1
  s_waitcnt vmcnt(0)
  v_cmp_ne_u32 s[92:93], s40, v23
  s_nop 0
  s_cmp_lg_u64 s[92:93], 0
  s_cbranch_scc1 Lretry8
  s_nop 4
  s_branch Lback9
Lretry10:
  s_nop 7
  s_sub_u32 s74, s74, 1
  s_cbranch_scc1 Lbail
  s_add_u32 s96, s7, 8388608
  buffer_load_dwordx2 v[68:69], v61, s[12:15], s96 offen sc1
  s_mov_b32 s96, 3080192
  buffer_load_dwordx4 v[72:75], v63, s[12:15], s96 offen sc1
  buffer_load_dwordx4 v[76:79], v63, s[12:15], s96 offen offset:16 sc1
  s_waitcnt vmcnt(0)
  v_min_f32 v75, v74, v78
  v_cmp_eq_u32 s[100:101], -1, v68
  v_cmp_neq_f32 s[98:99], s67, v75
  s_nop 0
  s_or_b64 s[98:99], s[98:99], s[100:101]
  s_cbranch_scc1 Lretry10
  s_nop 4
  s_branch Lback11
Lretry12:
  s_nop 7
  s_sub_u32 s74, s74, 1
  s_cbranch_scc1 Lbail
  s_add_u32 s96, s7, 8454144
  buffer_load_dwordx2 v[70:71], v61, s[12:15], s96 offen sc1
  s_mov_b32 s96, 3088384
  buffer_load_dwordx4 v[80:83], v63, s[12:15], s96 offen sc1
  buffer_load_dwordx4 v[84:87], v63, s[12:15], s96 offen offset:16 sc1
  s_waitcnt vmcnt(0)
  v_min_f32 v83, v82, v86
  v_cmp_eq_u32 s[100:101], -1, v70
  v_cmp_neq_f32 s[98:99], s67, v83
  s_nop 0
  s_or_b64 s[98:99], s[98:99], s[100:101]
  s_cbranch_scc1 Lretry12
  s_nop 4
  s_branch Lback13
Lretry14:
  s_nop 7
  s_sub_u32 s74, s74, 1
  s_cbranch_scc1 Lbail
  s_add_u32 s96, s7, 8519680
  buffer_load_dwordx2 v[68:69], v61, s[12:15], s96 offen sc1
  s_mov_b32 s96, 3096576
  buffer_load_dwordx4 v[72:75], v63, s[12:15], s96 offen sc1
  buffer_load_dwordx4 v[76:79], v63, s[12:15], s96 offen offset:16 sc1
  s_waitcnt vmcnt(0)
  v_min_f32 v75, v74, v78
  v_cmp_eq_u32 s[100:101], -1, v68
  v_cmp_neq_f32 s[98:99], s67, v75
  s_nop 0
  s_or_b64 s[98:99], s[98:99], s[100:101]
  s_cbranch_scc1 Lretry14
  s_nop 4
  s_branch Lback15
Lretry16:
  s_nop 7
  s_sub_u32 s74, s74, 1
  s_cbranch_scc1 Lbail
  s_add_u32 s96, s7, 8585216
  buffer_load_dwordx2 v[70:71], v61, s[12:15], s96 offen sc1
  s_mov_b32 s96, 3104768
  buffer_load_dwordx4 v[80:83], v63, s[12:15], s96 offen sc1
  buffer_load_dwordx4 v[84:87], v63, s[12:15], s96 offen offset:16 sc1
  s_waitcnt vmcnt(0)
  v_min_f32 v83, v82, v86
  v_cmp_eq_u32 s[100:101], -1, v70
  v_cmp_neq_f32 s[98:99], s67, v83
  s_nop 0
  s_or_b64 s[98:99], s[98:99], s[100:101]
  s_cbranch_scc1 Lretry16
  s_nop 4
  s_branch Lback17
Lretry18:
  s_nop 7
  s_sub_u32 s74, s74, 1
  s_cbranch_scc1 Lbail
  s_add_u32 s96, s33, 4194304
  buffer_load_dwordx4 v[24:27], v3, s[12:15], s96 offen sc1
  s_add_u32 s96, s33, 4198400
  buffer_load_dwordx4 v[28:31], v3, s[12:15], s96 offen sc1
  s_add_u32 s96, s33, 4202496
  buffer_load_dwordx4 v[32:35], v3, s[12:15], s96 offen sc1
  s_add_u32 s96, s33, 4206592
  buffer_load_dwordx4 v[36:39], v3, s[12:15], s96 offen sc1
  s_waitcnt vmcnt(0)
  v_max3_u32 v22, v24, v26, v28
  v_max3_u32 v22, v22, v30, v32
  v_max3_u32 v22, v22, v34, v36
  v_max_u32 v22, v22, v38
  v_cmp_eq_u32 vcc, -1, v22
  s_nop 0
  s_cbranch_vccnz Lretry18
  s_nop 4
  s_branch Lback19
Lretry20:
  s_nop 7
  s_sub_u32 s74, s74, 1
  s_cbranch_scc1 Lbail
  s_add_u32 s96, s33, 4718592
  buffer_load_dwordx4 v[68:71], v3, s[12:15], s96 offen sc1
  s_add_u32 s96, s33, 4722688
  buffer_load_dwordx4 v[72:75], v3, s[12:15], s96 offen sc1
  s_add_u32 s96, s33, 4726784
  buffer_load_dwordx4 v[76:79], v3, s[12:15], s96 offen sc1
  s_add_u32 s96, s33, 4730880
  buffer_load_dwordx4 v[80:83], v3, s[12:15], s96 offen sc1
  s_waitcnt vmcnt(0)
  v_max3_u32 v22, v68, v70, v72
  v_max3_u32 v22, v22, v74, v76
  v_max3_u32 v22, v22, v78, v80
  v_max_u32 v22, v22, v82
  v_cmp_eq_u32 vcc, -1, v22
  s_nop 0
  s_cbranch_vccnz Lretry20
  s_nop 4
  s_branch Lback21
Lretry22:
  s_nop 7
  s_sub_u32 s74, s74, 1
  s_cbranch_scc1 Lbail
  s_add_u32 s96, s33, 5242880
  buffer_load_dwordx4 v[100:103], v3, s[12:15], s96 offen sc1
  s_add_u32 s96, s33, 5246976
  buffer_load_dwordx4 v[104:107], v3, s[12:15], s96 offen sc1
  s_add_u32 s96, s33, 5251072
  buffer_load_dwordx4 v[108:111], v3, s[12:15], s96 offen sc1
  s_add_u32 s96, s33, 5255168
  buffer_load_dwordx4 v[112:115], v3, s[12:15], s96 offen sc1
  s_waitcnt vmcnt(0)
  v_max3_u32 v22, v100, v102, v104
  v_max3_u32 v22, v22, v106, v108
  v_max3_u32 v22, v22, v110, v112
  v_max_u32 v22, v22, v114
  v_cmp_eq_u32 vcc, -1, v22
  s_nop 0
  s_cbranch_vccnz Lretry22
  s_nop 4
  s_branch Lback23
Lretry24:
  s_nop 7
  s_sub_u32 s74, s74, 1
  s_cbranch_scc1 Lbail
  s_add_u32 s96, s33, 5767168
  buffer_load_dwordx4 v[84:87], v3, s[12:15], s96 offen sc1
  s_add_u32 s96, s33, 5771264
  buffer_load_dwordx4 v[88:91], v3, s[12:15], s96 offen sc1
  s_add_u32 s96, s33, 5775360
  buffer_load_dwordx4 v[92:95], v3, s[12:15], s96 offen sc1
  s_add_u32 s96, s33, 5779456
  buffer_load_dwordx4 v[96:99], v3, s[12:15], s96 offen sc1
  s_waitcnt vmcnt(0)
  v_max3_u32 v22, v84, v86, v88
  v_max3_u32 v22, v22, v90, v92
  v_max3_u32 v22, v22, v94, v96
  v_max_u32 v22, v22, v98
  v_cmp_eq_u32 vcc, -1, v22
  s_nop 0
  s_cbranch_vccnz Lretry24
  s_nop 4
  s_branch Lback25
Lretry26:
  s_nop 7
  s_sub_u32 s74, s74, 1
  s_cbranch_scc1 Lbail
  s_add_u32 s96, s26, 0
  buffer_load_dwordx4 v[56:59], v4, s[12:15], s96 offen offset:0 sc1
  buffer_load_dwordx4 v[60:63], v4, s[12:15], s96 offen offset:1024 sc1
  buffer_load_dwordx4 v[64:67], v4, s[12:15], s96 offen offset:2048 sc1
  buffer_load_dwordx4 v[68:71], v4, s[12:15], s96 offen offset:3072 sc1
  s_add_u32 s96, s26, 4096
  buffer_load_dwordx4 v[72:75], v4, s[12:15], s96 offen offset:0 sc1
  buffer_load_dwordx4 v[76:79], v4, s[12:15], s96 offen offset:1024 sc1
  s_waitcnt vmcnt(0)
  v_bitop3_b32 v22, v56, v57, v58 bitop3:0xf7
  v_bitop3_b32 v22, v22, v59, v60 bitop3:0xfe
  v_bitop3_b32 v22, v22, v61, v62 bitop3:0xf7
  v_bitop3_b32 v22, v22, v63, v64 bitop3:0xfe
  v_bitop3_b32 v22, v22, v65, v66 bitop3:0xf7
  v_bitop3_b32 v22, v22, v67, v68 bitop3:0xfe
  v_bitop3_b32 v22, v22, v69, v70 bitop3:0xf7
  v_bitop3_b32 v22, v22, v71, v72 bitop3:0xfe
  v_bitop3_b32 v22, v22, v73, v74 bitop3:0xf7
  v_bitop3_b32 v22, v22, v75, v76 bitop3:0xfe
  v_bitop3_b32 v22, v22, v77, v78 bitop3:0xf7
  v_bitop3_b32 v22, v22, v79, s75 bitop3:0xa8
  v_cmp_ne_u32 vcc, 0, v22
  s_nop 0
  s_cbranch_vccnz Lretry26
  s_nop 4
  s_branch Lback27
Lretry28:
  s_nop 7
  s_sub_u32 s74, s74, 1
  s_cbranch_scc1 Lbail
  s_add_u32 s96, s26, 4096
  buffer_load_dwordx4 v[80:83], v4, s[12:15], s96 offen offset:2048 sc1
  buffer_load_dwordx4 v[84:87], v4, s[12:15], s96 offen offset:3072 sc1
  s_add_u32 s96, s26, 8192
  buffer_load_dwordx2 v[88:89], v5, s[12:15], s96 offen offset:0 sc1
  buffer_load_dwordx2 v[90:91], v5, s[12:15], s96 offen offset:512 sc1
  buffer_load_dwordx2 v[92:93], v5, s[12:15], s96 offen offset:1024 sc1
  buffer_load_dwordx2 v[94:95], v5, s[12:15], s96 offen offset:1536 sc1
  buffer_load_dwordx2 v[96:97], v5, s[12:15], s96 offen offset:2048 sc1
  buffer_load_dwordx2 v[98:99], v5, s[12:15], s96 offen offset:2560 sc1
  s_waitcnt vmcnt(0)
  v_bitop3_b32 v22, v80, v81, v82 bitop3:0xf7
  v_bitop3_b32 v22, v22, v83, v84 bitop3:0xfe
  v_bitop3_b32 v22, v22, v85, v86 bitop3:0xf7
  v_bitop3_b32 v22, v22, v87, v88 bitop3:0xfe
  v_bitop3_b32 v22, v22, v89, v90 bitop3:0xfb
  v_bitop3_b32 v22, v22, v91, v92 bitop3:0xfb
  v_bitop3_b32 v22, v22, v93, v94 bitop3:0xfb
  v_bitop3_b32 v22, v22, v95, v96 bitop3:0xfb
  v_bitop3_b32 v22, v22, v97, v98 bitop3:0xfb
  v_bitop3_b32 v22, v22, v99, s75 bitop3:0xa2
  v_cmp_ne_u32 vcc, 0, v22
  s_nop 0
  s_cbranch_vccnz Lretry28
  s_nop 4
  s_branch Lback29
Lretry30:
  s_nop 7
  s_sub_u32 s74, s74, 1
  s_cbranch_scc1 Lbail
  s_add_u32 s96, s26, 45056
  buffer_load_dwordx4 v[100:103], v4, s[12:15], s96 offen offset:0 sc1
  buffer_load_dwordx4 v[104:107], v4, s[12:15], s96 offen offset:1024 sc1
  buffer_load_dwordx4 v[108:111], v4, s[12:15], s96 offen offset:2048 sc1
  buffer_load_dwordx4 v[112:115], v4, s[12:15], s96 offen offset:3072 sc1
  s_add_u32 s96, s26, 49152
  buffer_load_dwordx4 v[116:119], v4, s[12:15], s96 offen offset:0 sc1
  buffer_load_dwordx4 v[120:123], v4, s[12:15], s96 offen offset:1024 sc1
  s_waitcnt vmcnt(0)
  v_bitop3_b32 v22, v100, v101, v102 bitop3:0xf7
  v_bitop3_b32 v22, v22, v103, v104 bitop3:0xfe
  v_bitop3_b32 v22, v22, v105, v106 bitop3:0xf7
  v_bitop3_b32 v22, v22, v107, v108 bitop3:0xfe
  v_bitop3_b32 v22, v22, v109, v110 bitop3:0xf7
  v_bitop3_b32 v22, v22, v111, v112 bitop3:0xfe
  v_bitop3_b32 v22, v22, v113, v114 bitop3:0xf7
  v_bitop3_b32 v22, v22, v115, v116 bitop3:0xfe
  v_bitop3_b32 v22, v22, v117, v118 bitop3:0xf7
  v_bitop3_b32 v22, v22, v119, v120 bitop3:0xfe
  v_bitop3_b32 v22, v22, v121, v122 bitop3:0xf7
  v_bitop3_b32 v22, v22, v123, s75 bitop3:0xa8
  v_cmp_ne_u32 vcc, 0, v22
  s_nop 0
  s_cbranch_vccnz Lretry30
  s_nop 4
  s_branch Lback31
Lretry32:
  s_nop 7
  s_sub_u32 s74, s74, 1
  s_cbranch_scc1 Lbail
  s_add_u32 s96, s26, 49152
  buffer_load_dwordx4 v[124:127], v4, s[12:15], s96 offen offset:2048 sc1
  buffer_load_dwordx4 v[128:131], v4, s[12:15], s96 offen offset:3072 sc1
  s_add_u32 s96, s26, 53248
  buffer_load_dwordx2 v[132:133], v5, s[12:15], s96 offen offset:0 sc1
  buffer_load_dwordx2 v[134:135], v5, s[12:15], s96 offen offset:512 sc1
  buffer_load_dwordx2 v[136:137], v5, s[12:15], s96 offen offset:1024 sc1
  buffer_load_dwordx2 v[138:139], v5, s[12:15], s96 offen offset:1536 sc1
  buffer_load_dwordx2 v[140:141], v5, s[12:15], s96 offen offset:2048 sc1
  buffer_load_dwordx2 v[142:143], v5, s[12:15], s96 offen offset:2560 sc1
  s_waitcnt vmcnt(0)
  v_bitop3_b32 v22, v124, v125, v126 bitop3:0xf7
  v_bitop3_b32 v22, v22, v127, v128 bitop3:0xfe
  v_bitop3_b32 v22, v22, v129, v130 bitop3:0xf7
  v_bitop3_b32 v22, v22, v131, v132 bitop3:0xfe
  v_bitop3_b32 v22, v22, v133, v134 bitop3:0xfb
  v_bitop3_b32 v22, v22, v135, v136 bitop3:0xfb
  v_bitop3_b32 v22, v22, v137, v138 bitop3:0xfb
  v_bitop3_b32 v22, v22, v139, v140 bitop3:0xfb
  v_bitop3_b32 v22, v22, v141, v142 bitop3:0xfb
  v_bitop3_b32 v22, v22, v143, s75 bitop3:0xa2
  v_cmp_ne_u32 vcc, 0, v22
  s_nop 0
  s_cbranch_vccnz Lretry32
  s_nop 4
  s_branch Lback33
Lretry34:
  s_nop 7
  s_sub_u32 s74, s74, 1
  s_cbranch_scc1 Lbail
  s_add_u32 s96, s26, 90112
  buffer_load_dwordx4 v[56:59], v4, s[12:15], s96 offen offset:0 sc1
  buffer_load_dwordx4 v[60:63], v4, s[12:15], s96 offen offset:1024 sc1
  buffer_load_dwordx4 v[64:67], v4, s[12:15], s96 offen offset:2048 sc1
  buffer_load_dwordx4 v[68:71], v4, s[12:15], s96 offen offset:3072 sc1
  s_add_u32 s96, s26, 94208
  buffer_load_dwordx4 v[72:75], v4, s[12:15], s96 offen offset:0 sc1
  buffer_load_dwordx4 v[76:79], v4, s[12:15], s96 offen offset:1024 sc1
  s_waitcnt vmcnt(0)
  v_bitop3_b32 v22, v56, v57, v58 bitop3:0xf7
  v_bitop3_b32 v22, v22, v59, v60 bitop3:0xfe
  v_bitop3_b32 v22, v22, v61, v62 bitop3:0xf7
  v_bitop3_b32 v22, v22, v63, v64 bitop3:0xfe
  v_bitop3_b32 v22, v22, v65, v66 bitop3:0xf7
  v_bitop3_b32 v22, v22, v67, v68 bitop3:0xfe
  v_bitop3_b32 v22, v22, v69, v70 bitop3:0xf7
  v_bitop3_b32 v22, v22, v71, v72 bitop3:0xfe
  v_bitop3_b32 v22, v22, v73, v74 bitop3:0xf7
  v_bitop3_b32 v22, v22, v75, v76 bitop3:0xfe
  v_bitop3_b32 v22, v22, v77, v78 bitop3:0xf7
  v_bitop3_b32 v22, v22, v79, s75 bitop3:0xa8
  v_cmp_ne_u32 vcc, 0, v22
  s_nop 0
  s_cbranch_vccnz Lretry34
  s_nop 4
  s_branch Lback35
Lretry36:
  s_nop 7
  s_sub_u32 s74, s74, 1
  s_cbranch_scc1 Lbail
  s_add_u32 s96, s26, 94208
  buffer_load_dwordx4 v[80:83], v4, s[12:15], s96 offen offset:2048 sc1
  buffer_load_dwordx4 v[84:87], v4, s[12:15], s96 offen offset:3072 sc1
  s_add_u32 s96, s26, 98304
  buffer_load_dwordx2 v[88:89], v5, s[12:15], s96 offen offset:0 sc1
  buffer_load_dwordx2 v[90:91], v5, s[12:15], s96 offen offset:512 sc1
  buffer_load_dwordx2 v[92:93], v5, s[12:15], s96 offen offset:1024 sc1
  buffer_load_dwordx2 v[94:95], v5, s[12:15], s96 offen offset:1536 sc1
  buffer_load_dwordx2 v[96:97], v5, s[12:15], s96 offen offset:2048 sc1
  buffer_load_dwordx2 v[98:99], v5, s[12:15], s96 offen offset:2560 sc1
  s_waitcnt vmcnt(0)
  v_bitop3_b32 v22, v80, v81, v82 bitop3:0xf7
  v_bitop3_b32 v22, v22, v83, v84 bitop3:0xfe
  v_bitop3_b32 v22, v22, v85, v86 bitop3:0xf7
  v_bitop3_b32 v22, v22, v87, v88 bitop3:0xfe
  v_bitop3_b32 v22, v22, v89, v90 bitop3:0xfb
  v_bitop3_b32 v22, v22, v91, v92 bitop3:0xfb
  v_bitop3_b32 v22, v22, v93, v94 bitop3:0xfb
  v_bitop3_b32 v22, v22, v95, v96 bitop3:0xfb
  v_bitop3_b32 v22, v22, v97, v98 bitop3:0xfb
  v_bitop3_b32 v22, v22, v99, s75 bitop3:0xa2
  v_cmp_ne_u32 vcc, 0, v22
  s_nop 0
  s_cbranch_vccnz Lretry36
  s_nop 4
  s_branch Lback37
Lretry38:
  s_nop 7
  s_sub_u32 s74, s74, 1
  s_cbranch_scc1 Lbail
  s_add_u32 s96, s26, 135168
  buffer_load_dwordx4 v[100:103], v4, s[12:15], s96 offen offset:0 sc1
  buffer_load_dwordx4 v[104:107], v4, s[12:15], s96 offen offset:1024 sc1
  buffer_load_dwordx4 v[108:111], v4, s[12:15], s96 offen offset:2048 sc1
  buffer_load_dwordx4 v[112:115], v4, s[12:15], s96 offen offset:3072 sc1
  s_add_u32 s96, s26, 139264
  buffer_load_dwordx4 v[116:119], v4, s[12:15], s96 offen offset:0 sc1
  buffer_load_dwordx4 v[120:123], v4, s[12:15], s96 offen offset:1024 sc1
  s_waitcnt vmcnt(0)
  v_bitop3_b32 v22, v100, v101, v102 bitop3:0xf7
  v_bitop3_b32 v22, v22, v103, v104 bitop3:0xfe
  v_bitop3_b32 v22, v22, v105, v106 bitop3:0xf7
  v_bitop3_b32 v22, v22, v107, v108 bitop3:0xfe
  v_bitop3_b32 v22, v22, v109, v110 bitop3:0xf7
  v_bitop3_b32 v22, v22, v111, v112 bitop3:0xfe
  v_bitop3_b32 v22, v22, v113, v114 bitop3:0xf7
  v_bitop3_b32 v22, v22, v115, v116 bitop3:0xfe
  v_bitop3_b32 v22, v22, v117, v118 bitop3:0xf7
  v_bitop3_b32 v22, v22, v119, v120 bitop3:0xfe
  v_bitop3_b32 v22, v22, v121, v122 bitop3:0xf7
  v_bitop3_b32 v22, v22, v123, s75 bitop3:0xa8
  v_cmp_ne_u32 vcc, 0, v22
  s_nop 0
  s_cbranch_vccnz Lretry38
  s_nop 4
  s_branch Lback39
Lretry40:
  s_nop 7
  s_sub_u32 s74, s74, 1
  s_cbranch_scc1 Lbail
  s_add_u32 s96, s26, 139264
  buffer_load_dwordx4 v[124:127], v4, s[12:15], s96 offen offset:2048 sc1
  buffer_load_dwordx4 v[128:131], v4, s[12:15], s96 offen offset:3072 sc1
  s_add_u32 s96, s26, 143360
  buffer_load_dwordx2 v[132:133], v5, s[12:15], s96 offen offset:0 sc1
  buffer_load_dwordx2 v[134:135], v5, s[12:15], s96 offen offset:512 sc1
  buffer_load_dwordx2 v[136:137], v5, s[12:15], s96 offen offset:1024 sc1
  buffer_load_dwordx2 v[138:139], v5, s[12:15], s96 offen offset:1536 sc1
  buffer_load_dwordx2 v[140:141], v5, s[12:15], s96 offen offset:2048 sc1
  buffer_load_dwordx2 v[142:143], v5, s[12:15], s96 offen offset:2560 sc1
  s_waitcnt vmcnt(0)
  v_bitop3_b32 v22, v124, v125, v126 bitop3:0xf7
  v_bitop3_b32 v22, v22, v127, v128 bitop3:0xfe
  v_bitop3_b32 v22, v22, v129, v130 bitop3:0xf7
  v_bitop3_b32 v22, v22, v131, v132 bitop3:0xfe
  v_bitop3_b32 v22, v22, v133, v134 bitop3:0xfb
  v_bitop3_b32 v22, v22, v135, v136 bitop3:0xfb
  v_bitop3_b32 v22, v22, v137, v138 bitop3:0xfb
  v_bitop3_b32 v22, v22, v139, v140 bitop3:0xfb
  v_bitop3_b32 v22, v22, v141, v142 bitop3:0xfb
  v_bitop3_b32 v22, v22, v143, s75 bitop3:0xa2
  v_cmp_ne_u32_e64 vcc, 0, v22
  s_nop 0
  s_cbranch_vccnz Lretry40
  s_nop 4
  s_branch Lback41
Lretry42:
  s_nop 7
  s_sub_u32 s74, s74, 1
  s_cbranch_scc1 Lbail
  s_add_u32 s96, s33, 6291456
  buffer_load_dwordx4 v[24:27], v3, s[12:15], s96 offen sc1
  s_add_u32 s96, s33, 6295552
  buffer_load_dwordx4 v[28:31], v3, s[12:15], s96 offen sc1
  s_add_u32 s96, s33, 6299648
  buffer_load_dwordx4 v[32:35], v3, s[12:15], s96 offen sc1
  s_add_u32 s96, s33, 6303744
  buffer_load_dwordx4 v[36:39], v3, s[12:15], s96 offen sc1
  s_waitcnt vmcnt(0)
  v_max3_u32 v22, v24, v26, v28
  v_max3_u32 v22, v22, v30, v32
  v_max3_u32 v22, v22, v34, v36
  v_max_u32 v22, v22, v38
  v_cmp_eq_u32 vcc, -1, v22
  s_nop 0
  s_cbranch_vccnz Lretry42
  s_nop 4
  s_branch Lback43
Lretry44:
  s_nop 7
  s_sub_u32 s74, s74, 1
  s_cbranch_scc1 Lbail
  s_add_u32 s96, s33, 6815744
  buffer_load_dwordx4 v[68:71], v3, s[12:15], s96 offen sc1
  s_add_u32 s96, s33, 6819840
  buffer_load_dwordx4 v[72:75], v3, s[12:15], s96 offen sc1
  s_add_u32 s96, s33, 6823936
  buffer_load_dwordx4 v[76:79], v3, s[12:15], s96 offen sc1
  s_add_u32 s96, s33, 6828032
  buffer_load_dwordx4 v[80:83], v3, s[12:15], s96 offen sc1
  s_waitcnt vmcnt(0)
  v_max3_u32 v22, v68, v70, v72
  v_max3_u32 v22, v22, v74, v76
  v_max3_u32 v22, v22, v78, v80
  v_max_u32 v22, v22, v82
  v_cmp_eq_u32 vcc, -1, v22
  s_nop 0
  s_cbranch_vccnz Lretry44
  s_nop 4
  s_branch Lback45
Lretry46:
  s_nop 7
  s_sub_u32 s74, s74, 1
  s_cbranch_scc1 Lbail
  s_add_u32 s96, s33, 7340032
  buffer_load_dwordx4 v[100:103], v3, s[12:15], s96 offen sc1
  s_add_u32 s96, s33, 7344128
  buffer_load_dwordx4 v[104:107], v3, s[12:15], s96 offen sc1
  s_add_u32 s96, s33, 7348224
  buffer_load_dwordx4 v[108:111], v3, s[12:15], s96 offen sc1
  s_add_u32 s96, s33, 7352320
  buffer_load_dwordx4 v[112:115], v3, s[12:15], s96 offen sc1
  s_waitcnt vmcnt(0)
  v_max3_u32 v22, v100, v102, v104
  v_max3_u32 v22, v22, v106, v108
  v_max3_u32 v22, v22, v110, v112
  v_max_u32 v22, v22, v114
  v_cmp_eq_u32 vcc, -1, v22
  s_nop 0
  s_cbranch_vccnz Lretry46
  s_nop 4
  s_branch Lback47
Lretry48:
  s_nop 7
  s_sub_u32 s74, s74, 1
  s_cbranch_scc1 Lbail
  s_add_u32 s96, s33, 7864320
  buffer_load_dwordx4 v[84:87], v3, s[12:15], s96 offen sc1
  s_add_u32 s96, s33, 7868416
  buffer_load_dwordx4 v[88:91], v3, s[12:15], s96 offen sc1
  s_add_u32 s96, s33, 7872512
  buffer_load_dwordx4 v[92:95], v3, s[12:15], s96 offen sc1
  s_add_u32 s96, s33, 7876608
  buffer_load_dwordx4 v[96:99], v3, s[12:15], s96 offen sc1
  s_waitcnt vmcnt(0)
  v_max3_u32 v22, v84, v86, v88
  v_max3_u32 v22, v22, v90, v92
  v_max3_u32 v22, v22, v94, v96
  v_max_u32 v22, v22, v98
  v_cmp_eq_u32_e64 vcc, -1, v22
  s_nop 0
  s_cbranch_vccnz Lretry48
  s_nop 4
  s_branch Lback49
Lretry50:
  s_nop 7
  s_sub_u32 s74, s74, 1
  s_cbranch_scc1 Lbail
  s_add_u32 s96, s26, 0
  buffer_load_dwordx4 v[56:59], v4, s[12:15], s96 offen offset:0 sc1
  buffer_load_dwordx4 v[60:63], v4, s[12:15], s96 offen offset:1024 sc1
  buffer_load_dwordx4 v[64:67], v4, s[12:15], s96 offen offset:2048 sc1
  buffer_load_dwordx4 v[68:71], v4, s[12:15], s96 offen offset:3072 sc1
  s_add_u32 s96, s26, 4096
  buffer_load_dwordx4 v[72:75], v4, s[12:15], s96 offen offset:0 sc1
  buffer_load_dwordx4 v[76:79], v4, s[12:15], s96 offen offset:1024 sc1
  s_waitcnt vmcnt(0)
  v_bitop3_b32 v22, v56, v60, v64 bitop3:0x80
  v_bitop3_b32 v22, v22, v68, v72 bitop3:0x80
  v_and_b32 v22, v22, v76
  v_cmp_le_i32 vcc, 0, v22
  s_nop 0
  s_cbranch_vccnz Lretry50
  s_nop 4
  s_branch Lback51
Lretry52:
  s_nop 7
  s_sub_u32 s74, s74, 1
  s_cbranch_scc1 Lbail
  s_add_u32 s96, s26, 4096
  buffer_load_dwordx4 v[80:83], v4, s[12:15], s96 offen offset:2048 sc1
  buffer_load_dwordx4 v[84:87], v4, s[12:15], s96 offen offset:3072 sc1
  s_add_u32 s96, s26, 8192
  buffer_load_dwordx2 v[88:89], v5, s[12:15], s96 offen offset:0 sc1
  buffer_load_dwordx2 v[90:91], v5, s[12:15], s96 offen offset:512 sc1
  buffer_load_dwordx2 v[92:93], v5, s[12:15], s96 offen offset:1024 sc1
  buffer_load_dwordx2 v[94:95], v5, s[12:15], s96 offen offset:1536 sc1
  buffer_load_dwordx2 v[96:97], v5, s[12:15], s96 offen offset:2048 sc1
  buffer_load_dwordx2 v[98:99], v5, s[12:15], s96 offen offset:2560 sc1
  s_waitcnt vmcnt(0)
  v_bitop3_b32 v22, v80, v84, v88 bitop3:0x80
  v_bitop3_b32 v22, v22, v90, v92 bitop3:0x80
  v_bitop3_b32 v22, v22, v94, v96 bitop3:0x80
  v_and_b32 v22, v22, v98
  v_cmp_le_i32 vcc, 0, v22
  s_nop 0
  s_cbranch_vccnz Lretry52
  s_nop 4
  s_branch Lback53
Lretry54:
  s_nop 7
  s_sub_u32 s74, s74, 1
  s_cbranch_scc1 Lbail
  s_add_u32 s96, s26, 45056
  buffer_load_dwordx4 v[100:103], v4, s[12:15], s96 offen offset:0 sc1
  buffer_load_dwordx4 v[104:107], v4, s[12:15], s96 offen offset:1024 sc1
  buffer_load_dwordx4 v[108:111], v4, s[12:15], s96 offen offset:2048 sc1
  buffer_load_dwordx4 v[112:115], v4, s[12:15], s96 offen offset:3072 sc1
  s_add_u32 s96, s26, 49152
  buffer_load_dwordx4 v[116:119], v4, s[12:15], s96 offen offset:0 sc1
  buffer_load_dwordx4 v[120:123], v4, s[12:15], s96 offen offset:1024 sc1
  s_waitcnt vmcnt(0)
  v_bitop3_b32 v22, v100, v104, v108 bitop3:0x80
  v_bitop3_b32 v22, v22, v112, v116 bitop3:0x80
  v_and_b32 v22, v22, v120
  v_cmp_le_i32 vcc, 0, v22
  s_nop 0
  s_cbranch_vccnz Lretry54
  s_nop 4
  s_branch Lback55
Lretry56:
  s_nop 7
  s_sub_u32 s74, s74, 1
  s_cbranch_scc1 Lbail
  s_add_u32 s96, s26, 49152
  buffer_load_dwordx4 v[124:127], v4, s[12:15], s96 offen offset:2048 sc1
  buffer_load_dwordx4 v[128:131], v4, s[12:15], s96 offen offset:3072 sc1
  s_add_u32 s96, s26, 53248
  buffer_load_dwordx2 v[132:133], v5, s[12:15], s96 offen offset:0 sc1
  buffer_load_dwordx2 v[134:135], v5, s[12:15], s96 offen offset:512 sc1
  buffer_load_dwordx2 v[136:137], v5, s[12:15], s96 offen offset:1024 sc1
  buffer_load_dwordx2 v[138:139], v5, s[12:15], s96 offen offset:1536 sc1
  buffer_load_dwordx2 v[140:141], v5, s[12:15], s96 offen offset:2048 sc1
  buffer_load_dwordx2 v[142:143], v5, s[12:15], s96 offen offset:2560 sc1
  s_waitcnt vmcnt(0)
  v_bitop3_b32 v22, v124, v128, v132 bitop3:0x80
  v_bitop3_b32 v22, v22, v134, v136 bitop3:0x80
  v_bitop3_b32 v22, v22, v138, v140 bitop3:0x80
  v_and_b32 v22, v22, v142
  v_cmp_le_i32 vcc, 0, v22
  s_nop 0
  s_cbranch_vccnz Lretry56
  s_nop 4
  s_branch Lback57
Lretry58:
  s_nop 7
  s_sub_u32 s74, s74, 1
  s_cbranch_scc1 Lbail
  s_add_u32 s96, s26, 90112
  buffer_load_dwordx4 v[56:59], v4, s[12:15], s96 offen offset:0 sc1
  buffer_load_dwordx4 v[60:63], v4, s[12:15], s96 offen offset:1024 sc1
  buffer_load_dwordx4 v[64:67], v4, s[12:15], s96 offen offset:2048 sc1
  buffer_load_dwordx4 v[68:71], v4, s[12:15], s96 offen offset:3072 sc1
  s_add_u32 s96, s26, 94208
  buffer_load_dwordx4 v[72:75], v4, s[12:15], s96 offen offset:0 sc1
  buffer_load_dwordx4 v[76:79], v4, s[12:15], s96 offen offset:1024 sc1
  s_waitcnt vmcnt(0)
  v_bitop3_b32 v22, v56, v60, v64 bitop3:0x80
  v_bitop3_b32 v22, v22, v68, v72 bitop3:0x80
  v_and_b32_e64 v22, v22, v76
  v_cmp_le_i32_e64 vcc, 0, v22
  s_nop 0
  s_cbranch_vccnz Lretry58
  s_nop 4
  s_branch Lback59
Lretry60:
  s_nop 7
  s_sub_u32 s74, s74, 1
  s_cbranch_scc1 Lbail
  s_add_u32 s96, s26, 94208
  buffer_load_dwordx4 v[80:83], v4, s[12:15], s96 offen offset:2048 sc1
  buffer_load_dwordx4 v[84:87], v4, s[12:15], s96 offen offset:3072 sc1
  s_add_u32 s96, s26, 98304
  buffer_load_dwordx2 v[88:89], v5, s[12:15], s96 offen offset:0 sc1
  buffer_load_dwordx2 v[90:91], v5, s[12:15], s96 offen offset:512 sc1
  buffer_load_dwordx2 v[92:93], v5, s[12:15], s96 offen offset:1024 sc1
  buffer_load_dwordx2 v[94:95], v5, s[12:15], s96 offen offset:1536 sc1
  buffer_load_dwordx2 v[96:97], v5, s[12:15], s96 offen offset:2048 sc1
  buffer_load_dwordx2 v[98:99], v5, s[12:15], s96 offen offset:2560 sc1
  s_waitcnt vmcnt(0)
  v_bitop3_b32 v22, v80, v84, v88 bitop3:0x80
  v_bitop3_b32 v22, v22, v90, v92 bitop3:0x80
  v_bitop3_b32 v22, v22, v94, v96 bitop3:0x80
  v_and_b32 v22, v22, v98
  v_cmp_le_i32 vcc, 0, v22
  s_nop 0
  s_cbranch_vccnz Lretry60
  s_nop 4
  s_branch Lback61
Lretry62:
  s_nop 7
  s_sub_u32 s74, s74, 1
  s_cbranch_scc1 Lbail
  s_add_u32 s96, s26, 135168
  buffer_load_dwordx4 v[100:103], v4, s[12:15], s96 offen offset:0 sc1
  buffer_load_dwordx4 v[104:107], v4, s[12:15], s96 offen offset:1024 sc1
  buffer_load_dwordx4 v[108:111], v4, s[12:15], s96 offen offset:2048 sc1
  buffer_load_dwordx4 v[112:115], v4, s[12:15], s96 offen offset:3072 sc1
  s_add_u32 s96, s26, 139264
  buffer_load_dwordx4 v[116:119], v4, s[12:15], s96 offen offset:0 sc1
  buffer_load_dwordx4 v[120:123], v4, s[12:15], s96 offen offset:1024 sc1
  s_waitcnt vmcnt(0)
  v_bitop3_b32 v22, v100, v104, v108 bitop3:0x80
  v_bitop3_b32 v22, v22, v112, v116 bitop3:0x80
  v_and_b32 v22, v22, v120
  v_cmp_le_i32 vcc, 0, v22
  s_nop 0
  s_cbranch_vccnz Lretry62
  s_nop 4
  s_branch Lback63
Lretry64:
  s_nop 7
  s_sub_u32 s74, s74, 1
  s_cbranch_scc1 Lbail
  s_add_u32 s96, s26, 139264
  buffer_load_dwordx4 v[124:127], v4, s[12:15], s96 offen offset:2048 sc1
  buffer_load_dwordx4 v[128:131], v4, s[12:15], s96 offen offset:3072 sc1
  s_add_u32 s96, s26, 143360
  buffer_load_dwordx2 v[132:133], v5, s[12:15], s96 offen offset:0 sc1
  buffer_load_dwordx2 v[134:135], v5, s[12:15], s96 offen offset:512 sc1
  buffer_load_dwordx2 v[136:137], v5, s[12:15], s96 offen offset:1024 sc1
  buffer_load_dwordx2 v[138:139], v5, s[12:15], s96 offen offset:1536 sc1
  buffer_load_dwordx2 v[140:141], v5, s[12:15], s96 offen offset:2048 sc1
  buffer_load_dwordx2 v[142:143], v5, s[12:15], s96 offen offset:2560 sc1
  s_waitcnt vmcnt(0)
  v_bitop3_b32 v22, v124, v128, v132 bitop3:0x80
  v_bitop3_b32 v22, v22, v134, v136 bitop3:0x80
  v_bitop3_b32 v22, v22, v138, v140 bitop3:0x80
  v_and_b32 v22, v22, v142
  v_cmp_le_i32 vcc, 0, v22
  s_nop 0
  s_cbranch_vccnz Lretry64
  s_nop 4
  s_branch Lback65
Lcodeend:
.section .rodata,"a"
.p2align 6
.amdhsa_kernel interleave_layers__ssm_conv_s4d__dense_activation_relu__prompt_kernel
  .amdhsa_next_free_vgpr 512
  .amdhsa_next_free_sgpr 102
  .amdhsa_accum_offset 256
  .amdhsa_group_segment_fixed_size 0
  .amdhsa_kernarg_size 104
  .amdhsa_user_sgpr_count 2
  .amdhsa_user_sgpr_kernarg_segment_ptr 1
  .amdhsa_system_sgpr_workgroup_id_x 1
.end_amdhsa_kernel
```
